```python
import torch

def _softmax(x, axis=-1):
    return torch.softmax(x, dim=axis)

def _gelu(x):
    return torch.nn.functional.gelu(x, approximate='tanh')

def _silu(x):
    return torch.nn.functional.silu(x)

def _sigmoid(x):
    return torch.sigmoid(x)

def _layernorm(x, axis=-1, eps=1e-05):
    m = x.mean(dim=axis, keepdim=True)
    v = x.var(dim=axis, keepdim=True, unbiased=False)
    return (x - m) / torch.sqrt(v + eps)

def _scatter_add(tgt, idx, src, axis=0):
    return tgt.clone().index_add_(axis, idx, src)

def _segment_sum(src, seg, n):
    out = torch.zeros((n,) + src.shape[1:], dtype=src.dtype)
    return out.index_add_(0, seg, src)

def _pad(x, pw):
    flat = tuple((v for pair in reversed(pw) for v in pair))
    return torch.nn.functional.pad(x, flat)
kernel_name = 'concat_heads__linear_attn_block__memory_aug_recurrent_mem_tr__prompt'

def setup_inputs():

    _w = lambda a: (lambda t: t.to(torch.bfloat16) if t.is_floating_point() else t)(torch.as_tensor(a))

    def _A_setup():
        B, S, D = (1, 2048, 448)
        return {'x': _w((lambda *s: torch.randn(*s, dtype=torch.bfloat16) * 0.05)(B, S, D)), 'wqkv': _w((lambda *s: torch.randn(*s, dtype=torch.bfloat16) * 1.6)(D, 3 * D)), 'wo': _w((lambda *s: torch.randn(*s, dtype=torch.bfloat16) * 0.1)(D, D))}
    _A_in = _A_setup()

    def _B_setup():
        B, S, Dm = (1, 2048, 448)
        H, Dh = (16, 256)
        M, seg = (8, 32)
        seg = min(seg, S)
        S = S // seg * seg
        return {'x': _w((lambda *s: torch.randn(*s, dtype=torch.bfloat16) * 0.05)(B, S, Dm)), 'mem0': _w((lambda *s: torch.randn(*s, dtype=torch.bfloat16) * 0.8)(B, M, Dm)), 'Wq': _w((lambda *s: torch.randn(*s, dtype=torch.bfloat16) * 1.6)(Dm, H, Dh) * Dm ** (-0.5)), 'Wk': _w((lambda *s: torch.randn(*s, dtype=torch.bfloat16) * 1.6)(Dm, H, Dh) * Dm ** (-0.5)), 'Wv': _w((lambda *s: torch.randn(*s, dtype=torch.bfloat16) * 0.8)(Dm, H, Dh) * Dm ** (-0.5)), 'Wo': _w((lambda *s: torch.randn(*s, dtype=torch.bfloat16) * 0.8)(H, Dh, Dm) * (H * Dh) ** (-0.5)), 'seg_len': seg}
    _B_in = _B_setup()
    return {'A_x': _A_in['x'], 'A_wqkv': _A_in['wqkv'], 'A_wo': _A_in['wo'], 'B_x': _B_in['x'], 'B_mem0': _B_in['mem0'], 'B_Wq': _B_in['Wq'], 'B_Wk': _B_in['Wk'], 'B_Wv': _B_in['Wv'], 'B_Wo': _B_in['Wo'], 'B_seg_len': _B_in['seg_len']}

def reference(A_x, A_wqkv, A_wo, B_x, B_mem0, B_Wq, B_Wk, B_Wv, B_Wo, B_seg_len):

    def _A_ref(x, wqkv, wo):
        B, S, D = x.shape
        H = 16
        Dh = D // H
        qkv = (lambda x, *d: x.permute(*d))((x @ wqkv).reshape(B, S, 3, H, Dh), 2, 0, 3, 1, 4)
        q, k, v = (qkv[0], qkv[1], qkv[2])
        phi = lambda t: torch.where(t > 0, t + 1, torch.exp(t)) + 1e-06
        pq, pk = (phi(q), phi(k))
        kv = torch.einsum('bhsd,bhse->bhde', pk, v)
        z = torch.einsum('bhsd->bhd', pk)
        num = torch.einsum('bhqd,bhde->bhqe', pq, kv)
        den = torch.einsum('bhqd,bhd->bhq', pq, z)[..., None] + 1e-06
        o = num / den
        return (lambda x, *d: x.permute(*d))(o, 0, 2, 1, 3).reshape(B, S, D) @ wo

    def _B_ref(x, mem0, Wq, Wk, Wv, Wo, seg_len):
        B, S, Dm = x.shape
        H, Dh = (Wq.shape[1], Wq.shape[2])
        M = mem0.shape[1]
        scale = Dh ** (-0.5)
        n_seg = S // seg_len
        L = M + seg_len
        idx = torch.arange(L)
        mask = (idx[:, None] < M) | (idx[:, None] >= idx[None, :])
        mem = mem0
        outs = []
        for s in range(n_seg):
            xs = x[:, s * seg_len:(s + 1) * seg_len, :].clone()
            h = torch.concatenate([mem, xs], axis=1)
            q = torch.einsum('btd,dhe->bhte', h, Wq)
            k = torch.einsum('btd,dhe->bhte', h, Wk)
            v = torch.einsum('btd,dhe->bhte', h, Wv)
            scores = torch.einsum('bhqe,bhke->bhqk', q, k) * scale
            scores = torch.where(mask[None, None], scores, -1000000000.0)
            p = _softmax(scores, axis=-1)
            o = torch.einsum('bhqk,bhke->bhqe', p, v)
            o = torch.einsum('bhte,hed->btd', o, Wo)
            mem = o[:, :M, :].clone()
            outs.append(o[:, M:, :])
        return torch.concatenate(outs, axis=1)
    a = _A_ref(A_x, A_wqkv, A_wo)
    b = _B_ref(B_x, B_mem0, B_Wq, B_Wk, B_Wv, B_Wo, B_seg_len)
    return torch.concatenate([a, b], axis=-1)
```

```asm
; @launch grid=(256,1,1) block=(256,1,1) lds=163840
.amdgcn_target "amdgcn-amd-amdhsa--gfx950"
.text
.globl concat_heads__linear_attn_block__memory_aug_recurrent_mem_tr__prompt_kernel
.p2align 8
.type concat_heads__linear_attn_block__memory_aug_recurrent_mem_tr__prompt_kernel,@function
concat_heads__linear_attn_block__memory_aug_recurrent_mem_tr__prompt_kernel:
    s_cmp_ge_u32 s2, 256
    s_cbranch_scc1 L_exit
    s_load_dwordx16 s[64:79], s[0:1], 0
    s_load_dwordx8 s[80:87], s[0:1], 64
    s_load_dwordx2 s[88:89], s[0:1], 96
    s_getpc_b64 s[4:5]
L_pc:
    s_lshr_b32 s6, s2, 3
    s_and_b32 s6, s6, 3
    s_lshl_b32 s6, s6, 8
    v_add_u32 v1, s6, v0
    v_lshlrev_b32 v1, 7, v1
    v_min_u32 v1, L_exit-L_pc, v1
    global_load_dword v251, v1, s[4:5]
    v_lshrrev_b32 v1, 6, v0
    v_and_b32 v0, 63, v0
    s_getreg_b32 s61, hwreg(HW_REG_XCC_ID)
    v_readfirstlane_b32 s60, v1
    s_and_b32 s61, s61, 7
    s_waitcnt lgkmcnt(0)
    s_mov_b32 s44, s64
    s_and_b32 s45, s65, 0xffff
    s_mov_b32 s46, 1835008
    s_mov_b32 s47, 0x00020000
    s_mov_b32 s48, s66
    s_and_b32 s49, s67, 0xffff
    s_mov_b32 s50, 1204224
    s_mov_b32 s51, 0x00020000
    s_mov_b32 s52, s68
    s_and_b32 s53, s69, 0xffff
    s_mov_b32 s54, 401408
    s_mov_b32 s55, 0x00020000
    s_mov_b32 s12, s70
    s_and_b32 s13, s71, 0xffff
    s_mov_b32 s14, 1835008
    s_mov_b32 s15, 0x00020000
    s_mov_b32 s16, s72
    s_and_b32 s17, s73, 0xffff
    s_mov_b32 s18, 7168
    s_mov_b32 s19, 0x00020000
    s_mov_b32 s28, s74
    s_and_b32 s29, s75, 0xffff
    s_mov_b32 s30, 3670016
    s_mov_b32 s31, 0x00020000
    s_mov_b32 s32, s76
    s_and_b32 s33, s77, 0xffff
    s_mov_b32 s34, 3670016
    s_mov_b32 s35, 0x00020000
    s_mov_b32 s36, s78
    s_and_b32 s37, s79, 0xffff
    s_mov_b32 s38, 3670016
    s_mov_b32 s39, 0x00020000
    s_mov_b32 s40, s80
    s_and_b32 s41, s81, 0xffff
    s_mov_b32 s42, 3670016
    s_mov_b32 s43, 0x00020000
    s_mov_b32 s24, s84
    s_and_b32 s25, s85, 0xffff
    s_mov_b32 s26, 3670016
    s_mov_b32 s27, 0x00020000
    s_mov_b32 s20, s86
    s_and_b32 s21, s87, 0xffff
    s_mov_b32 s22, 256
    s_mov_b32 s23, 0x00020000
    s_mov_b32 s8, s88
    s_and_b32 s9, s89, 0xffff
    s_mov_b32 s10, 268435456
    s_mov_b32 s11, 0x00020000
    v_mov_b32 v2, 163832
    s_cmp_lg_u32 s60, 0
    s_cbranch_scc1 L_tk_wait
    s_lshr_b32 s65, s61, 1
    s_lshl_b32 s65, s65, 6
    s_and_b32 s66, s61, 1
    s_lshl_b32 s66, s66, 2
    s_add_u32 s65, s65, s66
    v_mov_b32 v3, s65
    v_mov_b32 v4, 1
    s_mov_b64 exec, 1
    buffer_atomic_add v4, v3, s[20:23], 0 offen sc0
    s_mov_b64 exec, -1
L_tk_wait:
    s_cmp_lg_u32 s60, 0
    s_cbranch_scc1 L_tk_wait2
    s_cmp_eq_u32 s61, 0
    s_cbranch_scc0 L_tk_w3
    s_waitcnt vmcnt(0)
L_tk_w3:
    s_waitcnt vmcnt(0)
    s_mov_b64 exec, 1
    ds_write_b32 v2, v4
    s_mov_b64 exec, -1
    s_waitcnt lgkmcnt(0)
L_tk_wait2:
    s_barrier
    ds_read_b32 v3, v2
    s_waitcnt lgkmcnt(0)
    v_readfirstlane_b32 s62, v3
L_tk_done:
    s_nop 0
    s_cmp_ge_u32 s62, 32
    s_cbranch_scc1 L_exit
    s_cmp_lg_u32 s61, 0
    s_cbranch_scc1 L_worker
    v_mov_b32 v255, v0
    s_mov_b32 s64, 4000000
    s_and_b32 s65, s62, 3
    s_lshl_b32 s82, s65, 8
    s_add_u32 s83, s82, 88219648
    s_add_u32 s82, s82, 88211456
    v_and_b32 v1, 2, v0
    v_cmp_eq_u32 vcc, 0, v1
    v_mov_b32 v2, 0xeeeeeeee
    v_mov_b32 v3, 0x44444444
    v_cndmask_b32 v60, v2, v3, vcc
    v_lshlrev_b32 v1, 4, v0
    s_sub_u32 s66, s62, 16
    s_lshr_b32 s66, s66, 1
    s_cmp_lt_u32 s62, 16
    s_cselect_b32 s66, 0, s66
    s_lshl_b32 s65, s60, 1
    s_add_u32 s65, s65, s66
    s_add_u32 s66, s65, 0
    s_sub_u32 s67, s66, 7
    s_cmp_ge_u32 s66, 7
    s_cselect_b32 s66, s67, s66
    s_mov_b32 s87, s66
    s_mov_b32 s65, s66
    s_add_u32 s66, s65, 0
    s_sub_u32 s67, s66, 7
    s_cmp_ge_u32 s66, 7
    s_cselect_b32 s66, s67, s66
    s_lshl_b32 s66, s66, 10
    v_add_u32 v61, s66, v1
    s_add_u32 s66, s65, 1
    s_sub_u32 s67, s66, 7
    s_cmp_ge_u32 s66, 7
    s_cselect_b32 s66, s67, s66
    s_lshl_b32 s66, s66, 10
    v_add_u32 v62, s66, v1
    s_add_u32 s66, s65, 2
    s_sub_u32 s67, s66, 7
    s_cmp_ge_u32 s66, 7
    s_cselect_b32 s66, s67, s66
    s_lshl_b32 s66, s66, 10
    v_add_u32 v63, s66, v1
    s_add_u32 s66, s65, 3
    s_sub_u32 s67, s66, 7
    s_cmp_ge_u32 s66, 7
    s_cselect_b32 s66, s67, s66
    s_lshl_b32 s66, s66, 10
    v_add_u32 v64, s66, v1
    s_add_u32 s66, s65, 4
    s_sub_u32 s67, s66, 7
    s_cmp_ge_u32 s66, 7
    s_cselect_b32 s66, s67, s66
    s_lshl_b32 s66, s66, 10
    v_add_u32 v65, s66, v1
    s_add_u32 s66, s65, 5
    s_sub_u32 s67, s66, 7
    s_cmp_ge_u32 s66, 7
    s_cselect_b32 s66, s67, s66
    s_lshl_b32 s66, s66, 10
    v_add_u32 v66, s66, v1
    s_add_u32 s66, s65, 6
    s_sub_u32 s67, s66, 7
    s_cmp_ge_u32 s66, 7
    s_cselect_b32 s66, s67, s66
    s_lshl_b32 s66, s66, 10
    v_add_u32 v67, s66, v1
    s_cmp_ge_u32 s62, 30
    s_cbranch_scc1 L_helper
    s_cmp_ge_u32 s62, 16
    s_cbranch_scc1 L_value
L_score:
    v_mov_b32 v70, 8192
    v_bfe_u32 v1, v255, 2, 2
    v_lshl_add_u32 v70, v1, 6, v70
    v_bfe_u32 v1, v255, 0, 1
    v_lshl_add_u32 v70, v1, 5, v70
    v_bfe_u32 v1, v255, 4, 2
    v_lshl_add_u32 v70, v1, 3, v70
    v_bfe_u32 v1, v255, 1, 1
    v_lshl_add_u32 v70, v1, 2, v70
    v_mov_b32 v71, 8192
    v_bfe_u32 v1, v255, 4, 2
    v_mul_u32_u24 v1, 1792, v1
    v_add_u32 v71, v71, v1
    v_bfe_u32 v1, v255, 0, 4
    v_lshl_add_u32 v71, v1, 3, v71
    v_mov_b32 v72, 0
    v_bfe_u32 v1, v255, 5, 1
    v_mul_u32_u24 v1, 1792, v1
    v_add_u32 v72, v72, v1
    v_bfe_u32 v1, v255, 4, 1
    v_lshl_add_u32 v72, v1, 5, v72
    v_bfe_u32 v1, v255, 0, 2
    v_lshl_add_u32 v72, v1, 6, v72
    v_bfe_u32 v1, v255, 3, 1
    v_lshl_add_u32 v72, v1, 4, v72
    v_mov_b32 v73, 0
    v_bfe_u32 v1, v255, 0, 6
    v_lshl_add_u32 v73, v1, 4, v73
    s_lshl_b32 s65, s60, 12
    s_add_u32 s65, s65, 65536
    v_add_u32 v78, s65, v73
    s_lshl_b32 s65, s62, 9
    v_mov_b32 v74, s65
    v_bfe_u32 v1, v255, 3, 1
    v_lshl_add_u32 v74, v1, 8, v74
    v_bfe_u32 v1, v255, 2, 1
    v_lshl_add_u32 v74, v1, 5, v74
    v_bfe_u32 v1, v255, 0, 2
    v_lshl_add_u32 v74, v1, 2, v74
    v_bfe_u32 v1, v255, 5, 1
    v_lshl_add_u32 v74, v1, 6, v74
    v_bfe_u32 v1, v255, 4, 1
    v_lshl_add_u32 v74, v1, 4, v74
    s_lshr_b32 s65, s62, 2
    s_lshl_b32 s65, s65, 9
    s_and_b32 s66, s62, 1
    s_lshl_b32 s66, s66, 5
    s_add_u32 s65, s65, s66
    s_and_b32 s66, s62, 2
    s_lshl_b32 s66, s66, 1
    s_add_u32 s65, s65, s66
    s_add_u32 s65, s65, 8192
    v_mov_b32 v3, s65
    v_bfe_u32 v1, v255, 1, 1
    v_lshl_add_u32 v3, v1, 8, v3
    v_bfe_u32 v1, v255, 0, 1
    v_lshl_add_u32 v3, v1, 3, v3
    v_bfe_u32 v1, v255, 2, 1
    v_lshl_add_u32 v3, v1, 7, v3
    v_bfe_u32 v1, v255, 5, 1
    v_lshl_add_u32 v3, v1, 6, v3
    v_bfe_u32 v1, v255, 4, 1
    v_lshl_add_u32 v3, v1, 4, v3
    v_and_b32 v4, 8, v255
    v_mov_b32 v2, 2147483632
    v_cmp_eq_u32 vcc, 0, v4
    s_nop 1
    v_cndmask_b32 v75, v2, v3, vcc
    s_lshl_b32 s84, s62, 2
    s_add_u32 s84, s84, 88219648
    v_lshlrev_b32 v1, 8, v255
    v_mov_b32 v2, 2147483632
    s_cmp_eq_u32 s60, 3
    s_cselect_b32 s65, 4, 0
    v_cmp_gt_u32 vcc, s65, v255
    s_nop 1
    v_cndmask_b32 v77, v2, v1, vcc
    v_mov_b32 v76, 0
    buffer_store_dword v76, v77, s[8:11], s84 offen
    v_min_u32 v1, 17, v255
    v_lshlrev_b32 v61, 2, v1
    s_waitcnt vmcnt(0) lgkmcnt(0)
    s_barrier
    s_cmp_lg_u32 s60, 0
    s_cbranch_scc1 L_gb_1
    v_mov_b32 v1, 144
    v_mov_b32 v2, 1
    s_mov_b64 exec, 1
    buffer_atomic_add v2, v1, s[20:23], 0 offen
    s_mov_b64 exec, -1
L_gb_1:
    v_lshrrev_b32 v8, 2, v255
    v_min_u32 v8, 6, v8
    s_cmp_eq_u32 s60, 0
    s_cselect_b32 s66, 0, 6
    v_min_u32 v8, s66, v8
    s_mul_i32 s65, s62, 7
    v_add_u32 v8, s65, v8
    v_lshlrev_b32 v8, 6, v8
    v_and_b32 v9, 3, v255
    v_lshl_add_u32 v8, v9, 2, v8
    s_mul_i32 s68, s62, 401408
    s_mul_i32 s65, s60, 0
    v_mov_b32 v68, v8
    v_mov_b32 v2, 12
    v_bfe_u32 v3, v255, 0, 2
    v_lshl_add_u32 v2, v3, 6, v2
L_wi_2:
    buffer_load_dword v3, v2, s[20:23], 0 offen sc1
    s_waitcnt vmcnt(0)
    v_cmp_gt_u32 vcc, 56, v3
    s_cbranch_vccnz L_retry_3
    v_mov_b32 v3, v68
    v_mov_b32 v1, s65
    v_bfe_u32 v2, v255, 0, 6
    v_lshl_add_u32 v1, v2, 4, v1
    v_add_u32 v2, 4096, v1
    s_mov_b32 s65, 0
    s_add_u32 s66, s65, 0
    s_sub_u32 s67, s66, 7
    s_cmp_ge_u32 s66, 7
    s_cselect_b32 s66, s67, s66
    s_mul_i32 s66, s66, 57344
    s_add_u32 s28, s66, s68
    s_add_u32 s29, s28, 28672
    s_add_u32 s66, s65, 1
    s_sub_u32 s67, s66, 7
    s_cmp_ge_u32 s66, 7
    s_cselect_b32 s66, s67, s66
    s_mul_i32 s66, s66, 57344
    s_add_u32 s30, s66, s68
    s_add_u32 s31, s30, 28672
    s_add_u32 s66, s65, 2
    s_sub_u32 s67, s66, 7
    s_cmp_ge_u32 s66, 7
    s_cselect_b32 s66, s67, s66
    s_mul_i32 s66, s66, 57344
    s_add_u32 s32, s66, s68
    s_add_u32 s33, s32, 28672
    s_add_u32 s66, s65, 3
    s_sub_u32 s67, s66, 7
    s_cmp_ge_u32 s66, 7
    s_cselect_b32 s66, s67, s66
    s_mul_i32 s66, s66, 57344
    s_add_u32 s34, s66, s68
    s_add_u32 s35, s34, 28672
    s_add_u32 s66, s65, 4
    s_sub_u32 s67, s66, 7
    s_cmp_ge_u32 s66, 7
    s_cselect_b32 s66, s67, s66
    s_mul_i32 s66, s66, 57344
    s_add_u32 s36, s66, s68
    s_add_u32 s37, s36, 28672
    s_add_u32 s66, s65, 5
    s_sub_u32 s67, s66, 7
    s_cmp_ge_u32 s66, 7
    s_cselect_b32 s66, s67, s66
    s_mul_i32 s66, s66, 57344
    s_add_u32 s38, s66, s68
    s_add_u32 s39, s38, 28672
    s_add_u32 s66, s65, 6
    s_sub_u32 s67, s66, 7
    s_cmp_ge_u32 s66, 7
    s_cselect_b32 s66, s67, s66
    s_mul_i32 s66, s66, 57344
    s_add_u32 s40, s66, s68
    s_add_u32 s41, s40, 28672
    s_mov_b32 s65, 88276992
    s_cmp_eq_u32 s60, 1
    s_cbranch_scc1 L_lwS1
    s_cmp_eq_u32 s60, 2
    s_cbranch_scc1 L_lwS2
    s_cmp_eq_u32 s60, 3
    s_cbranch_scc1 L_lwS3
L_lwS0:
    buffer_load_dword v68, v3, s[8:11], s65 offen sc1
    s_waitcnt vmcnt(0)
L_lwp_4:
    v_cmp_gt_u32 vcc, 1, v68
    s_nop 0
    s_and_b32 s67, vcc_lo, 0xf
    s_cbranch_scc1 L_lwr_5
    s_add_u32 s66, s28, 0
    buffer_load_dwordx4 a[0:3], v1, s[8:11], s66 offen sc1
    s_add_u32 s66, s28, 1024
    buffer_load_dwordx4 a[56:59], v1, s[8:11], s66 offen sc1
    s_add_u32 s66, s28, 2048
    buffer_load_dwordx4 a[112:115], v1, s[8:11], s66 offen sc1
    s_add_u32 s66, s28, 3072
    buffer_load_dwordx4 a[168:171], v1, s[8:11], s66 offen sc1
    s_add_u32 s66, s29, 0
    buffer_load_dwordx4 a[4:7], v1, s[8:11], s66 offen sc1
    s_add_u32 s66, s29, 1024
    buffer_load_dwordx4 a[60:63], v1, s[8:11], s66 offen sc1
    s_add_u32 s66, s29, 2048
    buffer_load_dwordx4 a[116:119], v1, s[8:11], s66 offen sc1
    s_add_u32 s66, s29, 3072
    buffer_load_dwordx4 a[172:175], v1, s[8:11], s66 offen sc1
    buffer_load_dword v68, v3, s[8:11], s65 offen sc1
    s_add_u32 s66, s30, 0
    buffer_load_dwordx4 a[8:11], v1, s[8:11], s66 offen sc1
    s_add_u32 s66, s30, 1024
    buffer_load_dwordx4 a[64:67], v1, s[8:11], s66 offen sc1
    s_add_u32 s66, s30, 2048
    buffer_load_dwordx4 a[120:123], v1, s[8:11], s66 offen sc1
    s_add_u32 s66, s30, 3072
    buffer_load_dwordx4 a[176:179], v1, s[8:11], s66 offen sc1
    s_add_u32 s66, s31, 0
    buffer_load_dwordx4 a[12:15], v1, s[8:11], s66 offen sc1
    s_add_u32 s66, s31, 1024
    buffer_load_dwordx4 a[68:71], v1, s[8:11], s66 offen sc1
    s_add_u32 s66, s31, 2048
    buffer_load_dwordx4 a[124:127], v1, s[8:11], s66 offen sc1
    s_add_u32 s66, s31, 3072
    buffer_load_dwordx4 a[180:183], v1, s[8:11], s66 offen sc1
    s_waitcnt vmcnt(8)
L_lwp_6:
    v_cmp_gt_u32 vcc, 2, v68
    s_nop 0
    s_and_b32 s67, vcc_lo, 0xf
    s_cbranch_scc1 L_lwr_7
    s_add_u32 s66, s32, 0
    buffer_load_dwordx4 a[16:19], v1, s[8:11], s66 offen sc1
    s_add_u32 s66, s32, 1024
    buffer_load_dwordx4 a[72:75], v1, s[8:11], s66 offen sc1
    s_add_u32 s66, s32, 2048
    buffer_load_dwordx4 a[128:131], v1, s[8:11], s66 offen sc1
    s_add_u32 s66, s32, 3072
    buffer_load_dwordx4 a[184:187], v1, s[8:11], s66 offen sc1
    s_add_u32 s66, s33, 0
    buffer_load_dwordx4 a[20:23], v1, s[8:11], s66 offen sc1
    s_add_u32 s66, s33, 1024
    buffer_load_dwordx4 a[76:79], v1, s[8:11], s66 offen sc1
    s_add_u32 s66, s33, 2048
    buffer_load_dwordx4 a[132:135], v1, s[8:11], s66 offen sc1
    s_add_u32 s66, s33, 3072
    buffer_load_dwordx4 a[188:191], v1, s[8:11], s66 offen sc1
    buffer_load_dword v68, v3, s[8:11], s65 offen sc1
    s_add_u32 s66, s34, 0
    buffer_load_dwordx4 a[24:27], v1, s[8:11], s66 offen sc1
    s_add_u32 s66, s34, 1024
    buffer_load_dwordx4 a[80:83], v1, s[8:11], s66 offen sc1
    s_add_u32 s66, s34, 2048
    buffer_load_dwordx4 a[136:139], v1, s[8:11], s66 offen sc1
    s_add_u32 s66, s34, 3072
    buffer_load_dwordx4 a[192:195], v1, s[8:11], s66 offen sc1
    s_add_u32 s66, s35, 0
    buffer_load_dwordx4 a[28:31], v1, s[8:11], s66 offen sc1
    s_add_u32 s66, s35, 1024
    buffer_load_dwordx4 a[84:87], v1, s[8:11], s66 offen sc1
    s_add_u32 s66, s35, 2048
    buffer_load_dwordx4 a[140:143], v1, s[8:11], s66 offen sc1
    s_add_u32 s66, s35, 3072
    buffer_load_dwordx4 a[196:199], v1, s[8:11], s66 offen sc1
    s_waitcnt vmcnt(8)
L_lwp_8:
    v_cmp_gt_u32 vcc, 3, v68
    s_nop 0
    s_and_b32 s67, vcc_lo, 0xf
    s_cbranch_scc1 L_lwr_9
    s_add_u32 s66, s36, 0
    buffer_load_dwordx4 a[32:35], v1, s[8:11], s66 offen sc1
    s_add_u32 s66, s36, 1024
    buffer_load_dwordx4 a[88:91], v1, s[8:11], s66 offen sc1
    s_add_u32 s66, s36, 2048
    buffer_load_dwordx4 a[144:147], v1, s[8:11], s66 offen sc1
    s_add_u32 s66, s36, 3072
    buffer_load_dwordx4 a[200:203], v1, s[8:11], s66 offen sc1
    s_add_u32 s66, s37, 0
    buffer_load_dwordx4 a[36:39], v1, s[8:11], s66 offen sc1
    s_add_u32 s66, s37, 1024
    buffer_load_dwordx4 a[92:95], v1, s[8:11], s66 offen sc1
    s_add_u32 s66, s37, 2048
    buffer_load_dwordx4 a[148:151], v1, s[8:11], s66 offen sc1
    s_add_u32 s66, s37, 3072
    buffer_load_dwordx4 a[204:207], v1, s[8:11], s66 offen sc1
    buffer_load_dword v68, v3, s[8:11], s65 offen sc1
    s_add_u32 s66, s38, 0
    buffer_load_dwordx4 a[40:43], v1, s[8:11], s66 offen sc1
    s_add_u32 s66, s38, 1024
    buffer_load_dwordx4 a[96:99], v1, s[8:11], s66 offen sc1
    s_add_u32 s66, s38, 2048
    buffer_load_dwordx4 a[152:155], v1, s[8:11], s66 offen sc1
    s_add_u32 s66, s38, 3072
    buffer_load_dwordx4 a[208:211], v1, s[8:11], s66 offen sc1
    s_add_u32 s66, s39, 0
    buffer_load_dwordx4 a[44:47], v1, s[8:11], s66 offen sc1
    s_add_u32 s66, s39, 1024
    buffer_load_dwordx4 a[100:103], v1, s[8:11], s66 offen sc1
    s_add_u32 s66, s39, 2048
    buffer_load_dwordx4 a[156:159], v1, s[8:11], s66 offen sc1
    s_add_u32 s66, s39, 3072
    buffer_load_dwordx4 a[212:215], v1, s[8:11], s66 offen sc1
    s_waitcnt vmcnt(8)
L_lwp_10:
    v_cmp_gt_u32 vcc, 4, v68
    s_nop 0
    s_and_b32 s67, vcc_lo, 0xf
    s_cbranch_scc1 L_lwr_11
    s_add_u32 s66, s40, 0
    buffer_load_dwordx4 a[48:51], v1, s[8:11], s66 offen sc1
    s_add_u32 s66, s40, 1024
    buffer_load_dwordx4 a[104:107], v1, s[8:11], s66 offen sc1
    s_add_u32 s66, s40, 2048
    buffer_load_dwordx4 a[160:163], v1, s[8:11], s66 offen sc1
    s_add_u32 s66, s40, 3072
    buffer_load_dwordx4 a[216:219], v1, s[8:11], s66 offen sc1
    s_add_u32 s66, s41, 0
    buffer_load_dwordx4 a[52:55], v1, s[8:11], s66 offen sc1
    s_add_u32 s66, s41, 1024
    buffer_load_dwordx4 a[108:111], v1, s[8:11], s66 offen sc1
    s_add_u32 s66, s41, 2048
    buffer_load_dwordx4 a[164:167], v1, s[8:11], s66 offen sc1
    s_add_u32 s66, s41, 3072
    buffer_load_dwordx4 a[220:223], v1, s[8:11], s66 offen sc1
    s_branch L_lwSE
L_lwS1:
    buffer_load_dword v68, v3, s[8:11], s65 offen sc1
    s_waitcnt vmcnt(0)
L_lwp_12:
    v_cmp_gt_u32 vcc, 1, v68
    s_nop 0
    s_and_b32 s67, vcc_lo, 0xf0
    s_cbranch_scc1 L_lwr_13
    s_add_u32 s66, s30, 7168
    buffer_load_dwordx4 a[8:11], v1, s[8:11], s66 offen sc1
    s_add_u32 s66, s30, 4096
    buffer_load_dwordx4 a[232:235], v1, s[8:11], s66 offen sc1
    s_add_u32 s66, s31, 7168
    buffer_load_dwordx4 a[12:15], v1, s[8:11], s66 offen sc1
    s_add_u32 s66, s31, 4096
    buffer_load_dwordx4 a[236:239], v1, s[8:11], s66 offen sc1
    s_add_u32 s66, s32, 7168
    buffer_load_dwordx4 a[16:19], v1, s[8:11], s66 offen sc1
    s_add_u32 s66, s32, 4096
    buffer_load_dwordx4 a[240:243], v1, s[8:11], s66 offen sc1
    s_add_u32 s66, s33, 7168
    buffer_load_dwordx4 a[20:23], v1, s[8:11], s66 offen sc1
    s_add_u32 s66, s33, 4096
    buffer_load_dwordx4 a[244:247], v1, s[8:11], s66 offen sc1
L_lwp_14:
    v_cmp_gt_u32 vcc, 1, v68
    s_nop 0
    s_and_b32 s67, vcc_lo, 0xf00
    s_cbranch_scc1 L_lwr_15
    s_add_u32 s66, s32, 8192
    buffer_load_dwordx4 a[72:75], v1, s[8:11], s66 offen sc1
    s_add_u32 s66, s32, 9216
    buffer_load_dwordx4 a[128:131], v1, s[8:11], s66 offen sc1
    s_add_u32 s66, s32, 10240
    buffer_load_dwordx4 a[184:187], v1, s[8:11], s66 offen sc1
    s_add_u32 s66, s33, 8192
    buffer_load_dwordx4 a[76:79], v1, s[8:11], s66 offen sc1
    s_add_u32 s66, s33, 9216
    buffer_load_dwordx4 a[132:135], v1, s[8:11], s66 offen sc1
    s_add_u32 s66, s33, 10240
    buffer_load_dwordx4 a[188:191], v1, s[8:11], s66 offen sc1
    s_add_u32 s66, s34, 8192
    buffer_load_dwordx4 a[80:83], v1, s[8:11], s66 offen sc1
    s_add_u32 s66, s34, 9216
    buffer_load_dwordx4 a[136:139], v1, s[8:11], s66 offen sc1
    buffer_load_dword v68, v3, s[8:11], s65 offen sc1
    s_add_u32 s66, s34, 10240
    buffer_load_dwordx4 a[192:195], v1, s[8:11], s66 offen sc1
    s_add_u32 s66, s35, 8192
    buffer_load_dwordx4 a[84:87], v1, s[8:11], s66 offen sc1
    s_add_u32 s66, s35, 9216
    buffer_load_dwordx4 a[140:143], v1, s[8:11], s66 offen sc1
    s_add_u32 s66, s35, 10240
    buffer_load_dwordx4 a[196:199], v1, s[8:11], s66 offen sc1
L_lwp_16:
    v_cmp_gt_u32 vcc, 1, v68
    s_nop 0
    s_and_b32 s67, vcc_lo, 0xf000
    s_cbranch_scc1 L_lwr_17
    s_add_u32 s66, s34, 13312
    buffer_load_dwordx4 v[104:107], v1, s[8:11], s66 offen sc1
    s_add_u32 s66, s35, 13312
    buffer_load_dwordx4 v[108:111], v1, s[8:11], s66 offen sc1
    s_add_u32 s66, s36, 13312
    buffer_load_dwordx4 v[112:115], v1, s[8:11], s66 offen sc1
    s_add_u32 s66, s37, 13312
    buffer_load_dwordx4 v[116:119], v1, s[8:11], s66 offen sc1
L_lwp_18:
    v_cmp_gt_u32 vcc, 1, v68
    s_nop 0
    s_and_b32 s67, vcc_lo, 0xf0000
    s_cbranch_scc1 L_lwr_19
    s_add_u32 s66, s36, 19456
    buffer_load_dwordx4 v[232:235], v1, s[8:11], s66 offen sc1
    s_add_u32 s66, s37, 19456
    buffer_load_dwordx4 v[236:239], v1, s[8:11], s66 offen sc1
    s_add_u32 s66, s38, 19456
    buffer_load_dwordx4 v[240:243], v1, s[8:11], s66 offen sc1
    s_add_u32 s66, s39, 19456
    buffer_load_dwordx4 v[244:247], v1, s[8:11], s66 offen sc1
L_lwp_20:
    v_cmp_gt_u32 vcc, 1, v68
    s_nop 0
    s_and_b32 s67, vcc_lo, 0xf000000
    s_cbranch_scc1 L_lwr_21
    s_add_u32 s66, s28, 25600
    buffer_load_dwordx4 v[144:147], v1, s[8:11], s66 offen sc1
    s_add_u32 s66, s29, 25600
    buffer_load_dwordx4 v[148:151], v1, s[8:11], s66 offen sc1
    s_add_u32 s66, s40, 25600
    buffer_load_dwordx4 v[192:195], v1, s[8:11], s66 offen sc1
    s_add_u32 s66, s41, 25600
    buffer_load_dwordx4 v[196:199], v1, s[8:11], s66 offen sc1
    s_waitcnt vmcnt(16)
L_lwp_22:
    v_cmp_gt_u32 vcc, 2, v68
    s_nop 0
    s_and_b32 s67, vcc_lo, 0xf0
    s_cbranch_scc1 L_lwr_23
    s_add_u32 s66, s34, 7168
    buffer_load_dwordx4 a[24:27], v1, s[8:11], s66 offen sc1
    s_add_u32 s66, s34, 4096
    buffer_load_dwordx4 a[248:251], v1, s[8:11], s66 offen sc1
    s_add_u32 s66, s35, 7168
    buffer_load_dwordx4 a[28:31], v1, s[8:11], s66 offen sc1
    s_add_u32 s66, s35, 4096
    buffer_load_dwordx4 a[252:255], v1, s[8:11], s66 offen sc1
    s_add_u32 s66, s36, 7168
    buffer_load_dwordx4 a[32:35], v1, s[8:11], s66 offen sc1
    s_add_u32 s66, s36, 4096
    buffer_load_dwordx4 v[120:123], v1, s[8:11], s66 offen sc1
    s_add_u32 s66, s37, 7168
    buffer_load_dwordx4 a[36:39], v1, s[8:11], s66 offen sc1
    s_add_u32 s66, s37, 4096
    buffer_load_dwordx4 v[124:127], v1, s[8:11], s66 offen sc1
L_lwp_24:
    v_cmp_gt_u32 vcc, 2, v68
    s_nop 0
    s_and_b32 s67, vcc_lo, 0xf00
    s_cbranch_scc1 L_lwr_25
    s_add_u32 s66, s36, 8192
    buffer_load_dwordx4 a[88:91], v1, s[8:11], s66 offen sc1
    s_add_u32 s66, s36, 9216
    buffer_load_dwordx4 a[144:147], v1, s[8:11], s66 offen sc1
    s_add_u32 s66, s36, 10240
    buffer_load_dwordx4 a[200:203], v1, s[8:11], s66 offen sc1
    s_add_u32 s66, s37, 8192
    buffer_load_dwordx4 a[92:95], v1, s[8:11], s66 offen sc1
    s_add_u32 s66, s37, 9216
    buffer_load_dwordx4 a[148:151], v1, s[8:11], s66 offen sc1
    s_add_u32 s66, s37, 10240
    buffer_load_dwordx4 a[204:207], v1, s[8:11], s66 offen sc1
    s_add_u32 s66, s38, 8192
    buffer_load_dwordx4 a[96:99], v1, s[8:11], s66 offen sc1
    s_add_u32 s66, s38, 9216
    buffer_load_dwordx4 a[152:155], v1, s[8:11], s66 offen sc1
    buffer_load_dword v68, v3, s[8:11], s65 offen sc1
    s_add_u32 s66, s38, 10240
    buffer_load_dwordx4 a[208:211], v1, s[8:11], s66 offen sc1
    s_add_u32 s66, s39, 8192
    buffer_load_dwordx4 a[100:103], v1, s[8:11], s66 offen sc1
    s_add_u32 s66, s39, 9216
    buffer_load_dwordx4 a[156:159], v1, s[8:11], s66 offen sc1
    s_add_u32 s66, s39, 10240
    buffer_load_dwordx4 a[212:215], v1, s[8:11], s66 offen sc1
L_lwp_26:
    v_cmp_gt_u32 vcc, 2, v68
    s_nop 0
    s_and_b32 s67, vcc_lo, 0xf000
    s_cbranch_scc1 L_lwr_27
    s_add_u32 s66, s38, 13312
    s_mov_b32 m0, 69632
    s_nop 0
    buffer_load_dwordx4 v1, s[8:11], s66 offen sc1 lds
    s_add_u32 s66, s39, 13312
    s_mov_b32 m0, 70656
    s_nop 0
    buffer_load_dwordx4 v1, s[8:11], s66 offen sc1 lds
    s_add_u32 s66, s40, 13312
    s_mov_b32 m0, 71680
    s_nop 0
    buffer_load_dwordx4 v1, s[8:11], s66 offen sc1 lds
    s_add_u32 s66, s41, 13312
    s_mov_b32 m0, 72704
    s_nop 0
    buffer_load_dwordx4 v1, s[8:11], s66 offen sc1 lds
L_lwp_28:
    v_cmp_gt_u32 vcc, 2, v68
    s_nop 0
    s_and_b32 s67, vcc_lo, 0xf0000
    s_cbranch_scc1 L_lwr_29
    s_add_u32 s66, s28, 19456
    buffer_load_dwordx4 v[200:203], v1, s[8:11], s66 offen sc1
    s_add_u32 s66, s29, 19456
    buffer_load_dwordx4 v[204:207], v1, s[8:11], s66 offen sc1
    s_add_u32 s66, s40, 19456
    buffer_load_dwordx4 v[248:251], v1, s[8:11], s66 offen sc1
    s_add_u32 s66, s41, 19456
    buffer_load_dwordx4 v[252:255], v1, s[8:11], s66 offen sc1
L_lwp_30:
    v_cmp_gt_u32 vcc, 2, v68
    s_nop 0
    s_and_b32 s67, vcc_lo, 0xf000000
    s_cbranch_scc1 L_lwr_31
    s_add_u32 s66, s30, 25600
    buffer_load_dwordx4 v[152:155], v1, s[8:11], s66 offen sc1
    s_add_u32 s66, s31, 25600
    buffer_load_dwordx4 v[156:159], v1, s[8:11], s66 offen sc1
    s_add_u32 s66, s32, 25600
    buffer_load_dwordx4 v[160:163], v1, s[8:11], s66 offen sc1
    s_add_u32 s66, s33, 25600
    buffer_load_dwordx4 v[164:167], v1, s[8:11], s66 offen sc1
    s_waitcnt vmcnt(16)
L_lwp_32:
    v_cmp_gt_u32 vcc, 3, v68
    s_nop 0
    s_and_b32 s67, vcc_lo, 0xf0
    s_cbranch_scc1 L_lwr_33
    s_add_u32 s66, s38, 7168
    buffer_load_dwordx4 a[40:43], v1, s[8:11], s66 offen sc1
    s_add_u32 s66, s38, 4096
    buffer_load_dwordx4 v[128:131], v1, s[8:11], s66 offen sc1
    s_add_u32 s66, s39, 7168
    buffer_load_dwordx4 a[44:47], v1, s[8:11], s66 offen sc1
    s_add_u32 s66, s39, 4096
    buffer_load_dwordx4 v[132:135], v1, s[8:11], s66 offen sc1
    s_add_u32 s66, s40, 7168
    buffer_load_dwordx4 a[48:51], v1, s[8:11], s66 offen sc1
    s_add_u32 s66, s40, 4096
    buffer_load_dwordx4 v[136:139], v1, s[8:11], s66 offen sc1
    s_add_u32 s66, s41, 7168
    buffer_load_dwordx4 a[52:55], v1, s[8:11], s66 offen sc1
    s_add_u32 s66, s41, 4096
    buffer_load_dwordx4 v[140:143], v1, s[8:11], s66 offen sc1
L_lwp_34:
    v_cmp_gt_u32 vcc, 3, v68
    s_nop 0
    s_and_b32 s67, vcc_lo, 0xf00
    s_cbranch_scc1 L_lwr_35
    s_add_u32 s66, s28, 8192
    buffer_load_dwordx4 a[56:59], v1, s[8:11], s66 offen sc1
    s_add_u32 s66, s28, 9216
    buffer_load_dwordx4 a[112:115], v1, s[8:11], s66 offen sc1
    s_add_u32 s66, s28, 10240
    buffer_load_dwordx4 a[168:171], v1, s[8:11], s66 offen sc1
    s_add_u32 s66, s29, 8192
    buffer_load_dwordx4 a[60:63], v1, s[8:11], s66 offen sc1
    s_add_u32 s66, s29, 9216
    buffer_load_dwordx4 a[116:119], v1, s[8:11], s66 offen sc1
    s_add_u32 s66, s29, 10240
    buffer_load_dwordx4 a[172:175], v1, s[8:11], s66 offen sc1
    s_add_u32 s66, s40, 8192
    buffer_load_dwordx4 a[104:107], v1, s[8:11], s66 offen sc1
    s_add_u32 s66, s40, 9216
    buffer_load_dwordx4 a[160:163], v1, s[8:11], s66 offen sc1
    buffer_load_dword v68, v3, s[8:11], s65 offen sc1
    s_add_u32 s66, s40, 10240
    buffer_load_dwordx4 a[216:219], v1, s[8:11], s66 offen sc1
    s_add_u32 s66, s41, 8192
    buffer_load_dwordx4 a[108:111], v1, s[8:11], s66 offen sc1
    s_add_u32 s66, s41, 9216
    buffer_load_dwordx4 a[164:167], v1, s[8:11], s66 offen sc1
    s_add_u32 s66, s41, 10240
    buffer_load_dwordx4 a[220:223], v1, s[8:11], s66 offen sc1
L_lwp_36:
    v_cmp_gt_u32 vcc, 3, v68
    s_nop 0
    s_and_b32 s67, vcc_lo, 0xf000
    s_cbranch_scc1 L_lwr_37
    s_add_u32 s66, s28, 13312
    buffer_load_dwordx4 v[80:83], v1, s[8:11], s66 offen sc1
    s_add_u32 s66, s29, 13312
    buffer_load_dwordx4 v[84:87], v1, s[8:11], s66 offen sc1
    s_add_u32 s66, s30, 13312
    buffer_load_dwordx4 v[88:91], v1, s[8:11], s66 offen sc1
    s_add_u32 s66, s31, 13312
    buffer_load_dwordx4 v[92:95], v1, s[8:11], s66 offen sc1
L_lwp_38:
    v_cmp_gt_u32 vcc, 3, v68
    s_nop 0
    s_and_b32 s67, vcc_lo, 0xf0000
    s_cbranch_scc1 L_lwr_39
    s_add_u32 s66, s30, 19456
    buffer_load_dwordx4 v[208:211], v1, s[8:11], s66 offen sc1
    s_add_u32 s66, s31, 19456
    buffer_load_dwordx4 v[212:215], v1, s[8:11], s66 offen sc1
    s_add_u32 s66, s32, 19456
    buffer_load_dwordx4 v[216:219], v1, s[8:11], s66 offen sc1
    s_add_u32 s66, s33, 19456
    buffer_load_dwordx4 v[220:223], v1, s[8:11], s66 offen sc1
L_lwp_40:
    v_cmp_gt_u32 vcc, 3, v68
    s_nop 0
    s_and_b32 s67, vcc_lo, 0xf000000
    s_cbranch_scc1 L_lwr_41
    s_add_u32 s66, s34, 25600
    buffer_load_dwordx4 v[168:171], v1, s[8:11], s66 offen sc1
    s_add_u32 s66, s35, 25600
    buffer_load_dwordx4 v[172:175], v1, s[8:11], s66 offen sc1
    s_add_u32 s66, s36, 25600
    buffer_load_dwordx4 v[176:179], v1, s[8:11], s66 offen sc1
    s_add_u32 s66, s37, 25600
    buffer_load_dwordx4 v[180:183], v1, s[8:11], s66 offen sc1
    s_waitcnt vmcnt(16)
L_lwp_42:
    v_cmp_gt_u32 vcc, 4, v68
    s_nop 0
    s_and_b32 s67, vcc_lo, 0xf0
    s_cbranch_scc1 L_lwr_43
    s_add_u32 s66, s28, 7168
    buffer_load_dwordx4 a[0:3], v1, s[8:11], s66 offen sc1
    s_add_u32 s66, s28, 4096
    buffer_load_dwordx4 a[224:227], v1, s[8:11], s66 offen sc1
    s_add_u32 s66, s29, 7168
    buffer_load_dwordx4 a[4:7], v1, s[8:11], s66 offen sc1
    s_add_u32 s66, s29, 4096
    buffer_load_dwordx4 a[228:231], v1, s[8:11], s66 offen sc1
L_lwp_44:
    v_cmp_gt_u32 vcc, 4, v68
    s_nop 0
    s_and_b32 s67, vcc_lo, 0xf00
    s_cbranch_scc1 L_lwr_45
    s_add_u32 s66, s30, 8192
    buffer_load_dwordx4 a[64:67], v1, s[8:11], s66 offen sc1
    s_add_u32 s66, s30, 9216
    buffer_load_dwordx4 a[120:123], v1, s[8:11], s66 offen sc1
    s_add_u32 s66, s30, 10240
    buffer_load_dwordx4 a[176:179], v1, s[8:11], s66 offen sc1
    s_add_u32 s66, s31, 8192
    buffer_load_dwordx4 a[68:71], v1, s[8:11], s66 offen sc1
    s_add_u32 s66, s31, 9216
    buffer_load_dwordx4 a[124:127], v1, s[8:11], s66 offen sc1
    s_add_u32 s66, s31, 10240
    buffer_load_dwordx4 a[180:183], v1, s[8:11], s66 offen sc1
L_lwp_46:
    v_cmp_gt_u32 vcc, 4, v68
    s_nop 0
    s_and_b32 s67, vcc_lo, 0xf000
    s_cbranch_scc1 L_lwr_47
    s_add_u32 s66, s32, 13312
    buffer_load_dwordx4 v[96:99], v1, s[8:11], s66 offen sc1
    s_add_u32 s66, s33, 13312
    buffer_load_dwordx4 v[100:103], v1, s[8:11], s66 offen sc1
L_lwp_48:
    v_cmp_gt_u32 vcc, 4, v68
    s_nop 0
    s_and_b32 s67, vcc_lo, 0xf0000
    s_cbranch_scc1 L_lwr_49
    s_add_u32 s66, s34, 19456
    buffer_load_dwordx4 v[224:227], v1, s[8:11], s66 offen sc1
    s_add_u32 s66, s35, 19456
    buffer_load_dwordx4 v[228:231], v1, s[8:11], s66 offen sc1
L_lwp_50:
    v_cmp_gt_u32 vcc, 4, v68
    s_nop 0
    s_and_b32 s67, vcc_lo, 0xf000000
    s_cbranch_scc1 L_lwr_51
    s_add_u32 s66, s38, 25600
    buffer_load_dwordx4 v[184:187], v1, s[8:11], s66 offen sc1
    s_add_u32 s66, s39, 25600
    buffer_load_dwordx4 v[188:191], v1, s[8:11], s66 offen sc1
    s_branch L_lwSE
L_lwS2:
    buffer_load_dword v68, v3, s[8:11], s65 offen sc1
    s_waitcnt vmcnt(0)
L_lwp_52:
    v_cmp_gt_u32 vcc, 1, v68
    s_nop 0
    s_and_b32 s67, vcc_lo, 0xf0
    s_cbranch_scc1 L_lwr_53
    s_add_u32 s66, s30, 5120
    buffer_load_dwordx4 v[152:155], v1, s[8:11], s66 offen sc1
    s_add_u32 s66, s31, 5120
    buffer_load_dwordx4 v[156:159], v1, s[8:11], s66 offen sc1
    s_add_u32 s66, s32, 5120
    buffer_load_dwordx4 v[160:163], v1, s[8:11], s66 offen sc1
    s_add_u32 s66, s33, 5120
    buffer_load_dwordx4 v[164:167], v1, s[8:11], s66 offen sc1
L_lwp_54:
    v_cmp_gt_u32 vcc, 1, v68
    s_nop 0
    s_and_b32 s67, vcc_lo, 0xf00
    s_cbranch_scc1 L_lwr_55
    s_add_u32 s66, s32, 11264
    buffer_load_dwordx4 a[240:243], v1, s[8:11], s66 offen sc1
    s_add_u32 s66, s33, 11264
    buffer_load_dwordx4 a[244:247], v1, s[8:11], s66 offen sc1
    s_add_u32 s66, s34, 11264
    buffer_load_dwordx4 a[248:251], v1, s[8:11], s66 offen sc1
    s_add_u32 s66, s35, 11264
    buffer_load_dwordx4 a[252:255], v1, s[8:11], s66 offen sc1
L_lwp_56:
    v_cmp_gt_u32 vcc, 1, v68
    s_nop 0
    s_and_b32 s67, vcc_lo, 0xf000
    s_cbranch_scc1 L_lwr_57
    s_add_u32 s66, s34, 14336
    buffer_load_dwordx4 a[24:27], v1, s[8:11], s66 offen sc1
    s_add_u32 s66, s34, 15360
    buffer_load_dwordx4 a[80:83], v1, s[8:11], s66 offen sc1
    s_add_u32 s66, s35, 14336
    buffer_load_dwordx4 a[28:31], v1, s[8:11], s66 offen sc1
    s_add_u32 s66, s35, 15360
    buffer_load_dwordx4 a[84:87], v1, s[8:11], s66 offen sc1
    s_add_u32 s66, s36, 14336
    buffer_load_dwordx4 a[32:35], v1, s[8:11], s66 offen sc1
    s_add_u32 s66, s36, 15360
    buffer_load_dwordx4 a[88:91], v1, s[8:11], s66 offen sc1
    s_add_u32 s66, s37, 14336
    buffer_load_dwordx4 a[36:39], v1, s[8:11], s66 offen sc1
    s_add_u32 s66, s37, 15360
    buffer_load_dwordx4 a[92:95], v1, s[8:11], s66 offen sc1
L_lwp_58:
    v_cmp_gt_u32 vcc, 1, v68
    s_nop 0
    s_and_b32 s67, vcc_lo, 0xf0000
    s_cbranch_scc1 L_lwr_59
    buffer_load_dword v68, v3, s[8:11], s65 offen sc1
    s_add_u32 s66, s36, 16384
    buffer_load_dwordx4 a[144:147], v1, s[8:11], s66 offen sc1
    s_add_u32 s66, s36, 17408
    buffer_load_dwordx4 a[200:203], v1, s[8:11], s66 offen sc1
    s_add_u32 s66, s37, 16384
    buffer_load_dwordx4 a[148:151], v1, s[8:11], s66 offen sc1
    s_add_u32 s66, s37, 17408
    buffer_load_dwordx4 a[204:207], v1, s[8:11], s66 offen sc1
    s_add_u32 s66, s38, 16384
    buffer_load_dwordx4 a[152:155], v1, s[8:11], s66 offen sc1
    s_add_u32 s66, s38, 17408
    buffer_load_dwordx4 a[208:211], v1, s[8:11], s66 offen sc1
    s_add_u32 s66, s39, 16384
    buffer_load_dwordx4 a[156:159], v1, s[8:11], s66 offen sc1
    s_add_u32 s66, s39, 17408
    buffer_load_dwordx4 a[212:215], v1, s[8:11], s66 offen sc1
L_lwp_60:
    v_cmp_gt_u32 vcc, 1, v68
    s_nop 0
    s_and_b32 s67, vcc_lo, 0xf00000
    s_cbranch_scc1 L_lwr_61
    s_add_u32 s66, s38, 20480
    s_mov_b32 m0, 73728
    s_nop 0
    buffer_load_dwordx4 v1, s[8:11], s66 offen sc1 lds
    s_add_u32 s66, s39, 20480
    s_mov_b32 m0, 74752
    s_nop 0
    buffer_load_dwordx4 v1, s[8:11], s66 offen sc1 lds
    s_add_u32 s66, s40, 20480
    s_mov_b32 m0, 75776
    s_nop 0
    buffer_load_dwordx4 v1, s[8:11], s66 offen sc1 lds
    s_add_u32 s66, s41, 20480
    s_mov_b32 m0, 76800
    s_nop 0
    buffer_load_dwordx4 v1, s[8:11], s66 offen sc1 lds
L_lwp_62:
    v_cmp_gt_u32 vcc, 1, v68
    s_nop 0
    s_and_b32 s67, vcc_lo, 0xf000000
    s_cbranch_scc1 L_lwr_63
    s_add_u32 s66, s28, 26624
    buffer_load_dwordx4 v[200:203], v1, s[8:11], s66 offen sc1
    s_add_u32 s66, s29, 26624
    buffer_load_dwordx4 v[204:207], v1, s[8:11], s66 offen sc1
    s_add_u32 s66, s40, 26624
    buffer_load_dwordx4 v[248:251], v1, s[8:11], s66 offen sc1
    s_add_u32 s66, s41, 26624
    buffer_load_dwordx4 v[252:255], v1, s[8:11], s66 offen sc1
    s_waitcnt vmcnt(16)
L_lwp_64:
    v_cmp_gt_u32 vcc, 2, v68
    s_nop 0
    s_and_b32 s67, vcc_lo, 0xf0
    s_cbranch_scc1 L_lwr_65
    s_add_u32 s66, s34, 5120
    buffer_load_dwordx4 v[168:171], v1, s[8:11], s66 offen sc1
    s_add_u32 s66, s35, 5120
    buffer_load_dwordx4 v[172:175], v1, s[8:11], s66 offen sc1
    s_add_u32 s66, s36, 5120
    buffer_load_dwordx4 v[176:179], v1, s[8:11], s66 offen sc1
    s_add_u32 s66, s37, 5120
    buffer_load_dwordx4 v[180:183], v1, s[8:11], s66 offen sc1
L_lwp_66:
    v_cmp_gt_u32 vcc, 2, v68
    s_nop 0
    s_and_b32 s67, vcc_lo, 0xf00
    s_cbranch_scc1 L_lwr_67
    s_add_u32 s66, s36, 11264
    buffer_load_dwordx4 v[120:123], v1, s[8:11], s66 offen sc1
    s_add_u32 s66, s37, 11264
    buffer_load_dwordx4 v[124:127], v1, s[8:11], s66 offen sc1
    s_add_u32 s66, s38, 11264
    buffer_load_dwordx4 v[128:131], v1, s[8:11], s66 offen sc1
    s_add_u32 s66, s39, 11264
    buffer_load_dwordx4 v[132:135], v1, s[8:11], s66 offen sc1
L_lwp_68:
    v_cmp_gt_u32 vcc, 2, v68
    s_nop 0
    s_and_b32 s67, vcc_lo, 0xf000
    s_cbranch_scc1 L_lwr_69
    s_add_u32 s66, s38, 14336
    buffer_load_dwordx4 a[40:43], v1, s[8:11], s66 offen sc1
    s_add_u32 s66, s38, 15360
    buffer_load_dwordx4 a[96:99], v1, s[8:11], s66 offen sc1
    s_add_u32 s66, s39, 14336
    buffer_load_dwordx4 a[44:47], v1, s[8:11], s66 offen sc1
    s_add_u32 s66, s39, 15360
    buffer_load_dwordx4 a[100:103], v1, s[8:11], s66 offen sc1
    s_add_u32 s66, s40, 14336
    buffer_load_dwordx4 a[48:51], v1, s[8:11], s66 offen sc1
    s_add_u32 s66, s40, 15360
    buffer_load_dwordx4 a[104:107], v1, s[8:11], s66 offen sc1
    s_add_u32 s66, s41, 14336
    buffer_load_dwordx4 a[52:55], v1, s[8:11], s66 offen sc1
    s_add_u32 s66, s41, 15360
    buffer_load_dwordx4 a[108:111], v1, s[8:11], s66 offen sc1
L_lwp_70:
    v_cmp_gt_u32 vcc, 2, v68
    s_nop 0
    s_and_b32 s67, vcc_lo, 0xf0000
    s_cbranch_scc1 L_lwr_71
    buffer_load_dword v68, v3, s[8:11], s65 offen sc1
    s_add_u32 s66, s28, 16384
    buffer_load_dwordx4 a[112:115], v1, s[8:11], s66 offen sc1
    s_add_u32 s66, s28, 17408
    buffer_load_dwordx4 a[168:171], v1, s[8:11], s66 offen sc1
    s_add_u32 s66, s29, 16384
    buffer_load_dwordx4 a[116:119], v1, s[8:11], s66 offen sc1
    s_add_u32 s66, s29, 17408
    buffer_load_dwordx4 a[172:175], v1, s[8:11], s66 offen sc1
    s_add_u32 s66, s40, 16384
    buffer_load_dwordx4 a[160:163], v1, s[8:11], s66 offen sc1
    s_add_u32 s66, s40, 17408
    buffer_load_dwordx4 a[216:219], v1, s[8:11], s66 offen sc1
    s_add_u32 s66, s41, 16384
    buffer_load_dwordx4 a[164:167], v1, s[8:11], s66 offen sc1
    s_add_u32 s66, s41, 17408
    buffer_load_dwordx4 a[220:223], v1, s[8:11], s66 offen sc1
L_lwp_72:
    v_cmp_gt_u32 vcc, 2, v68
    s_nop 0
    s_and_b32 s67, vcc_lo, 0xf00000
    s_cbranch_scc1 L_lwr_73
    s_add_u32 s66, s28, 20480
    buffer_load_dwordx4 v[80:83], v1, s[8:11], s66 offen sc1
    s_add_u32 s66, s29, 20480
    buffer_load_dwordx4 v[84:87], v1, s[8:11], s66 offen sc1
    s_add_u32 s66, s30, 20480
    buffer_load_dwordx4 v[88:91], v1, s[8:11], s66 offen sc1
    s_add_u32 s66, s31, 20480
    buffer_load_dwordx4 v[92:95], v1, s[8:11], s66 offen sc1
L_lwp_74:
    v_cmp_gt_u32 vcc, 2, v68
    s_nop 0
    s_and_b32 s67, vcc_lo, 0xf000000
    s_cbranch_scc1 L_lwr_75
    s_add_u32 s66, s30, 26624
    buffer_load_dwordx4 v[208:211], v1, s[8:11], s66 offen sc1
    s_add_u32 s66, s31, 26624
    buffer_load_dwordx4 v[212:215], v1, s[8:11], s66 offen sc1
    s_add_u32 s66, s32, 26624
    buffer_load_dwordx4 v[216:219], v1, s[8:11], s66 offen sc1
    s_add_u32 s66, s33, 26624
    buffer_load_dwordx4 v[220:223], v1, s[8:11], s66 offen sc1
    s_waitcnt vmcnt(16)
L_lwp_76:
    v_cmp_gt_u32 vcc, 3, v68
    s_nop 0
    s_and_b32 s67, vcc_lo, 0xf0
    s_cbranch_scc1 L_lwr_77
    s_add_u32 s66, s38, 5120
    buffer_load_dwordx4 v[184:187], v1, s[8:11], s66 offen sc1
    s_add_u32 s66, s39, 5120
    buffer_load_dwordx4 v[188:191], v1, s[8:11], s66 offen sc1
    s_add_u32 s66, s40, 5120
    buffer_load_dwordx4 v[192:195], v1, s[8:11], s66 offen sc1
    s_add_u32 s66, s41, 5120
    buffer_load_dwordx4 v[196:199], v1, s[8:11], s66 offen sc1
L_lwp_78:
    v_cmp_gt_u32 vcc, 3, v68
    s_nop 0
    s_and_b32 s67, vcc_lo, 0xf00
    s_cbranch_scc1 L_lwr_79
    s_add_u32 s66, s28, 11264
    buffer_load_dwordx4 a[224:227], v1, s[8:11], s66 offen sc1
    s_add_u32 s66, s29, 11264
    buffer_load_dwordx4 a[228:231], v1, s[8:11], s66 offen sc1
    s_add_u32 s66, s40, 11264
    buffer_load_dwordx4 v[136:139], v1, s[8:11], s66 offen sc1
    s_add_u32 s66, s41, 11264
    buffer_load_dwordx4 v[140:143], v1, s[8:11], s66 offen sc1
L_lwp_80:
    v_cmp_gt_u32 vcc, 3, v68
    s_nop 0
    s_and_b32 s67, vcc_lo, 0xf000
    s_cbranch_scc1 L_lwr_81
    s_add_u32 s66, s28, 14336
    buffer_load_dwordx4 a[0:3], v1, s[8:11], s66 offen sc1
    s_add_u32 s66, s28, 15360
    buffer_load_dwordx4 a[56:59], v1, s[8:11], s66 offen sc1
    s_add_u32 s66, s29, 14336
    buffer_load_dwordx4 a[4:7], v1, s[8:11], s66 offen sc1
    s_add_u32 s66, s29, 15360
    buffer_load_dwordx4 a[60:63], v1, s[8:11], s66 offen sc1
    s_add_u32 s66, s30, 14336
    buffer_load_dwordx4 a[8:11], v1, s[8:11], s66 offen sc1
    s_add_u32 s66, s30, 15360
    buffer_load_dwordx4 a[64:67], v1, s[8:11], s66 offen sc1
    s_add_u32 s66, s31, 14336
    buffer_load_dwordx4 a[12:15], v1, s[8:11], s66 offen sc1
    s_add_u32 s66, s31, 15360
    buffer_load_dwordx4 a[68:71], v1, s[8:11], s66 offen sc1
L_lwp_82:
    v_cmp_gt_u32 vcc, 3, v68
    s_nop 0
    s_and_b32 s67, vcc_lo, 0xf0000
    s_cbranch_scc1 L_lwr_83
    buffer_load_dword v68, v3, s[8:11], s65 offen sc1
    s_add_u32 s66, s30, 16384
    buffer_load_dwordx4 a[120:123], v1, s[8:11], s66 offen sc1
    s_add_u32 s66, s30, 17408
    buffer_load_dwordx4 a[176:179], v1, s[8:11], s66 offen sc1
    s_add_u32 s66, s31, 16384
    buffer_load_dwordx4 a[124:127], v1, s[8:11], s66 offen sc1
    s_add_u32 s66, s31, 17408
    buffer_load_dwordx4 a[180:183], v1, s[8:11], s66 offen sc1
    s_add_u32 s66, s32, 16384
    buffer_load_dwordx4 a[128:131], v1, s[8:11], s66 offen sc1
    s_add_u32 s66, s32, 17408
    buffer_load_dwordx4 a[184:187], v1, s[8:11], s66 offen sc1
    s_add_u32 s66, s33, 16384
    buffer_load_dwordx4 a[132:135], v1, s[8:11], s66 offen sc1
    s_add_u32 s66, s33, 17408
    buffer_load_dwordx4 a[188:191], v1, s[8:11], s66 offen sc1
L_lwp_84:
    v_cmp_gt_u32 vcc, 3, v68
    s_nop 0
    s_and_b32 s67, vcc_lo, 0xf00000
    s_cbranch_scc1 L_lwr_85
    s_add_u32 s66, s32, 20480
    buffer_load_dwordx4 v[96:99], v1, s[8:11], s66 offen sc1
    s_add_u32 s66, s33, 20480
    buffer_load_dwordx4 v[100:103], v1, s[8:11], s66 offen sc1
    s_add_u32 s66, s34, 20480
    buffer_load_dwordx4 v[104:107], v1, s[8:11], s66 offen sc1
    s_add_u32 s66, s35, 20480
    buffer_load_dwordx4 v[108:111], v1, s[8:11], s66 offen sc1
L_lwp_86:
    v_cmp_gt_u32 vcc, 3, v68
    s_nop 0
    s_and_b32 s67, vcc_lo, 0xf000000
    s_cbranch_scc1 L_lwr_87
    s_add_u32 s66, s34, 26624
    buffer_load_dwordx4 v[224:227], v1, s[8:11], s66 offen sc1
    s_add_u32 s66, s35, 26624
    buffer_load_dwordx4 v[228:231], v1, s[8:11], s66 offen sc1
    s_add_u32 s66, s36, 26624
    buffer_load_dwordx4 v[232:235], v1, s[8:11], s66 offen sc1
    s_add_u32 s66, s37, 26624
    buffer_load_dwordx4 v[236:239], v1, s[8:11], s66 offen sc1
    s_waitcnt vmcnt(16)
L_lwp_88:
    v_cmp_gt_u32 vcc, 4, v68
    s_nop 0
    s_and_b32 s67, vcc_lo, 0xf0
    s_cbranch_scc1 L_lwr_89
    s_add_u32 s66, s28, 5120
    buffer_load_dwordx4 v[144:147], v1, s[8:11], s66 offen sc1
    s_add_u32 s66, s29, 5120
    buffer_load_dwordx4 v[148:151], v1, s[8:11], s66 offen sc1
L_lwp_90:
    v_cmp_gt_u32 vcc, 4, v68
    s_nop 0
    s_and_b32 s67, vcc_lo, 0xf00
    s_cbranch_scc1 L_lwr_91
    s_add_u32 s66, s30, 11264
    buffer_load_dwordx4 a[232:235], v1, s[8:11], s66 offen sc1
    s_add_u32 s66, s31, 11264
    buffer_load_dwordx4 a[236:239], v1, s[8:11], s66 offen sc1
L_lwp_92:
    v_cmp_gt_u32 vcc, 4, v68
    s_nop 0
    s_and_b32 s67, vcc_lo, 0xf000
    s_cbranch_scc1 L_lwr_93
    s_add_u32 s66, s32, 14336
    buffer_load_dwordx4 a[16:19], v1, s[8:11], s66 offen sc1
    s_add_u32 s66, s32, 15360
    buffer_load_dwordx4 a[72:75], v1, s[8:11], s66 offen sc1
    s_add_u32 s66, s33, 14336
    buffer_load_dwordx4 a[20:23], v1, s[8:11], s66 offen sc1
    s_add_u32 s66, s33, 15360
    buffer_load_dwordx4 a[76:79], v1, s[8:11], s66 offen sc1
L_lwp_94:
    v_cmp_gt_u32 vcc, 4, v68
    s_nop 0
    s_and_b32 s67, vcc_lo, 0xf0000
    s_cbranch_scc1 L_lwr_95
    s_add_u32 s66, s34, 16384
    buffer_load_dwordx4 a[136:139], v1, s[8:11], s66 offen sc1
    s_add_u32 s66, s34, 17408
    buffer_load_dwordx4 a[192:195], v1, s[8:11], s66 offen sc1
    s_add_u32 s66, s35, 16384
    buffer_load_dwordx4 a[140:143], v1, s[8:11], s66 offen sc1
    s_add_u32 s66, s35, 17408
    buffer_load_dwordx4 a[196:199], v1, s[8:11], s66 offen sc1
L_lwp_96:
    v_cmp_gt_u32 vcc, 4, v68
    s_nop 0
    s_and_b32 s67, vcc_lo, 0xf00000
    s_cbranch_scc1 L_lwr_97
    s_add_u32 s66, s36, 20480
    buffer_load_dwordx4 v[112:115], v1, s[8:11], s66 offen sc1
    s_add_u32 s66, s37, 20480
    buffer_load_dwordx4 v[116:119], v1, s[8:11], s66 offen sc1
L_lwp_98:
    v_cmp_gt_u32 vcc, 4, v68
    s_nop 0
    s_and_b32 s67, vcc_lo, 0xf000000
    s_cbranch_scc1 L_lwr_99
    s_add_u32 s66, s38, 26624
    buffer_load_dwordx4 v[240:243], v1, s[8:11], s66 offen sc1
    s_add_u32 s66, s39, 26624
    buffer_load_dwordx4 v[244:247], v1, s[8:11], s66 offen sc1
    s_branch L_lwSE
L_lwS3:
    buffer_load_dword v68, v3, s[8:11], s65 offen sc1
    s_waitcnt vmcnt(0)
L_lwp_100:
    v_cmp_gt_u32 vcc, 1, v68
    s_nop 0
    s_and_b32 s67, vcc_lo, 0xf0
    s_cbranch_scc1 L_lwr_101
    s_add_u32 s66, s30, 6144
    buffer_load_dwordx4 v[208:211], v1, s[8:11], s66 offen sc1
    s_add_u32 s66, s31, 6144
    buffer_load_dwordx4 v[212:215], v1, s[8:11], s66 offen sc1
    s_add_u32 s66, s32, 6144
    buffer_load_dwordx4 v[216:219], v1, s[8:11], s66 offen sc1
    s_add_u32 s66, s33, 6144
    buffer_load_dwordx4 v[220:223], v1, s[8:11], s66 offen sc1
L_lwp_102:
    v_cmp_gt_u32 vcc, 1, v68
    s_nop 0
    s_and_b32 s67, vcc_lo, 0xf000
    s_cbranch_scc1 L_lwr_103
    s_add_u32 s66, s34, 12288
    buffer_load_dwordx4 v[168:171], v1, s[8:11], s66 offen sc1
    s_add_u32 s66, s35, 12288
    buffer_load_dwordx4 v[172:175], v1, s[8:11], s66 offen sc1
    s_add_u32 s66, s36, 12288
    buffer_load_dwordx4 v[176:179], v1, s[8:11], s66 offen sc1
    s_add_u32 s66, s37, 12288
    buffer_load_dwordx4 v[180:183], v1, s[8:11], s66 offen sc1
L_lwp_104:
    v_cmp_gt_u32 vcc, 1, v68
    s_nop 0
    s_and_b32 s67, vcc_lo, 0xf0000
    s_cbranch_scc1 L_lwr_105
    s_add_u32 s66, s36, 18432
    buffer_load_dwordx4 v[120:123], v1, s[8:11], s66 offen sc1
    s_add_u32 s66, s37, 18432
    buffer_load_dwordx4 v[124:127], v1, s[8:11], s66 offen sc1
    s_add_u32 s66, s38, 18432
    buffer_load_dwordx4 v[128:131], v1, s[8:11], s66 offen sc1
    s_add_u32 s66, s39, 18432
    buffer_load_dwordx4 v[132:135], v1, s[8:11], s66 offen sc1
L_lwp_106:
    v_cmp_gt_u32 vcc, 1, v68
    s_nop 0
    s_and_b32 s67, vcc_lo, 0xf00000
    s_cbranch_scc1 L_lwr_107
    s_add_u32 s66, s38, 21504
    buffer_load_dwordx4 a[40:43], v1, s[8:11], s66 offen sc1
    s_add_u32 s66, s38, 22528
    buffer_load_dwordx4 a[96:99], v1, s[8:11], s66 offen sc1
    s_add_u32 s66, s38, 23552
    buffer_load_dwordx4 a[152:155], v1, s[8:11], s66 offen sc1
    s_add_u32 s66, s39, 21504
    buffer_load_dwordx4 a[44:47], v1, s[8:11], s66 offen sc1
    buffer_load_dword v68, v3, s[8:11], s65 offen sc1
    s_add_u32 s66, s39, 22528
    buffer_load_dwordx4 a[100:103], v1, s[8:11], s66 offen sc1
    s_add_u32 s66, s39, 23552
    buffer_load_dwordx4 a[156:159], v1, s[8:11], s66 offen sc1
    s_add_u32 s66, s40, 21504
    buffer_load_dwordx4 a[48:51], v1, s[8:11], s66 offen sc1
    s_add_u32 s66, s40, 22528
    buffer_load_dwordx4 a[104:107], v1, s[8:11], s66 offen sc1
    s_add_u32 s66, s40, 23552
    buffer_load_dwordx4 a[160:163], v1, s[8:11], s66 offen sc1
    s_add_u32 s66, s41, 21504
    buffer_load_dwordx4 a[52:55], v1, s[8:11], s66 offen sc1
    s_add_u32 s66, s41, 22528
    buffer_load_dwordx4 a[108:111], v1, s[8:11], s66 offen sc1
    s_add_u32 s66, s41, 23552
    buffer_load_dwordx4 a[164:167], v1, s[8:11], s66 offen sc1
L_lwp_108:
    v_cmp_gt_u32 vcc, 1, v68
    s_nop 0
    s_and_b32 s67, vcc_lo, 0xf000000
    s_cbranch_scc1 L_lwr_109
    s_add_u32 s66, s28, 24576
    buffer_load_dwordx4 a[168:171], v1, s[8:11], s66 offen sc1
    s_add_u32 s66, s28, 27648
    buffer_load_dwordx4 v[80:83], v1, s[8:11], s66 offen sc1
    s_add_u32 s66, s29, 24576
    buffer_load_dwordx4 a[172:175], v1, s[8:11], s66 offen sc1
    s_add_u32 s66, s29, 27648
    buffer_load_dwordx4 v[84:87], v1, s[8:11], s66 offen sc1
    s_add_u32 s66, s40, 24576
    buffer_load_dwordx4 a[216:219], v1, s[8:11], s66 offen sc1
    s_add_u32 s66, s40, 27648
    s_mov_b32 m0, 79872
    s_nop 0
    buffer_load_dwordx4 v1, s[8:11], s66 offen sc1 lds
    s_add_u32 s66, s41, 24576
    buffer_load_dwordx4 a[220:223], v1, s[8:11], s66 offen sc1
    s_add_u32 s66, s41, 27648
    s_mov_b32 m0, 80896
    s_nop 0
    buffer_load_dwordx4 v1, s[8:11], s66 offen sc1 lds
    s_waitcnt vmcnt(16)
L_lwp_110:
    v_cmp_gt_u32 vcc, 2, v68
    s_nop 0
    s_and_b32 s67, vcc_lo, 0xf0
    s_cbranch_scc1 L_lwr_111
    s_add_u32 s66, s34, 6144
    buffer_load_dwordx4 v[224:227], v1, s[8:11], s66 offen sc1
    s_add_u32 s66, s35, 6144
    buffer_load_dwordx4 v[228:231], v1, s[8:11], s66 offen sc1
    s_add_u32 s66, s36, 6144
    buffer_load_dwordx4 v[232:235], v1, s[8:11], s66 offen sc1
    s_add_u32 s66, s37, 6144
    buffer_load_dwordx4 v[236:239], v1, s[8:11], s66 offen sc1
L_lwp_112:
    v_cmp_gt_u32 vcc, 2, v68
    s_nop 0
    s_and_b32 s67, vcc_lo, 0xf000
    s_cbranch_scc1 L_lwr_113
    s_add_u32 s66, s38, 12288
    buffer_load_dwordx4 v[184:187], v1, s[8:11], s66 offen sc1
    s_add_u32 s66, s39, 12288
    buffer_load_dwordx4 v[188:191], v1, s[8:11], s66 offen sc1
    s_add_u32 s66, s40, 12288
    buffer_load_dwordx4 v[192:195], v1, s[8:11], s66 offen sc1
    s_add_u32 s66, s41, 12288
    buffer_load_dwordx4 v[196:199], v1, s[8:11], s66 offen sc1
L_lwp_114:
    v_cmp_gt_u32 vcc, 2, v68
    s_nop 0
    s_and_b32 s67, vcc_lo, 0xf0000
    s_cbranch_scc1 L_lwr_115
    s_add_u32 s66, s28, 18432
    buffer_load_dwordx4 a[224:227], v1, s[8:11], s66 offen sc1
    s_add_u32 s66, s29, 18432
    buffer_load_dwordx4 a[228:231], v1, s[8:11], s66 offen sc1
    s_add_u32 s66, s40, 18432
    buffer_load_dwordx4 v[136:139], v1, s[8:11], s66 offen sc1
    s_add_u32 s66, s41, 18432
    buffer_load_dwordx4 v[140:143], v1, s[8:11], s66 offen sc1
L_lwp_116:
    v_cmp_gt_u32 vcc, 2, v68
    s_nop 0
    s_and_b32 s67, vcc_lo, 0xf00000
    s_cbranch_scc1 L_lwr_117
    s_add_u32 s66, s28, 21504
    buffer_load_dwordx4 a[0:3], v1, s[8:11], s66 offen sc1
    s_add_u32 s66, s28, 22528
    buffer_load_dwordx4 a[56:59], v1, s[8:11], s66 offen sc1
    s_add_u32 s66, s28, 23552
    buffer_load_dwordx4 a[112:115], v1, s[8:11], s66 offen sc1
    s_add_u32 s66, s29, 21504
    buffer_load_dwordx4 a[4:7], v1, s[8:11], s66 offen sc1
    buffer_load_dword v68, v3, s[8:11], s65 offen sc1
    s_add_u32 s66, s29, 22528
    buffer_load_dwordx4 a[60:63], v1, s[8:11], s66 offen sc1
    s_add_u32 s66, s29, 23552
    buffer_load_dwordx4 a[116:119], v1, s[8:11], s66 offen sc1
    s_add_u32 s66, s30, 21504
    buffer_load_dwordx4 a[8:11], v1, s[8:11], s66 offen sc1
    s_add_u32 s66, s30, 22528
    buffer_load_dwordx4 a[64:67], v1, s[8:11], s66 offen sc1
    s_add_u32 s66, s30, 23552
    buffer_load_dwordx4 a[120:123], v1, s[8:11], s66 offen sc1
    s_add_u32 s66, s31, 21504
    buffer_load_dwordx4 a[12:15], v1, s[8:11], s66 offen sc1
    s_add_u32 s66, s31, 22528
    buffer_load_dwordx4 a[68:71], v1, s[8:11], s66 offen sc1
    s_add_u32 s66, s31, 23552
    buffer_load_dwordx4 a[124:127], v1, s[8:11], s66 offen sc1
L_lwp_118:
    v_cmp_gt_u32 vcc, 2, v68
    s_nop 0
    s_and_b32 s67, vcc_lo, 0xf000000
    s_cbranch_scc1 L_lwr_119
    s_add_u32 s66, s30, 24576
    buffer_load_dwordx4 a[176:179], v1, s[8:11], s66 offen sc1
    s_add_u32 s66, s30, 27648
    buffer_load_dwordx4 v[88:91], v1, s[8:11], s66 offen sc1
    s_add_u32 s66, s31, 24576
    buffer_load_dwordx4 a[180:183], v1, s[8:11], s66 offen sc1
    s_add_u32 s66, s31, 27648
    buffer_load_dwordx4 v[92:95], v1, s[8:11], s66 offen sc1
    s_add_u32 s66, s32, 24576
    buffer_load_dwordx4 a[184:187], v1, s[8:11], s66 offen sc1
    s_add_u32 s66, s32, 27648
    buffer_load_dwordx4 v[96:99], v1, s[8:11], s66 offen sc1
    s_add_u32 s66, s33, 24576
    buffer_load_dwordx4 a[188:191], v1, s[8:11], s66 offen sc1
    s_add_u32 s66, s33, 27648
    buffer_load_dwordx4 v[100:103], v1, s[8:11], s66 offen sc1
    s_waitcnt vmcnt(16)
L_lwp_120:
    v_cmp_gt_u32 vcc, 3, v68
    s_nop 0
    s_and_b32 s67, vcc_lo, 0xf0
    s_cbranch_scc1 L_lwr_121
    s_add_u32 s66, s38, 6144
    buffer_load_dwordx4 v[240:243], v1, s[8:11], s66 offen sc1
    s_add_u32 s66, s39, 6144
    buffer_load_dwordx4 v[244:247], v1, s[8:11], s66 offen sc1
    s_add_u32 s66, s40, 6144
    buffer_load_dwordx4 v[248:251], v1, s[8:11], s66 offen sc1
    s_add_u32 s66, s41, 6144
    buffer_load_dwordx4 v[252:255], v1, s[8:11], s66 offen sc1
L_lwp_122:
    v_cmp_gt_u32 vcc, 3, v68
    s_nop 0
    s_and_b32 s67, vcc_lo, 0xf000
    s_cbranch_scc1 L_lwr_123
    s_add_u32 s66, s28, 12288
    buffer_load_dwordx4 v[144:147], v1, s[8:11], s66 offen sc1
    s_add_u32 s66, s29, 12288
    buffer_load_dwordx4 v[148:151], v1, s[8:11], s66 offen sc1
    s_add_u32 s66, s30, 12288
    buffer_load_dwordx4 v[152:155], v1, s[8:11], s66 offen sc1
    s_add_u32 s66, s31, 12288
    buffer_load_dwordx4 v[156:159], v1, s[8:11], s66 offen sc1
L_lwp_124:
    v_cmp_gt_u32 vcc, 3, v68
    s_nop 0
    s_and_b32 s67, vcc_lo, 0xf0000
    s_cbranch_scc1 L_lwr_125
    s_add_u32 s66, s30, 18432
    buffer_load_dwordx4 a[232:235], v1, s[8:11], s66 offen sc1
    s_add_u32 s66, s31, 18432
    buffer_load_dwordx4 a[236:239], v1, s[8:11], s66 offen sc1
    s_add_u32 s66, s32, 18432
    buffer_load_dwordx4 a[240:243], v1, s[8:11], s66 offen sc1
    s_add_u32 s66, s33, 18432
    buffer_load_dwordx4 a[244:247], v1, s[8:11], s66 offen sc1
L_lwp_126:
    v_cmp_gt_u32 vcc, 3, v68
    s_nop 0
    s_and_b32 s67, vcc_lo, 0xf00000
    s_cbranch_scc1 L_lwr_127
    s_add_u32 s66, s32, 21504
    buffer_load_dwordx4 a[16:19], v1, s[8:11], s66 offen sc1
    s_add_u32 s66, s32, 22528
    buffer_load_dwordx4 a[72:75], v1, s[8:11], s66 offen sc1
    s_add_u32 s66, s32, 23552
    buffer_load_dwordx4 a[128:131], v1, s[8:11], s66 offen sc1
    s_add_u32 s66, s33, 21504
    buffer_load_dwordx4 a[20:23], v1, s[8:11], s66 offen sc1
    buffer_load_dword v68, v3, s[8:11], s65 offen sc1
    s_add_u32 s66, s33, 22528
    buffer_load_dwordx4 a[76:79], v1, s[8:11], s66 offen sc1
    s_add_u32 s66, s33, 23552
    buffer_load_dwordx4 a[132:135], v1, s[8:11], s66 offen sc1
    s_add_u32 s66, s34, 21504
    buffer_load_dwordx4 a[24:27], v1, s[8:11], s66 offen sc1
    s_add_u32 s66, s34, 22528
    buffer_load_dwordx4 a[80:83], v1, s[8:11], s66 offen sc1
    s_add_u32 s66, s34, 23552
    buffer_load_dwordx4 a[136:139], v1, s[8:11], s66 offen sc1
    s_add_u32 s66, s35, 21504
    buffer_load_dwordx4 a[28:31], v1, s[8:11], s66 offen sc1
    s_add_u32 s66, s35, 22528
    buffer_load_dwordx4 a[84:87], v1, s[8:11], s66 offen sc1
    s_add_u32 s66, s35, 23552
    buffer_load_dwordx4 a[140:143], v1, s[8:11], s66 offen sc1
L_lwp_128:
    v_cmp_gt_u32 vcc, 3, v68
    s_nop 0
    s_and_b32 s67, vcc_lo, 0xf000000
    s_cbranch_scc1 L_lwr_129
    s_add_u32 s66, s34, 24576
    buffer_load_dwordx4 a[192:195], v1, s[8:11], s66 offen sc1
    s_add_u32 s66, s34, 27648
    buffer_load_dwordx4 v[104:107], v1, s[8:11], s66 offen sc1
    s_add_u32 s66, s35, 24576
    buffer_load_dwordx4 a[196:199], v1, s[8:11], s66 offen sc1
    s_add_u32 s66, s35, 27648
    buffer_load_dwordx4 v[108:111], v1, s[8:11], s66 offen sc1
    s_add_u32 s66, s36, 24576
    buffer_load_dwordx4 a[200:203], v1, s[8:11], s66 offen sc1
    s_add_u32 s66, s36, 27648
    buffer_load_dwordx4 v[112:115], v1, s[8:11], s66 offen sc1
    s_add_u32 s66, s37, 24576
    buffer_load_dwordx4 a[204:207], v1, s[8:11], s66 offen sc1
    s_add_u32 s66, s37, 27648
    buffer_load_dwordx4 v[116:119], v1, s[8:11], s66 offen sc1
    s_waitcnt vmcnt(16)
L_lwp_130:
    v_cmp_gt_u32 vcc, 4, v68
    s_nop 0
    s_and_b32 s67, vcc_lo, 0xf0
    s_cbranch_scc1 L_lwr_131
    s_add_u32 s66, s28, 6144
    buffer_load_dwordx4 v[200:203], v1, s[8:11], s66 offen sc1
    s_add_u32 s66, s29, 6144
    buffer_load_dwordx4 v[204:207], v1, s[8:11], s66 offen sc1
L_lwp_132:
    v_cmp_gt_u32 vcc, 4, v68
    s_nop 0
    s_and_b32 s67, vcc_lo, 0xf000
    s_cbranch_scc1 L_lwr_133
    s_add_u32 s66, s32, 12288
    buffer_load_dwordx4 v[160:163], v1, s[8:11], s66 offen sc1
    s_add_u32 s66, s33, 12288
    buffer_load_dwordx4 v[164:167], v1, s[8:11], s66 offen sc1
L_lwp_134:
    v_cmp_gt_u32 vcc, 4, v68
    s_nop 0
    s_and_b32 s67, vcc_lo, 0xf0000
    s_cbranch_scc1 L_lwr_135
    s_add_u32 s66, s34, 18432
    buffer_load_dwordx4 a[248:251], v1, s[8:11], s66 offen sc1
    s_add_u32 s66, s35, 18432
    buffer_load_dwordx4 a[252:255], v1, s[8:11], s66 offen sc1
L_lwp_136:
    v_cmp_gt_u32 vcc, 4, v68
    s_nop 0
    s_and_b32 s67, vcc_lo, 0xf00000
    s_cbranch_scc1 L_lwr_137
    s_add_u32 s66, s36, 21504
    buffer_load_dwordx4 a[32:35], v1, s[8:11], s66 offen sc1
    s_add_u32 s66, s36, 22528
    buffer_load_dwordx4 a[88:91], v1, s[8:11], s66 offen sc1
    s_add_u32 s66, s36, 23552
    buffer_load_dwordx4 a[144:147], v1, s[8:11], s66 offen sc1
    s_add_u32 s66, s37, 21504
    buffer_load_dwordx4 a[36:39], v1, s[8:11], s66 offen sc1
    s_add_u32 s66, s37, 22528
    buffer_load_dwordx4 a[92:95], v1, s[8:11], s66 offen sc1
    s_add_u32 s66, s37, 23552
    buffer_load_dwordx4 a[148:151], v1, s[8:11], s66 offen sc1
L_lwp_138:
    v_cmp_gt_u32 vcc, 4, v68
    s_nop 0
    s_and_b32 s67, vcc_lo, 0xf000000
    s_cbranch_scc1 L_lwr_139
    s_add_u32 s66, s38, 24576
    buffer_load_dwordx4 a[208:211], v1, s[8:11], s66 offen sc1
    s_add_u32 s66, s38, 27648
    s_mov_b32 m0, 77824
    s_nop 0
    buffer_load_dwordx4 v1, s[8:11], s66 offen sc1 lds
    s_add_u32 s66, s39, 24576
    buffer_load_dwordx4 a[212:215], v1, s[8:11], s66 offen sc1
    s_add_u32 s66, s39, 27648
    s_mov_b32 m0, 78848
    s_nop 0
    buffer_load_dwordx4 v1, s[8:11], s66 offen sc1 lds
L_lwSE:
    v_mov_b32 v2, 144
L_gw_140:
    buffer_load_dword v69, v2, s[20:23], 0 offen sc1
    s_waitcnt vmcnt(0)
    v_cmp_gt_u32 vcc, 32, v69
    s_cbranch_vccnz L_retry_141
    s_waitcnt vmcnt(0)
    s_mov_b32 s63, 0
    s_mov_b32 s71, 98566144
    s_mov_b32 s74, 90177536
    s_cmp_eq_u32 s60, 1
    s_cbranch_scc1 L_score_loop1
    s_cmp_eq_u32 s60, 2
    s_cbranch_scc1 L_score_loop2
    s_cmp_eq_u32 s60, 3
    s_cbranch_scc1 L_score_loop3
    v_mov_b32 v62, 0x5f800000
    v_and_b32 v1, 64, v73
    v_cmp_eq_u32 vcc, 0, v1
    s_nop 1
    v_cndmask_b32 v64, 0, 1.0, vcc
    v_cndmask_b32 v65, 1.0, 0, vcc
L_score_loop0:
    s_add_u32 s81, s74, 0
    buffer_load_dwordx4 v[120:123], v73, s[8:11], s81 offen offset:0 sc1
    v_mov_b32 v4, 0
    buffer_load_dwordx4 v[124:127], v73, s[8:11], s81 offen offset:1024 sc1
    v_mov_b32 v5, 0
    buffer_load_dwordx4 v[128:131], v73, s[8:11], s81 offen offset:2048 sc1
    v_mov_b32 v6, 0
    buffer_load_dwordx4 v[132:135], v73, s[8:11], s81 offen offset:3072 sc1
    v_mov_b32 v7, 0
    s_add_u32 s81, s74, 4096
    buffer_load_dwordx4 v[136:139], v73, s[8:11], s81 offen offset:0 sc1
    v_mov_b32 v8, 0
    buffer_load_dwordx4 v[140:143], v73, s[8:11], s81 offen offset:1024 sc1
    v_mov_b32 v9, 0
    buffer_load_dwordx4 v[144:147], v73, s[8:11], s81 offen offset:2048 sc1
    v_mov_b32 v10, 0
    buffer_load_dwordx4 v[148:151], v73, s[8:11], s81 offen offset:3072 sc1
    v_mov_b32 v11, 0
    s_add_u32 s81, s74, 8192
    buffer_load_dwordx4 v[152:155], v73, s[8:11], s81 offen offset:0 sc1
    v_mov_b32 v12, 0
    buffer_load_dwordx4 v[156:159], v73, s[8:11], s81 offen offset:1024 sc1
    v_mov_b32 v13, 0
    buffer_load_dwordx4 v[160:163], v73, s[8:11], s81 offen offset:2048 sc1
    v_mov_b32 v14, 0
    buffer_load_dwordx4 v[164:167], v73, s[8:11], s81 offen offset:3072 sc1
    v_mov_b32 v15, 0
    s_add_u32 s81, s74, 12288
    buffer_load_dwordx4 v[168:171], v73, s[8:11], s81 offen offset:0 sc1
    v_mov_b32 v16, 0
    buffer_load_dwordx4 v[172:175], v73, s[8:11], s81 offen offset:1024 sc1
    v_mov_b32 v17, 0
    buffer_load_dwordx4 v[176:179], v73, s[8:11], s81 offen offset:2048 sc1
    v_mov_b32 v18, 0
    buffer_load_dwordx4 v[180:183], v73, s[8:11], s81 offen offset:3072 sc1
    v_mov_b32 v19, 0
    s_add_u32 s81, s74, 16384
    buffer_load_dwordx4 v[184:187], v73, s[8:11], s81 offen offset:0 sc1
    v_mov_b32 v80, 0
    buffer_load_dwordx4 v[188:191], v73, s[8:11], s81 offen offset:1024 sc1
    v_mov_b32 v81, 0
    buffer_load_dwordx4 v[192:195], v73, s[8:11], s81 offen offset:2048 sc1
    v_mov_b32 v82, 0
    buffer_load_dwordx4 v[196:199], v73, s[8:11], s81 offen offset:3072 sc1
    v_mov_b32 v83, 0
    s_add_u32 s81, s74, 20480
    buffer_load_dwordx4 v[200:203], v73, s[8:11], s81 offen offset:0 sc1
    v_mov_b32 v84, 0
    buffer_load_dwordx4 v[204:207], v73, s[8:11], s81 offen offset:1024 sc1
    v_mov_b32 v85, 0
    buffer_load_dwordx4 v[208:211], v73, s[8:11], s81 offen offset:2048 sc1
    v_mov_b32 v86, 0
    buffer_load_dwordx4 v[212:215], v73, s[8:11], s81 offen offset:3072 sc1
    v_mov_b32 v87, 0
    s_add_u32 s81, s74, 24576
    buffer_load_dwordx4 v[216:219], v73, s[8:11], s81 offen offset:0 sc1
    v_mov_b32 v88, 0
    buffer_load_dwordx4 v[220:223], v73, s[8:11], s81 offen offset:1024 sc1
    v_mov_b32 v89, 0
    buffer_load_dwordx4 v[224:227], v73, s[8:11], s81 offen offset:2048 sc1
    v_mov_b32 v90, 0
    buffer_load_dwordx4 v[228:231], v73, s[8:11], s81 offen offset:3072 sc1
    v_mov_b32 v91, 0
    s_add_u32 s74, s74, 32768
    s_add_u32 s72, s71, 8192
    s_add_u32 s86, s71, 4096
    s_add_u32 s85, s63, 1
    s_barrier
    s_barrier
    s_barrier
    buffer_load_dwordx4 v[44:47], v73, s[8:11], s71 offen offset:3072 sc1
    buffer_load_dwordx4 v[48:51], v73, s[8:11], s86 offen offset:0 sc1
    buffer_load_dwordx4 v[52:55], v73, s[8:11], s86 offen offset:1024 sc1
    buffer_load_dwordx4 v[56:59], v73, s[8:11], s86 offen offset:2048 sc1
    s_barrier
    s_nop 7
    s_mov_b32 m0, 0
    s_nop 0
    buffer_load_dwordx4 v73, s[8:11], s71 offen offset:3072 sc1 lds
    s_mov_b32 m0, 4096
    s_nop 0
    buffer_load_dwordx4 v73, s[8:11], s86 offen offset:0 sc1 lds
    buffer_load_dwordx4 v73, s[8:11], s86 offen offset:1024 sc1 lds
    buffer_load_dwordx4 v73, s[8:11], s86 offen offset:2048 sc1 lds
    buffer_load_dwordx4 v[32:35], v73, s[8:11], s71 offen offset:0 sc1
    buffer_load_dwordx4 v[36:39], v73, s[8:11], s71 offen offset:1024 sc1
    buffer_load_dwordx4 v[40:43], v73, s[8:11], s71 offen offset:2048 sc1
    s_mov_b32 m0, 0
    s_nop 0
    buffer_load_dwordx4 v73, s[8:11], s71 offen offset:0 sc1 lds
    buffer_load_dwordx4 v73, s[8:11], s71 offen offset:1024 sc1 lds
    buffer_load_dwordx4 v73, s[8:11], s71 offen offset:2048 sc1 lds
L_s0_x:
    s_waitcnt vmcnt(13)
    v_smfmac_f32_16x16x64_bf16 v[4:7], v[44:47], a[24:31], v60
    v_max3_u32 v68, v44, v45, v46
    v_smfmac_f32_16x16x64_bf16 v[8:11], v[44:47], a[80:87], v60
    v_max_u32 v68, v68, v47
    v_smfmac_f32_16x16x64_bf16 v[12:15], v[44:47], a[136:143], v60
    s_waitcnt vmcnt(12)
    v_max3_u32 v68, v68, v48, v49
    v_smfmac_f32_16x16x64_bf16 v[16:19], v[44:47], a[192:199], v60
    v_max3_u32 v68, v68, v50, v51
    s_waitcnt vmcnt(12)
    v_smfmac_f32_16x16x64_bf16 v[4:7], v[48:51], a[32:39], v60
    s_waitcnt vmcnt(11)
    v_max3_u32 v68, v68, v52, v53
    v_smfmac_f32_16x16x64_bf16 v[8:11], v[48:51], a[88:95], v60
    v_max3_u32 v68, v68, v54, v55
    v_smfmac_f32_16x16x64_bf16 v[12:15], v[48:51], a[144:151], v60
    s_waitcnt vmcnt(10)
    v_max3_u32 v68, v68, v56, v57
    v_smfmac_f32_16x16x64_bf16 v[16:19], v[48:51], a[200:207], v60
    v_max3_u32 v68, v68, v58, v59
    s_waitcnt vmcnt(11)
    v_smfmac_f32_16x16x64_bf16 v[4:7], v[52:55], a[40:47], v60
    v_cmp_eq_u32 vcc, -1, v68
    s_cbranch_vccnz L_retry_142
    v_smfmac_f32_16x16x64_bf16 v[8:11], v[52:55], a[96:103], v60
    v_smfmac_f32_16x16x64_bf16 v[12:15], v[52:55], a[152:159], v60
    v_smfmac_f32_16x16x64_bf16 v[16:19], v[52:55], a[208:215], v60
    s_waitcnt vmcnt(10)
    v_smfmac_f32_16x16x64_bf16 v[4:7], v[56:59], a[48:55], v60
    v_smfmac_f32_16x16x64_bf16 v[8:11], v[56:59], a[104:111], v60
    v_smfmac_f32_16x16x64_bf16 v[12:15], v[56:59], a[160:167], v60
    v_smfmac_f32_16x16x64_bf16 v[16:19], v[56:59], a[216:223], v60
    s_waitcnt vmcnt(6)
    s_barrier
    s_waitcnt vmcnt(3)
    v_max3_u32 v68, v32, v33, v34
    v_max_u32 v68, v68, v35
    v_max3_u32 v68, v68, v36, v37
    v_max3_u32 v68, v68, v38, v39
    v_max3_u32 v68, v68, v40, v41
    v_max3_u32 v68, v68, v42, v43
    v_cmp_eq_u32 vcc, -1, v68
    s_cbranch_vccnz L_s0_y
L_s0_z:
    v_smfmac_f32_16x16x64_bf16 v[4:7], v[32:35], a[0:7], v60
    v_smfmac_f32_16x16x64_bf16 v[4:7], v[36:39], a[8:15], v60
    v_smfmac_f32_16x16x64_bf16 v[4:7], v[40:43], a[16:23], v60
    v_smfmac_f32_16x16x64_bf16 v[8:11], v[32:35], a[56:63], v60
    v_smfmac_f32_16x16x64_bf16 v[8:11], v[36:39], a[64:71], v60
    v_add_f32 v4, v4, v6
    v_smfmac_f32_16x16x64_bf16 v[8:11], v[40:43], a[72:79], v60
    v_add_f32 v5, v5, v7
    v_smfmac_f32_16x16x64_bf16 v[12:15], v[32:35], a[112:119], v60
    v_cvt_pk_bf16_f32 v4, v4, v5
    ds_write_b32 v70, v4 offset:0
    v_smfmac_f32_16x16x64_bf16 v[12:15], v[36:39], a[120:127], v60
    v_add_f32 v8, v8, v10
    v_smfmac_f32_16x16x64_bf16 v[12:15], v[40:43], a[128:135], v60
    v_add_f32 v9, v9, v11
    v_smfmac_f32_16x16x64_bf16 v[16:19], v[32:35], a[168:175], v60
    v_cvt_pk_bf16_f32 v8, v8, v9
    ds_write_b32 v70, v8 offset:256
    v_smfmac_f32_16x16x64_bf16 v[16:19], v[36:39], a[176:183], v60
    v_add_f32 v12, v12, v14
    v_smfmac_f32_16x16x64_bf16 v[16:19], v[40:43], a[184:191], v60
    v_add_f32 v13, v13, v15
    s_waitcnt vmcnt(0)
    v_cvt_pk_bf16_f32 v12, v12, v13
    ds_write_b32 v70, v12 offset:512
    ds_read_b128 a[224:227], v72 offset:0
    ds_read_b128 a[228:231], v72 offset:3584
    ds_read_b128 a[232:235], v72 offset:256
    ds_read_b128 a[236:239], v72 offset:3840
    v_add_f32 v16, v16, v18
    v_add_f32 v17, v17, v19
    v_cvt_pk_bf16_f32 v16, v16, v17
    ds_write_b32 v70, v16 offset:768
    ds_read_b128 a[240:243], v72 offset:512
    ds_read_b128 a[244:247], v72 offset:4096
    s_waitcnt lgkmcnt(5)
    s_barrier
    ds_read_b64_tr_b16 v[92:93], v71 offset:0
    ds_read_b64_tr_b16 v[94:95], v71 offset:128
    ds_read_b64_tr_b16 v[96:97], v71 offset:256
    ds_read_b64_tr_b16 v[98:99], v71 offset:384
    ds_read_b128 a[248:251], v72 offset:768
    ds_read_b128 a[252:255], v72 offset:4352
    s_waitcnt lgkmcnt(4)
    v_smfmac_f32_16x16x64_bf16 v[80:83], v[92:95], v[120:127], v60
    ds_read_b128 v[232:235], v72 offset:1024
    ds_read_b128 v[236:239], v72 offset:4608
    v_smfmac_f32_16x16x64_bf16 v[84:87], v[92:95], v[128:135], v60
    ds_read_b128 v[240:243], v72 offset:1280
    ds_read_b128 v[244:247], v72 offset:4864
    s_barrier
    ds_read_b64_tr_b16 v[100:101], v71 offset:512
    ds_read_b64_tr_b16 v[102:103], v71 offset:640
    ds_read_b64_tr_b16 v[104:105], v71 offset:768
    ds_read_b64_tr_b16 v[106:107], v71 offset:896
    v_smfmac_f32_16x16x64_bf16 v[88:91], v[92:95], a[224:231], v60
    ds_read_b128 v[248:251], v72 offset:1536
    ds_read_b128 v[252:255], v72 offset:5120
    s_waitcnt lgkmcnt(12)
    v_smfmac_f32_16x16x64_bf16 v[80:83], v[96:99], v[136:143], v60
    v_smfmac_f32_16x16x64_bf16 v[84:87], v[96:99], v[144:151], v60
    v_smfmac_f32_16x16x64_bf16 v[88:91], v[96:99], a[232:239], v60
    s_waitcnt lgkmcnt(4)
    v_smfmac_f32_16x16x64_bf16 v[80:83], v[100:103], v[152:159], v60
    v_smfmac_f32_16x16x64_bf16 v[84:87], v[100:103], v[160:167], v60
    s_barrier
    ds_read_b64_tr_b16 v[108:109], v71 offset:1024
    ds_read_b64_tr_b16 v[110:111], v71 offset:1152
    v_smfmac_f32_16x16x64_bf16 v[88:91], v[100:103], a[240:247], v60
    s_waitcnt lgkmcnt(4)
    v_smfmac_f32_16x16x64_bf16 v[80:83], v[104:107], v[168:175], v60
    v_smfmac_f32_16x16x64_bf16 v[84:87], v[104:107], v[176:183], v60
    v_smfmac_f32_16x16x64_bf16 v[88:91], v[104:107], a[248:255], v60
    s_waitcnt lgkmcnt(0)
    v_smfmac_f32_16x16x64_bf16 v[80:83], v[108:111], v[184:191], v60
    s_barrier
    ds_read_b64_tr_b16 v[112:113], v71 offset:1280
    ds_read_b64_tr_b16 v[114:115], v71 offset:1408
    v_smfmac_f32_16x16x64_bf16 v[84:87], v[108:111], v[192:199], v60
    v_smfmac_f32_16x16x64_bf16 v[88:91], v[108:111], v[232:239], v60
    s_barrier
    ds_read_b64_tr_b16 v[116:117], v71 offset:1536
    ds_read_b64_tr_b16 v[118:119], v71 offset:1664
    s_waitcnt lgkmcnt(2)
    v_smfmac_f32_16x16x64_bf16 v[80:83], v[112:115], v[200:207], v60
    v_smfmac_f32_16x16x64_bf16 v[84:87], v[112:115], v[208:215], v60
    v_smfmac_f32_16x16x64_bf16 v[88:91], v[112:115], v[240:247], v60
    s_waitcnt lgkmcnt(0)
    v_smfmac_f32_16x16x64_bf16 v[88:91], v[116:119], v[248:255], v60
    v_smfmac_f32_16x16x64_bf16 v[80:83], v[116:119], v[216:223], v60
    v_smfmac_f32_16x16x64_bf16 v[84:87], v[116:119], v[224:231], v60
    v_add_f32 v8, v88, v90
    s_nop 1
    v_add_f32_dpp v8, v89, v91 quad_perm:[0,1,2,3] row_mask:0xf bank_mask:0xa
    v_pk_add_f32 v[4:5], v[80:81], v[82:83]
    v_exp_f32 v8, v8
    v_exp_f32 v4, v4
    v_exp_f32 v5, v5
    v_pk_add_f32 v[6:7], v[84:85], v[86:87]
    v_exp_f32 v6, v6
    v_exp_f32 v7, v7
    v_pk_fma_f32 v[10:11], v[8:9], v[64:65], v[4:5] op_sel_hi:[0,1,1]
    v_pk_add_f32 v[10:11], v[10:11], v[6:7]
    v_mov_b32_dpp v9, v8 row_ror:8 row_mask:0xf bank_mask:0xf
    s_nop 0
    v_add_f32_dpp v10, v10, v10 quad_perm:[1,0,3,2] row_mask:0xf bank_mask:0xf
    v_add_f32_dpp v11, v11, v11 quad_perm:[1,0,3,2] row_mask:0xf bank_mask:0xf
    s_nop 0
    v_add_f32_dpp v10, v10, v10 quad_perm:[2,3,0,1] row_mask:0xf bank_mask:0xf
    v_add_f32_dpp v11, v11, v11 quad_perm:[2,3,0,1] row_mask:0xf bank_mask:0xf
    s_nop 0
    v_add_f32_dpp v10, v10, v10 row_half_mirror row_mask:0xf bank_mask:0xf
    v_add_f32_dpp v11, v11, v11 row_half_mirror row_mask:0xf bank_mask:0xf
    s_nop 0
    v_add_f32_dpp v10, v10, v10 row_mirror row_mask:0xf bank_mask:0xf
    v_add_f32_dpp v11, v11, v11 row_mirror row_mask:0xf bank_mask:0xf
    v_rcp_f32 v12, v10
    v_rcp_f32 v13, v11
    v_add_f32 v10, v10, v11
    v_add_f32 v11, v12, v13
    v_pk_mul_f32 v[4:5], v[4:5], v[12:13]
    v_add_f32 v10, v10, v11
    v_pk_mul_f32 v[6:7], v[6:7], v[12:13]
    v_cmp_nlt_f32 vcc, v10, v62
    v_cvt_pk_bf16_f32 v68, v4, v6
    v_cvt_pk_bf16_f32 v69, v5, v7
    s_cbranch_vccnz L_sc_exact
    buffer_store_dword v68, v74, s[8:11], s72 offen
    buffer_store_dword v69, v74, s[8:11], s72 offen offset:128
    v_mov_b32_dpp v12, v13 quad_perm:[0,1,2,3] row_mask:0xf bank_mask:0xa
    v_mul_f32 v8, v8, v12
    v_mul_f32 v9, v9, v12
    v_cvt_pk_bf16_f32 v14, v8, v9
    buffer_store_dword v14, v75, s[8:11], s72 offen
L_sc_join:
    s_add_u32 s71, s71, 18432
    s_add_u32 s63, s63, 1
    s_cmp_lt_u32 s63, 63
    s_cbranch_scc1 L_score_loop0
    s_branch L_sc_end
L_s0_y:
    buffer_load_dwordx4 v[32:35], v73, s[8:11], s71 offen offset:0 sc1
    buffer_load_dwordx4 v[36:39], v73, s[8:11], s71 offen offset:1024 sc1
    buffer_load_dwordx4 v[40:43], v73, s[8:11], s71 offen offset:2048 sc1
    s_mov_b32 m0, 0
    s_nop 0
    buffer_load_dwordx4 v73, s[8:11], s71 offen offset:0 sc1 lds
    buffer_load_dwordx4 v73, s[8:11], s71 offen offset:1024 sc1 lds
    buffer_load_dwordx4 v73, s[8:11], s71 offen offset:2048 sc1 lds
    s_waitcnt vmcnt(0)
    v_max3_u32 v68, v32, v33, v34
    v_max_u32 v68, v68, v35
    v_max3_u32 v68, v68, v36, v37
    v_max3_u32 v68, v68, v38, v39
    v_max3_u32 v68, v68, v40, v41
    v_max3_u32 v68, v68, v42, v43
    v_cmp_eq_u32 vcc, -1, v68
    s_cbranch_vccnz L_retry_143
    s_branch L_s0_z
L_sc_exact:
    v_pk_add_f32 v[4:5], v[80:81], v[82:83]
    v_pk_add_f32 v[6:7], v[84:85], v[86:87]
    v_add_f32 v8, v88, v90
    v_add_f32 v9, v89, v91
    v_max3_f32 v10, v4, v6, v8
    v_max3_f32 v11, v5, v7, v9
    s_nop 0
    v_max_f32_dpp v10, v10, v10 quad_perm:[1,0,3,2] row_mask:0xf bank_mask:0xf
    v_max_f32_dpp v11, v11, v11 quad_perm:[1,0,3,2] row_mask:0xf bank_mask:0xf
    s_nop 0
    v_max_f32_dpp v10, v10, v10 quad_perm:[2,3,0,1] row_mask:0xf bank_mask:0xf
    v_max_f32_dpp v11, v11, v11 quad_perm:[2,3,0,1] row_mask:0xf bank_mask:0xf
    s_nop 0
    v_max_f32_dpp v10, v10, v10 row_half_mirror row_mask:0xf bank_mask:0xf
    v_max_f32_dpp v11, v11, v11 row_half_mirror row_mask:0xf bank_mask:0xf
    s_nop 0
    v_max_f32_dpp v10, v10, v10 row_mirror row_mask:0xf bank_mask:0xf
    v_max_f32_dpp v11, v11, v11 row_mirror row_mask:0xf bank_mask:0xf
    v_sub_f32 v4, v4, v10
    v_sub_f32 v6, v6, v10
    v_sub_f32 v5, v5, v11
    v_sub_f32 v7, v7, v11
    v_sub_f32 v8, v8, v10
    s_nop 1
    v_sub_f32_dpp v8, v9, v11 quad_perm:[0,1,2,3] row_mask:0xf bank_mask:0xa
    v_exp_f32 v4, v4
    v_exp_f32 v6, v6
    v_exp_f32 v5, v5
    v_exp_f32 v7, v7
    v_exp_f32 v8, v8
    s_nop 0
    v_pk_fma_f32 v[10:11], v[8:9], v[64:65], v[4:5] op_sel_hi:[0,1,1]
    v_pk_add_f32 v[10:11], v[10:11], v[6:7]
    v_mov_b32_dpp v9, v8 row_ror:8 row_mask:0xf bank_mask:0xf
    s_nop 0
    v_add_f32_dpp v10, v10, v10 quad_perm:[1,0,3,2] row_mask:0xf bank_mask:0xf
    v_add_f32_dpp v11, v11, v11 quad_perm:[1,0,3,2] row_mask:0xf bank_mask:0xf
    s_nop 0
    v_add_f32_dpp v10, v10, v10 quad_perm:[2,3,0,1] row_mask:0xf bank_mask:0xf
    v_add_f32_dpp v11, v11, v11 quad_perm:[2,3,0,1] row_mask:0xf bank_mask:0xf
    s_nop 0
    v_add_f32_dpp v10, v10, v10 row_half_mirror row_mask:0xf bank_mask:0xf
    v_add_f32_dpp v11, v11, v11 row_half_mirror row_mask:0xf bank_mask:0xf
    s_nop 0
    v_add_f32_dpp v10, v10, v10 row_mirror row_mask:0xf bank_mask:0xf
    v_add_f32_dpp v11, v11, v11 row_mirror row_mask:0xf bank_mask:0xf
    v_rcp_f32 v12, v10
    v_rcp_f32 v13, v11
    s_nop 0
    v_pk_mul_f32 v[4:5], v[4:5], v[12:13]
    v_pk_mul_f32 v[6:7], v[6:7], v[12:13]
    v_cvt_pk_bf16_f32 v68, v4, v6
    v_min_u32 v68, -2, v68
    v_cvt_pk_bf16_f32 v69, v5, v7
    v_min_u32 v69, -2, v69
    buffer_store_dword v68, v74, s[8:11], s72 offen
    buffer_store_dword v69, v74, s[8:11], s72 offen offset:128
    v_mov_b32_dpp v12, v13 quad_perm:[0,1,2,3] row_mask:0xf bank_mask:0xa
    v_mul_f32 v8, v8, v12
    v_mul_f32 v9, v9, v12
    v_cvt_pk_bf16_f32 v14, v8, v9
    v_min_u32 v14, -2, v14
    buffer_store_dword v14, v75, s[8:11], s72 offen
    s_branch L_sc_join
L_score_loop1:
    v_pk_mov_b32 v[0:1], 0, 0
    v_pk_mov_b32 v[2:3], 0, 0
    v_pk_mov_b32 v[4:5], 0, 0
    v_pk_mov_b32 v[6:7], 0, 0
    v_pk_mov_b32 v[8:9], 0, 0
    v_pk_mov_b32 v[10:11], 0, 0
    v_pk_mov_b32 v[12:13], 0, 0
    v_pk_mov_b32 v[14:15], 0, 0
    v_pk_mov_b32 v[16:17], 0, 0
    v_pk_mov_b32 v[18:19], 0, 0
    v_pk_mov_b32 v[20:21], 0, 0
    v_pk_mov_b32 v[22:23], 0, 0
    v_pk_mov_b32 v[24:25], 0, 0
    v_pk_mov_b32 v[26:27], 0, 0
    v_pk_mov_b32 v[28:29], 0, 0
    v_pk_mov_b32 v[30:31], 0, 0
    s_add_u32 s72, s71, 8192
    s_add_u32 s86, s71, 4096
    s_add_u32 s85, s63, 1
    s_barrier
    buffer_load_dwordx4 v[32:35], v73, s[8:11], s71 offen offset:0 sc1
    s_barrier
    buffer_load_dwordx4 v[36:39], v73, s[8:11], s71 offen offset:1024 sc1
    s_barrier
    s_barrier
    buffer_load_dwordx4 v[40:43], v73, s[8:11], s71 offen offset:2048 sc1
L_lk_144:
    s_waitcnt vmcnt(2)
    v_smfmac_f32_16x16x64_bf16 v[4:7], v[32:35], a[0:7], v60
    v_smfmac_f32_16x16x64_bf16 v[8:11], v[32:35], a[56:63], v60
    v_max3_u32 v68, v32, v33, v34
    v_smfmac_f32_16x16x64_bf16 v[12:15], v[32:35], a[112:119], v60
    v_max_u32 v68, v68, v35
    v_smfmac_f32_16x16x64_bf16 v[16:19], v[32:35], a[168:175], v60
    v_smfmac_f32_16x16x64_bf16 v[20:23], v[32:35], a[224:231], v60
    v_smfmac_f32_16x16x64_bf16 v[24:27], v[32:35], v[144:151], v60
    v_smfmac_f32_16x16x64_bf16 v[28:31], v[32:35], v[200:207], v60
    v_smfmac_f32_16x16x64_bf16 v[0:3], v[32:35], v[80:87], v60
    s_waitcnt vmcnt(1)
    v_smfmac_f32_16x16x64_bf16 v[4:7], v[36:39], a[8:15], v60
    v_smfmac_f32_16x16x64_bf16 v[8:11], v[36:39], a[64:71], v60
    v_max3_u32 v68, v68, v36, v37
    v_smfmac_f32_16x16x64_bf16 v[12:15], v[36:39], a[120:127], v60
    v_max3_u32 v68, v68, v38, v39
    v_smfmac_f32_16x16x64_bf16 v[16:19], v[36:39], a[176:183], v60
    v_smfmac_f32_16x16x64_bf16 v[20:23], v[36:39], a[232:239], v60
    v_smfmac_f32_16x16x64_bf16 v[24:27], v[36:39], v[152:159], v60
    v_smfmac_f32_16x16x64_bf16 v[28:31], v[36:39], v[208:215], v60
    v_smfmac_f32_16x16x64_bf16 v[0:3], v[36:39], v[88:95], v60
    s_waitcnt vmcnt(0)
    v_smfmac_f32_16x16x64_bf16 v[4:7], v[40:43], a[16:23], v60
    v_smfmac_f32_16x16x64_bf16 v[8:11], v[40:43], a[72:79], v60
    v_max3_u32 v68, v68, v40, v41
    v_smfmac_f32_16x16x64_bf16 v[12:15], v[40:43], a[128:135], v60
    v_max3_u32 v68, v68, v42, v43
    v_smfmac_f32_16x16x64_bf16 v[16:19], v[40:43], a[184:191], v60
    v_cmp_eq_u32 vcc, -1, v68
    s_cbranch_vccnz L_retry_145
    v_smfmac_f32_16x16x64_bf16 v[20:23], v[40:43], a[240:247], v60
    s_barrier
    ds_read_b128 v[44:47], v73 offset:3072
    ds_read_b128 v[48:51], v73 offset:4096
    v_smfmac_f32_16x16x64_bf16 v[24:27], v[40:43], v[160:167], v60
    ds_read_b128 v[52:55], v73 offset:5120
    ds_read_b128 v[56:59], v73 offset:6144
    v_smfmac_f32_16x16x64_bf16 v[28:31], v[40:43], v[216:223], v60
    v_smfmac_f32_16x16x64_bf16 v[0:3], v[40:43], v[96:103], v60
    s_waitcnt lgkmcnt(3)
    v_smfmac_f32_16x16x64_bf16 v[4:7], v[44:47], a[24:31], v60
    s_waitcnt lgkmcnt(2)
    v_smfmac_f32_16x16x64_bf16 v[4:7], v[48:51], a[32:39], v60
    s_waitcnt lgkmcnt(1)
    v_smfmac_f32_16x16x64_bf16 v[4:7], v[52:55], a[40:47], v60
    s_waitcnt lgkmcnt(0)
    v_smfmac_f32_16x16x64_bf16 v[4:7], v[56:59], a[48:55], v60
    ds_read_b128 v[32:35], v78 offset:0
    v_smfmac_f32_16x16x64_bf16 v[8:11], v[44:47], a[80:87], v60
    ds_read_b128 v[36:39], v78 offset:1024
    v_smfmac_f32_16x16x64_bf16 v[8:11], v[48:51], a[88:95], v60
    v_add_f32 v4, v4, v6
    v_smfmac_f32_16x16x64_bf16 v[8:11], v[52:55], a[96:103], v60
    v_add_f32 v5, v5, v7
    v_smfmac_f32_16x16x64_bf16 v[8:11], v[56:59], a[104:111], v60
    v_cvt_pk_bf16_f32 v4, v4, v5
    v_smfmac_f32_16x16x64_bf16 v[12:15], v[44:47], a[136:143], v60
    ds_write_b32 v70, v4 offset:1792
    v_smfmac_f32_16x16x64_bf16 v[12:15], v[48:51], a[144:151], v60
    v_add_f32 v8, v8, v10
    v_smfmac_f32_16x16x64_bf16 v[12:15], v[52:55], a[152:159], v60
    v_add_f32 v9, v9, v11
    v_smfmac_f32_16x16x64_bf16 v[12:15], v[56:59], a[160:167], v60
    v_cvt_pk_bf16_f32 v8, v8, v9
    v_smfmac_f32_16x16x64_bf16 v[16:19], v[44:47], a[192:199], v60
    ds_write_b32 v70, v8 offset:2048
    v_smfmac_f32_16x16x64_bf16 v[16:19], v[48:51], a[200:207], v60
    v_add_f32 v12, v12, v14
    ds_read_b128 v[4:7], v78 offset:2048
    v_smfmac_f32_16x16x64_bf16 v[16:19], v[52:55], a[208:215], v60
    v_add_f32 v13, v13, v15
    v_smfmac_f32_16x16x64_bf16 v[16:19], v[56:59], a[216:223], v60
    v_cvt_pk_bf16_f32 v12, v12, v13
    v_smfmac_f32_16x16x64_bf16 v[20:23], v[44:47], a[248:255], v60
    ds_write_b32 v70, v12 offset:2304
    v_smfmac_f32_16x16x64_bf16 v[20:23], v[48:51], v[120:127], v60
    v_add_f32 v16, v16, v18
    ds_read_b128 v[8:11], v78 offset:3072
    v_smfmac_f32_16x16x64_bf16 v[20:23], v[52:55], v[128:135], v60
    v_add_f32 v17, v17, v19
    v_smfmac_f32_16x16x64_bf16 v[20:23], v[56:59], v[136:143], v60
    v_cvt_pk_bf16_f32 v16, v16, v17
    s_waitcnt lgkmcnt(3)
    s_barrier
    v_smfmac_f32_16x16x64_bf16 v[24:27], v[44:47], v[168:175], v60
    ds_write_b32 v70, v16 offset:2560
    v_smfmac_f32_16x16x64_bf16 v[24:27], v[48:51], v[176:183], v60
    v_add_f32 v20, v20, v22
    v_smfmac_f32_16x16x64_bf16 v[24:27], v[52:55], v[184:191], v60
    v_add_f32 v21, v21, v23
    v_smfmac_f32_16x16x64_bf16 v[24:27], v[56:59], v[192:199], v60
    v_cvt_pk_bf16_f32 v20, v20, v21
    v_smfmac_f32_16x16x64_bf16 v[28:31], v[44:47], v[224:231], v60
    ds_write_b32 v70, v20 offset:1024
    v_smfmac_f32_16x16x64_bf16 v[28:31], v[48:51], v[232:239], v60
    v_add_f32 v24, v24, v26
    s_waitcnt lgkmcnt(1)
    s_barrier
    v_smfmac_f32_16x16x64_bf16 v[28:31], v[52:55], v[240:247], v60
    v_add_f32 v25, v25, v27
    v_smfmac_f32_16x16x64_bf16 v[28:31], v[56:59], v[248:255], v60
    v_cvt_pk_bf16_f32 v24, v24, v25
    v_smfmac_f32_16x16x64_bf16 v[0:3], v[44:47], v[104:111], v60
    ds_write_b32 v70, v24 offset:6400
    v_smfmac_f32_16x16x64_bf16 v[0:3], v[48:51], v[112:119], v60
    v_add_f32 v28, v28, v30
    s_waitcnt lgkmcnt(3)
    v_smfmac_f32_16x16x64_bf16 v[0:3], v[52:55], v[32:39], v60
    v_add_f32 v29, v29, v31
    v_smfmac_f32_16x16x64_bf16 v[0:3], v[56:59], v[4:11], v60
    v_cvt_pk_bf16_f32 v28, v28, v29
    s_waitcnt lgkmcnt(0)
    s_barrier
    ds_write_b32 v70, v28 offset:4864
    s_nop 3
    v_pk_add_f32 v[0:1], v[0:1], v[2:3]
    v_cvt_pk_bf16_f32 v0, v0, v1
    ds_write_b32 v70, v0 offset:3328
    s_waitcnt lgkmcnt(1)
    s_barrier
    s_waitcnt lgkmcnt(0)
    s_barrier
    s_add_u32 s71, s71, 18432
    s_add_u32 s63, s63, 1
    s_cmp_lt_u32 s63, 63
    s_cbranch_scc1 L_score_loop1
    s_branch L_sc_end
L_score_loop2:
    v_pk_mov_b32 v[0:1], 0, 0
    v_pk_mov_b32 v[2:3], 0, 0
    v_pk_mov_b32 v[4:5], 0, 0
    v_pk_mov_b32 v[6:7], 0, 0
    v_pk_mov_b32 v[8:9], 0, 0
    v_pk_mov_b32 v[10:11], 0, 0
    v_pk_mov_b32 v[12:13], 0, 0
    v_pk_mov_b32 v[14:15], 0, 0
    v_pk_mov_b32 v[16:17], 0, 0
    v_pk_mov_b32 v[18:19], 0, 0
    v_pk_mov_b32 v[20:21], 0, 0
    v_pk_mov_b32 v[22:23], 0, 0
    v_pk_mov_b32 v[24:25], 0, 0
    v_pk_mov_b32 v[26:27], 0, 0
    v_pk_mov_b32 v[28:29], 0, 0
    v_pk_mov_b32 v[30:31], 0, 0
    s_add_u32 s72, s71, 8192
    s_add_u32 s86, s71, 4096
    s_add_u32 s85, s63, 1
    buffer_load_dword v68, v61, s[8:11], s82 offen sc1
    s_nop 15
    buffer_load_dword v68, v61, s[8:11], s82 offen sc1
    s_nop 15
L_hint_146:
    buffer_load_dword v68, v61, s[8:11], s82 offen sc1
    s_waitcnt vmcnt(2)
    v_cmp_gt_u32 vcc, s85, v68
    s_cbranch_vccnz L_retry_148
    s_barrier
    buffer_load_dwordx4 v[32:35], v73, s[8:11], s71 offen offset:0 sc1
    s_barrier
    buffer_load_dwordx4 v[36:39], v73, s[8:11], s71 offen offset:1024 sc1
    s_barrier
    s_barrier
    buffer_load_dwordx4 v[40:43], v73, s[8:11], s71 offen offset:2048 sc1
L_lk_149:
    s_waitcnt vmcnt(2)
    v_smfmac_f32_16x16x64_bf16 v[4:7], v[32:35], a[0:7], v60
    v_smfmac_f32_16x16x64_bf16 v[8:11], v[32:35], a[56:63], v60
    v_max3_u32 v68, v32, v33, v34
    v_smfmac_f32_16x16x64_bf16 v[12:15], v[32:35], a[112:119], v60
    v_max_u32 v68, v68, v35
    v_smfmac_f32_16x16x64_bf16 v[16:19], v[32:35], a[168:175], v60
    v_smfmac_f32_16x16x64_bf16 v[20:23], v[32:35], a[224:231], v60
    v_smfmac_f32_16x16x64_bf16 v[24:27], v[32:35], v[144:151], v60
    v_smfmac_f32_16x16x64_bf16 v[28:31], v[32:35], v[200:207], v60
    v_smfmac_f32_16x16x64_bf16 v[0:3], v[32:35], v[80:87], v60
    s_waitcnt vmcnt(1)
    v_smfmac_f32_16x16x64_bf16 v[4:7], v[36:39], a[8:15], v60
    v_smfmac_f32_16x16x64_bf16 v[8:11], v[36:39], a[64:71], v60
    v_max3_u32 v68, v68, v36, v37
    v_smfmac_f32_16x16x64_bf16 v[12:15], v[36:39], a[120:127], v60
    v_max3_u32 v68, v68, v38, v39
    v_smfmac_f32_16x16x64_bf16 v[16:19], v[36:39], a[176:183], v60
    v_smfmac_f32_16x16x64_bf16 v[20:23], v[36:39], a[232:239], v60
    v_smfmac_f32_16x16x64_bf16 v[24:27], v[36:39], v[152:159], v60
    v_smfmac_f32_16x16x64_bf16 v[28:31], v[36:39], v[208:215], v60
    v_smfmac_f32_16x16x64_bf16 v[0:3], v[36:39], v[88:95], v60
    s_waitcnt vmcnt(0)
    v_smfmac_f32_16x16x64_bf16 v[4:7], v[40:43], a[16:23], v60
    v_smfmac_f32_16x16x64_bf16 v[8:11], v[40:43], a[72:79], v60
    v_max3_u32 v68, v68, v40, v41
    v_smfmac_f32_16x16x64_bf16 v[12:15], v[40:43], a[128:135], v60
    v_max3_u32 v68, v68, v42, v43
    v_smfmac_f32_16x16x64_bf16 v[16:19], v[40:43], a[184:191], v60
    v_cmp_eq_u32 vcc, -1, v68
    s_cbranch_vccnz L_retry_150
    v_smfmac_f32_16x16x64_bf16 v[20:23], v[40:43], a[240:247], v60
    s_barrier
    ds_read_b128 v[44:47], v73 offset:3072
    ds_read_b128 v[48:51], v73 offset:4096
    v_smfmac_f32_16x16x64_bf16 v[24:27], v[40:43], v[160:167], v60
    ds_read_b128 v[52:55], v73 offset:5120
    ds_read_b128 v[56:59], v73 offset:6144
    v_smfmac_f32_16x16x64_bf16 v[28:31], v[40:43], v[216:223], v60
    v_smfmac_f32_16x16x64_bf16 v[0:3], v[40:43], v[96:103], v60
    s_waitcnt lgkmcnt(3)
    v_smfmac_f32_16x16x64_bf16 v[4:7], v[44:47], a[24:31], v60
    s_waitcnt lgkmcnt(2)
    v_smfmac_f32_16x16x64_bf16 v[4:7], v[48:51], a[32:39], v60
    s_waitcnt lgkmcnt(1)
    v_smfmac_f32_16x16x64_bf16 v[4:7], v[52:55], a[40:47], v60
    s_waitcnt lgkmcnt(0)
    v_smfmac_f32_16x16x64_bf16 v[4:7], v[56:59], a[48:55], v60
    ds_read_b128 v[32:35], v78 offset:0
    v_smfmac_f32_16x16x64_bf16 v[8:11], v[44:47], a[80:87], v60
    ds_read_b128 v[36:39], v78 offset:1024
    v_smfmac_f32_16x16x64_bf16 v[8:11], v[48:51], a[88:95], v60
    v_add_f32 v4, v4, v6
    v_smfmac_f32_16x16x64_bf16 v[8:11], v[52:55], a[96:103], v60
    v_add_f32 v5, v5, v7
    v_smfmac_f32_16x16x64_bf16 v[8:11], v[56:59], a[104:111], v60
    v_cvt_pk_bf16_f32 v4, v4, v5
    v_smfmac_f32_16x16x64_bf16 v[12:15], v[44:47], a[136:143], v60
    ds_write_b32 v70, v4 offset:3584
    v_smfmac_f32_16x16x64_bf16 v[12:15], v[48:51], a[144:151], v60
    v_add_f32 v8, v8, v10
    v_smfmac_f32_16x16x64_bf16 v[12:15], v[52:55], a[152:159], v60
    v_add_f32 v9, v9, v11
    v_smfmac_f32_16x16x64_bf16 v[12:15], v[56:59], a[160:167], v60
    v_cvt_pk_bf16_f32 v8, v8, v9
    v_smfmac_f32_16x16x64_bf16 v[16:19], v[44:47], a[192:199], v60
    ds_write_b32 v70, v8 offset:3840
    v_smfmac_f32_16x16x64_bf16 v[16:19], v[48:51], a[200:207], v60
    v_add_f32 v12, v12, v14
    ds_read_b128 v[4:7], v78 offset:2048
    v_smfmac_f32_16x16x64_bf16 v[16:19], v[52:55], a[208:215], v60
    v_add_f32 v13, v13, v15
    v_smfmac_f32_16x16x64_bf16 v[16:19], v[56:59], a[216:223], v60
    v_cvt_pk_bf16_f32 v12, v12, v13
    v_smfmac_f32_16x16x64_bf16 v[20:23], v[44:47], a[248:255], v60
    ds_write_b32 v70, v12 offset:4096
    v_smfmac_f32_16x16x64_bf16 v[20:23], v[48:51], v[120:127], v60
    v_add_f32 v16, v16, v18
    ds_read_b128 v[8:11], v78 offset:3072
    v_smfmac_f32_16x16x64_bf16 v[20:23], v[52:55], v[128:135], v60
    v_add_f32 v17, v17, v19
    v_smfmac_f32_16x16x64_bf16 v[20:23], v[56:59], v[136:143], v60
    v_cvt_pk_bf16_f32 v16, v16, v17
    s_waitcnt lgkmcnt(3)
    s_barrier
    v_smfmac_f32_16x16x64_bf16 v[24:27], v[44:47], v[168:175], v60
    ds_write_b32 v70, v16 offset:4352
    v_smfmac_f32_16x16x64_bf16 v[24:27], v[48:51], v[176:183], v60
    v_add_f32 v20, v20, v22
    v_smfmac_f32_16x16x64_bf16 v[24:27], v[52:55], v[184:191], v60
    v_add_f32 v21, v21, v23
    v_smfmac_f32_16x16x64_bf16 v[24:27], v[56:59], v[192:199], v60
    v_cvt_pk_bf16_f32 v20, v20, v21
    v_smfmac_f32_16x16x64_bf16 v[28:31], v[44:47], v[224:231], v60
    ds_write_b32 v70, v20 offset:2816
    v_smfmac_f32_16x16x64_bf16 v[28:31], v[48:51], v[232:239], v60
    v_add_f32 v24, v24, v26
    s_waitcnt lgkmcnt(1)
    s_barrier
    v_smfmac_f32_16x16x64_bf16 v[28:31], v[52:55], v[240:247], v60
    v_add_f32 v25, v25, v27
    v_smfmac_f32_16x16x64_bf16 v[28:31], v[56:59], v[248:255], v60
    v_cvt_pk_bf16_f32 v24, v24, v25
    v_smfmac_f32_16x16x64_bf16 v[0:3], v[44:47], v[104:111], v60
    ds_write_b32 v70, v24 offset:1280
    v_smfmac_f32_16x16x64_bf16 v[0:3], v[48:51], v[112:119], v60
    v_add_f32 v28, v28, v30
    s_waitcnt lgkmcnt(3)
    v_smfmac_f32_16x16x64_bf16 v[0:3], v[52:55], v[32:39], v60
    v_add_f32 v29, v29, v31
    v_smfmac_f32_16x16x64_bf16 v[0:3], v[56:59], v[4:11], v60
    v_cvt_pk_bf16_f32 v28, v28, v29
    s_waitcnt lgkmcnt(0)
    s_barrier
    ds_write_b32 v70, v28 offset:6656
    s_nop 3
    v_pk_add_f32 v[0:1], v[0:1], v[2:3]
    v_cvt_pk_bf16_f32 v0, v0, v1
    ds_write_b32 v70, v0 offset:5120
    s_waitcnt lgkmcnt(1)
    s_barrier
    s_waitcnt lgkmcnt(0)
    s_barrier
    s_sleep 8
    s_add_u32 s71, s71, 18432
    s_add_u32 s63, s63, 1
    s_cmp_lt_u32 s63, 63
    s_cbranch_scc1 L_score_loop2
    s_branch L_sc_end
L_score_loop3:
    v_pk_mov_b32 v[0:1], 0, 0
    v_pk_mov_b32 v[2:3], 0, 0
    v_pk_mov_b32 v[4:5], 0, 0
    v_pk_mov_b32 v[6:7], 0, 0
    v_pk_mov_b32 v[8:9], 0, 0
    v_pk_mov_b32 v[10:11], 0, 0
    v_pk_mov_b32 v[12:13], 0, 0
    v_pk_mov_b32 v[14:15], 0, 0
    v_pk_mov_b32 v[16:17], 0, 0
    v_pk_mov_b32 v[18:19], 0, 0
    v_pk_mov_b32 v[20:21], 0, 0
    v_pk_mov_b32 v[22:23], 0, 0
    v_pk_mov_b32 v[24:25], 0, 0
    v_pk_mov_b32 v[26:27], 0, 0
    v_pk_mov_b32 v[28:29], 0, 0
    v_pk_mov_b32 v[30:31], 0, 0
    s_add_u32 s72, s71, 8192
    s_add_u32 s86, s71, 4096
    s_add_u32 s85, s63, 1
    v_mov_b32 v76, s85
    s_barrier
    buffer_load_dwordx4 v[32:35], v73, s[8:11], s71 offen offset:0 sc1
    s_barrier
    buffer_load_dwordx4 v[36:39], v73, s[8:11], s71 offen offset:1024 sc1
    s_barrier
    s_barrier
    buffer_load_dwordx4 v[40:43], v73, s[8:11], s71 offen offset:2048 sc1
L_lk_151:
    s_waitcnt vmcnt(2)
    v_smfmac_f32_16x16x64_bf16 v[4:7], v[32:35], a[0:7], v60
    v_smfmac_f32_16x16x64_bf16 v[8:11], v[32:35], a[56:63], v60
    v_max3_u32 v68, v32, v33, v34
    v_smfmac_f32_16x16x64_bf16 v[12:15], v[32:35], a[112:119], v60
    v_max_u32 v68, v68, v35
    v_smfmac_f32_16x16x64_bf16 v[16:19], v[32:35], a[168:175], v60
    v_smfmac_f32_16x16x64_bf16 v[20:23], v[32:35], a[224:231], v60
    v_smfmac_f32_16x16x64_bf16 v[24:27], v[32:35], v[144:151], v60
    v_smfmac_f32_16x16x64_bf16 v[28:31], v[32:35], v[200:207], v60
    v_smfmac_f32_16x16x64_bf16 v[0:3], v[32:35], v[80:87], v60
    s_waitcnt vmcnt(1)
    v_smfmac_f32_16x16x64_bf16 v[4:7], v[36:39], a[8:15], v60
    v_smfmac_f32_16x16x64_bf16 v[8:11], v[36:39], a[64:71], v60
    v_max3_u32 v68, v68, v36, v37
    v_smfmac_f32_16x16x64_bf16 v[12:15], v[36:39], a[120:127], v60
    v_max3_u32 v68, v68, v38, v39
    v_smfmac_f32_16x16x64_bf16 v[16:19], v[36:39], a[176:183], v60
    v_smfmac_f32_16x16x64_bf16 v[20:23], v[36:39], a[232:239], v60
    v_smfmac_f32_16x16x64_bf16 v[24:27], v[36:39], v[152:159], v60
    v_smfmac_f32_16x16x64_bf16 v[28:31], v[36:39], v[208:215], v60
    v_smfmac_f32_16x16x64_bf16 v[0:3], v[36:39], v[88:95], v60
    s_waitcnt vmcnt(0)
    v_smfmac_f32_16x16x64_bf16 v[4:7], v[40:43], a[16:23], v60
    v_smfmac_f32_16x16x64_bf16 v[8:11], v[40:43], a[72:79], v60
    v_max3_u32 v68, v68, v40, v41
    v_smfmac_f32_16x16x64_bf16 v[12:15], v[40:43], a[128:135], v60
    v_max3_u32 v68, v68, v42, v43
    v_smfmac_f32_16x16x64_bf16 v[16:19], v[40:43], a[184:191], v60
    v_cmp_eq_u32 vcc, -1, v68
    s_cbranch_vccnz L_retry_152
    v_smfmac_f32_16x16x64_bf16 v[20:23], v[40:43], a[240:247], v60
    s_barrier
    ds_read_b128 v[44:47], v73 offset:3072
    ds_read_b128 v[48:51], v73 offset:4096
    v_smfmac_f32_16x16x64_bf16 v[24:27], v[40:43], v[160:167], v60
    ds_read_b128 v[52:55], v73 offset:5120
    ds_read_b128 v[56:59], v73 offset:6144
    v_smfmac_f32_16x16x64_bf16 v[28:31], v[40:43], v[216:223], v60
    v_smfmac_f32_16x16x64_bf16 v[0:3], v[40:43], v[96:103], v60
    s_waitcnt lgkmcnt(3)
    v_smfmac_f32_16x16x64_bf16 v[4:7], v[44:47], a[24:31], v60
    s_waitcnt lgkmcnt(2)
    v_smfmac_f32_16x16x64_bf16 v[4:7], v[48:51], a[32:39], v60
    s_waitcnt lgkmcnt(1)
    v_smfmac_f32_16x16x64_bf16 v[4:7], v[52:55], a[40:47], v60
    s_waitcnt lgkmcnt(0)
    v_smfmac_f32_16x16x64_bf16 v[4:7], v[56:59], a[48:55], v60
    ds_read_b128 v[32:35], v78 offset:0
    v_smfmac_f32_16x16x64_bf16 v[8:11], v[44:47], a[80:87], v60
    ds_read_b128 v[36:39], v78 offset:1024
    v_smfmac_f32_16x16x64_bf16 v[8:11], v[48:51], a[88:95], v60
    v_add_f32 v4, v4, v6
    v_smfmac_f32_16x16x64_bf16 v[8:11], v[52:55], a[96:103], v60
    v_add_f32 v5, v5, v7
    v_smfmac_f32_16x16x64_bf16 v[8:11], v[56:59], a[104:111], v60
    v_cvt_pk_bf16_f32 v4, v4, v5
    v_smfmac_f32_16x16x64_bf16 v[12:15], v[44:47], a[136:143], v60
    ds_write_b32 v70, v4 offset:5376
    v_smfmac_f32_16x16x64_bf16 v[12:15], v[48:51], a[144:151], v60
    v_add_f32 v8, v8, v10
    v_smfmac_f32_16x16x64_bf16 v[12:15], v[52:55], a[152:159], v60
    v_add_f32 v9, v9, v11
    v_smfmac_f32_16x16x64_bf16 v[12:15], v[56:59], a[160:167], v60
    v_cvt_pk_bf16_f32 v8, v8, v9
    v_smfmac_f32_16x16x64_bf16 v[16:19], v[44:47], a[192:199], v60
    ds_write_b32 v70, v8 offset:5632
    v_smfmac_f32_16x16x64_bf16 v[16:19], v[48:51], a[200:207], v60
    v_add_f32 v12, v12, v14
    ds_read_b128 v[4:7], v78 offset:2048
    v_smfmac_f32_16x16x64_bf16 v[16:19], v[52:55], a[208:215], v60
    v_add_f32 v13, v13, v15
    v_smfmac_f32_16x16x64_bf16 v[16:19], v[56:59], a[216:223], v60
    v_cvt_pk_bf16_f32 v12, v12, v13
    v_smfmac_f32_16x16x64_bf16 v[20:23], v[44:47], a[248:255], v60
    ds_write_b32 v70, v12 offset:5888
    v_smfmac_f32_16x16x64_bf16 v[20:23], v[48:51], v[120:127], v60
    v_add_f32 v16, v16, v18
    ds_read_b128 v[8:11], v78 offset:3072
    v_smfmac_f32_16x16x64_bf16 v[20:23], v[52:55], v[128:135], v60
    v_add_f32 v17, v17, v19
    v_smfmac_f32_16x16x64_bf16 v[20:23], v[56:59], v[136:143], v60
    v_cvt_pk_bf16_f32 v16, v16, v17
    s_waitcnt lgkmcnt(3)
    s_barrier
    v_smfmac_f32_16x16x64_bf16 v[24:27], v[44:47], v[168:175], v60
    ds_write_b32 v70, v16 offset:6144
    v_smfmac_f32_16x16x64_bf16 v[24:27], v[48:51], v[176:183], v60
    v_add_f32 v20, v20, v22
    v_smfmac_f32_16x16x64_bf16 v[24:27], v[52:55], v[184:191], v60
    v_add_f32 v21, v21, v23
    v_smfmac_f32_16x16x64_bf16 v[24:27], v[56:59], v[192:199], v60
    v_cvt_pk_bf16_f32 v20, v20, v21
    v_smfmac_f32_16x16x64_bf16 v[28:31], v[44:47], v[224:231], v60
    ds_write_b32 v70, v20 offset:4608
    v_smfmac_f32_16x16x64_bf16 v[28:31], v[48:51], v[232:239], v60
    v_add_f32 v24, v24, v26
    s_waitcnt lgkmcnt(1)
    s_barrier
    v_smfmac_f32_16x16x64_bf16 v[28:31], v[52:55], v[240:247], v60
    v_add_f32 v25, v25, v27
    v_smfmac_f32_16x16x64_bf16 v[28:31], v[56:59], v[248:255], v60
    v_cvt_pk_bf16_f32 v24, v24, v25
    v_smfmac_f32_16x16x64_bf16 v[0:3], v[44:47], v[104:111], v60
    ds_write_b32 v70, v24 offset:3072
    v_smfmac_f32_16x16x64_bf16 v[0:3], v[48:51], v[112:119], v60
    v_add_f32 v28, v28, v30
    s_waitcnt lgkmcnt(3)
    v_smfmac_f32_16x16x64_bf16 v[0:3], v[52:55], v[32:39], v60
    v_add_f32 v29, v29, v31
    v_smfmac_f32_16x16x64_bf16 v[0:3], v[56:59], v[4:11], v60
    v_cvt_pk_bf16_f32 v28, v28, v29
    s_waitcnt lgkmcnt(0)
    s_barrier
    ds_write_b32 v70, v28 offset:1536
    s_nop 3
    v_pk_add_f32 v[0:1], v[0:1], v[2:3]
    v_cvt_pk_bf16_f32 v0, v0, v1
    ds_write_b32 v70, v0 offset:6912
    s_waitcnt lgkmcnt(1)
    s_barrier
    s_waitcnt lgkmcnt(0)
    s_barrier
    s_nop 3
    s_nop 3
    s_nop 3
    s_nop 3
    s_nop 3
    s_nop 3
    s_nop 3
    buffer_store_dword v76, v77, s[8:11], s84 offen
    s_add_u32 s71, s71, 18432
    s_add_u32 s63, s63, 1
    s_cmp_lt_u32 s63, 63
    s_cbranch_scc1 L_score_loop3
    s_branch L_sc_end
L_sc_end:
    s_branch L_exit
L_retry_3:
    s_sleep 16
    s_sub_u32 s64, s64, 1
    s_cbranch_scc0 L_wi_2
    s_branch L_exit
L_lwr_5:
    s_sleep 3
    buffer_load_dword v68, v3, s[8:11], s65 offen sc1
    s_waitcnt vmcnt(0)
    s_sub_u32 s64, s64, 1
    s_cbranch_scc0 L_lwp_4
    s_branch L_exit
L_lwr_7:
    s_sleep 3
    buffer_load_dword v68, v3, s[8:11], s65 offen sc1
    s_waitcnt vmcnt(0)
    s_sub_u32 s64, s64, 1
    s_cbranch_scc0 L_lwp_6
    s_branch L_exit
L_lwr_9:
    s_sleep 3
    buffer_load_dword v68, v3, s[8:11], s65 offen sc1
    s_waitcnt vmcnt(0)
    s_sub_u32 s64, s64, 1
    s_cbranch_scc0 L_lwp_8
    s_branch L_exit
L_lwr_11:
    s_sleep 3
    buffer_load_dword v68, v3, s[8:11], s65 offen sc1
    s_waitcnt vmcnt(0)
    s_sub_u32 s64, s64, 1
    s_cbranch_scc0 L_lwp_10
    s_branch L_exit
L_lwr_13:
    s_sleep 3
    buffer_load_dword v68, v3, s[8:11], s65 offen sc1
    s_waitcnt vmcnt(0)
    s_sub_u32 s64, s64, 1
    s_cbranch_scc0 L_lwp_12
    s_branch L_exit
L_lwr_15:
    s_sleep 3
    buffer_load_dword v68, v3, s[8:11], s65 offen sc1
    s_waitcnt vmcnt(0)
    s_sub_u32 s64, s64, 1
    s_cbranch_scc0 L_lwp_14
    s_branch L_exit
L_lwr_17:
    s_sleep 3
    buffer_load_dword v68, v3, s[8:11], s65 offen sc1
    s_waitcnt vmcnt(0)
    s_sub_u32 s64, s64, 1
    s_cbranch_scc0 L_lwp_16
    s_branch L_exit
L_lwr_19:
    s_sleep 3
    buffer_load_dword v68, v3, s[8:11], s65 offen sc1
    s_waitcnt vmcnt(0)
    s_sub_u32 s64, s64, 1
    s_cbranch_scc0 L_lwp_18
    s_branch L_exit
L_lwr_21:
    s_sleep 3
    buffer_load_dword v68, v3, s[8:11], s65 offen sc1
    s_waitcnt vmcnt(0)
    s_sub_u32 s64, s64, 1
    s_cbranch_scc0 L_lwp_20
    s_branch L_exit
L_lwr_23:
    s_sleep 3
    buffer_load_dword v68, v3, s[8:11], s65 offen sc1
    s_waitcnt vmcnt(0)
    s_sub_u32 s64, s64, 1
    s_cbranch_scc0 L_lwp_22
    s_branch L_exit
L_lwr_25:
    s_sleep 3
    buffer_load_dword v68, v3, s[8:11], s65 offen sc1
    s_waitcnt vmcnt(0)
    s_sub_u32 s64, s64, 1
    s_cbranch_scc0 L_lwp_24
    s_branch L_exit
L_lwr_27:
    s_sleep 3
    buffer_load_dword v68, v3, s[8:11], s65 offen sc1
    s_waitcnt vmcnt(0)
    s_sub_u32 s64, s64, 1
    s_cbranch_scc0 L_lwp_26
    s_branch L_exit
L_lwr_29:
    s_sleep 3
    buffer_load_dword v68, v3, s[8:11], s65 offen sc1
    s_waitcnt vmcnt(0)
    s_sub_u32 s64, s64, 1
    s_cbranch_scc0 L_lwp_28
    s_branch L_exit
L_lwr_31:
    s_sleep 3
    buffer_load_dword v68, v3, s[8:11], s65 offen sc1
    s_waitcnt vmcnt(0)
    s_sub_u32 s64, s64, 1
    s_cbranch_scc0 L_lwp_30
    s_branch L_exit
L_lwr_33:
    s_sleep 3
    buffer_load_dword v68, v3, s[8:11], s65 offen sc1
    s_waitcnt vmcnt(0)
    s_sub_u32 s64, s64, 1
    s_cbranch_scc0 L_lwp_32
    s_branch L_exit
L_lwr_35:
    s_sleep 3
    buffer_load_dword v68, v3, s[8:11], s65 offen sc1
    s_waitcnt vmcnt(0)
    s_sub_u32 s64, s64, 1
    s_cbranch_scc0 L_lwp_34
    s_branch L_exit
L_lwr_37:
    s_sleep 3
    buffer_load_dword v68, v3, s[8:11], s65 offen sc1
    s_waitcnt vmcnt(0)
    s_sub_u32 s64, s64, 1
    s_cbranch_scc0 L_lwp_36
    s_branch L_exit
L_lwr_39:
    s_sleep 3
    buffer_load_dword v68, v3, s[8:11], s65 offen sc1
    s_waitcnt vmcnt(0)
    s_sub_u32 s64, s64, 1
    s_cbranch_scc0 L_lwp_38
    s_branch L_exit
L_lwr_41:
    s_sleep 3
    buffer_load_dword v68, v3, s[8:11], s65 offen sc1
    s_waitcnt vmcnt(0)
    s_sub_u32 s64, s64, 1
    s_cbranch_scc0 L_lwp_40
    s_branch L_exit
L_lwr_43:
    s_sleep 3
    buffer_load_dword v68, v3, s[8:11], s65 offen sc1
    s_waitcnt vmcnt(0)
    s_sub_u32 s64, s64, 1
    s_cbranch_scc0 L_lwp_42
    s_branch L_exit
L_lwr_45:
    s_sleep 3
    buffer_load_dword v68, v3, s[8:11], s65 offen sc1
    s_waitcnt vmcnt(0)
    s_sub_u32 s64, s64, 1
    s_cbranch_scc0 L_lwp_44
    s_branch L_exit
L_lwr_47:
    s_sleep 3
    buffer_load_dword v68, v3, s[8:11], s65 offen sc1
    s_waitcnt vmcnt(0)
    s_sub_u32 s64, s64, 1
    s_cbranch_scc0 L_lwp_46
    s_branch L_exit
L_lwr_49:
    s_sleep 3
    buffer_load_dword v68, v3, s[8:11], s65 offen sc1
    s_waitcnt vmcnt(0)
    s_sub_u32 s64, s64, 1
    s_cbranch_scc0 L_lwp_48
    s_branch L_exit
L_lwr_51:
    s_sleep 3
    buffer_load_dword v68, v3, s[8:11], s65 offen sc1
    s_waitcnt vmcnt(0)
    s_sub_u32 s64, s64, 1
    s_cbranch_scc0 L_lwp_50
    s_branch L_exit
L_lwr_53:
    s_sleep 3
    buffer_load_dword v68, v3, s[8:11], s65 offen sc1
    s_waitcnt vmcnt(0)
    s_sub_u32 s64, s64, 1
    s_cbranch_scc0 L_lwp_52
    s_branch L_exit
L_lwr_55:
    s_sleep 3
    buffer_load_dword v68, v3, s[8:11], s65 offen sc1
    s_waitcnt vmcnt(0)
    s_sub_u32 s64, s64, 1
    s_cbranch_scc0 L_lwp_54
    s_branch L_exit
L_lwr_57:
    s_sleep 3
    buffer_load_dword v68, v3, s[8:11], s65 offen sc1
    s_waitcnt vmcnt(0)
    s_sub_u32 s64, s64, 1
    s_cbranch_scc0 L_lwp_56
    s_branch L_exit
L_lwr_59:
    s_sleep 3
    buffer_load_dword v68, v3, s[8:11], s65 offen sc1
    s_waitcnt vmcnt(0)
    s_sub_u32 s64, s64, 1
    s_cbranch_scc0 L_lwp_58
    s_branch L_exit
L_lwr_61:
    s_sleep 3
    buffer_load_dword v68, v3, s[8:11], s65 offen sc1
    s_waitcnt vmcnt(0)
    s_sub_u32 s64, s64, 1
    s_cbranch_scc0 L_lwp_60
    s_branch L_exit
L_lwr_63:
    s_sleep 3
    buffer_load_dword v68, v3, s[8:11], s65 offen sc1
    s_waitcnt vmcnt(0)
    s_sub_u32 s64, s64, 1
    s_cbranch_scc0 L_lwp_62
    s_branch L_exit
L_lwr_65:
    s_sleep 3
    buffer_load_dword v68, v3, s[8:11], s65 offen sc1
    s_waitcnt vmcnt(0)
    s_sub_u32 s64, s64, 1
    s_cbranch_scc0 L_lwp_64
    s_branch L_exit
L_lwr_67:
    s_sleep 3
    buffer_load_dword v68, v3, s[8:11], s65 offen sc1
    s_waitcnt vmcnt(0)
    s_sub_u32 s64, s64, 1
    s_cbranch_scc0 L_lwp_66
    s_branch L_exit
L_lwr_69:
    s_sleep 3
    buffer_load_dword v68, v3, s[8:11], s65 offen sc1
    s_waitcnt vmcnt(0)
    s_sub_u32 s64, s64, 1
    s_cbranch_scc0 L_lwp_68
    s_branch L_exit
L_lwr_71:
    s_sleep 3
    buffer_load_dword v68, v3, s[8:11], s65 offen sc1
    s_waitcnt vmcnt(0)
    s_sub_u32 s64, s64, 1
    s_cbranch_scc0 L_lwp_70
    s_branch L_exit
L_lwr_73:
    s_sleep 3
    buffer_load_dword v68, v3, s[8:11], s65 offen sc1
    s_waitcnt vmcnt(0)
    s_sub_u32 s64, s64, 1
    s_cbranch_scc0 L_lwp_72
    s_branch L_exit
L_lwr_75:
    s_sleep 3
    buffer_load_dword v68, v3, s[8:11], s65 offen sc1
    s_waitcnt vmcnt(0)
    s_sub_u32 s64, s64, 1
    s_cbranch_scc0 L_lwp_74
    s_branch L_exit
L_lwr_77:
    s_sleep 3
    buffer_load_dword v68, v3, s[8:11], s65 offen sc1
    s_waitcnt vmcnt(0)
    s_sub_u32 s64, s64, 1
    s_cbranch_scc0 L_lwp_76
    s_branch L_exit
L_lwr_79:
    s_sleep 3
    buffer_load_dword v68, v3, s[8:11], s65 offen sc1
    s_waitcnt vmcnt(0)
    s_sub_u32 s64, s64, 1
    s_cbranch_scc0 L_lwp_78
    s_branch L_exit
L_lwr_81:
    s_sleep 3
    buffer_load_dword v68, v3, s[8:11], s65 offen sc1
    s_waitcnt vmcnt(0)
    s_sub_u32 s64, s64, 1
    s_cbranch_scc0 L_lwp_80
    s_branch L_exit
L_lwr_83:
    s_sleep 3
    buffer_load_dword v68, v3, s[8:11], s65 offen sc1
    s_waitcnt vmcnt(0)
    s_sub_u32 s64, s64, 1
    s_cbranch_scc0 L_lwp_82
    s_branch L_exit
L_lwr_85:
    s_sleep 3
    buffer_load_dword v68, v3, s[8:11], s65 offen sc1
    s_waitcnt vmcnt(0)
    s_sub_u32 s64, s64, 1
    s_cbranch_scc0 L_lwp_84
    s_branch L_exit
L_lwr_87:
    s_sleep 3
    buffer_load_dword v68, v3, s[8:11], s65 offen sc1
    s_waitcnt vmcnt(0)
    s_sub_u32 s64, s64, 1
    s_cbranch_scc0 L_lwp_86
    s_branch L_exit
L_lwr_89:
    s_sleep 3
    buffer_load_dword v68, v3, s[8:11], s65 offen sc1
    s_waitcnt vmcnt(0)
    s_sub_u32 s64, s64, 1
    s_cbranch_scc0 L_lwp_88
    s_branch L_exit
L_lwr_91:
    s_sleep 3
    buffer_load_dword v68, v3, s[8:11], s65 offen sc1
    s_waitcnt vmcnt(0)
    s_sub_u32 s64, s64, 1
    s_cbranch_scc0 L_lwp_90
    s_branch L_exit
L_lwr_93:
    s_sleep 3
    buffer_load_dword v68, v3, s[8:11], s65 offen sc1
    s_waitcnt vmcnt(0)
    s_sub_u32 s64, s64, 1
    s_cbranch_scc0 L_lwp_92
    s_branch L_exit
L_lwr_95:
    s_sleep 3
    buffer_load_dword v68, v3, s[8:11], s65 offen sc1
    s_waitcnt vmcnt(0)
    s_sub_u32 s64, s64, 1
    s_cbranch_scc0 L_lwp_94
    s_branch L_exit
L_lwr_97:
    s_sleep 3
    buffer_load_dword v68, v3, s[8:11], s65 offen sc1
    s_waitcnt vmcnt(0)
    s_sub_u32 s64, s64, 1
    s_cbranch_scc0 L_lwp_96
    s_branch L_exit
L_lwr_99:
    s_sleep 3
    buffer_load_dword v68, v3, s[8:11], s65 offen sc1
    s_waitcnt vmcnt(0)
    s_sub_u32 s64, s64, 1
    s_cbranch_scc0 L_lwp_98
    s_branch L_exit
L_lwr_101:
    s_sleep 3
    buffer_load_dword v68, v3, s[8:11], s65 offen sc1
    s_waitcnt vmcnt(0)
    s_sub_u32 s64, s64, 1
    s_cbranch_scc0 L_lwp_100
    s_branch L_exit
L_lwr_103:
    s_sleep 3
    buffer_load_dword v68, v3, s[8:11], s65 offen sc1
    s_waitcnt vmcnt(0)
    s_sub_u32 s64, s64, 1
    s_cbranch_scc0 L_lwp_102
    s_branch L_exit
L_lwr_105:
    s_sleep 3
    buffer_load_dword v68, v3, s[8:11], s65 offen sc1
    s_waitcnt vmcnt(0)
    s_sub_u32 s64, s64, 1
    s_cbranch_scc0 L_lwp_104
    s_branch L_exit
L_lwr_107:
    s_sleep 3
    buffer_load_dword v68, v3, s[8:11], s65 offen sc1
    s_waitcnt vmcnt(0)
    s_sub_u32 s64, s64, 1
    s_cbranch_scc0 L_lwp_106
    s_branch L_exit
L_lwr_109:
    s_sleep 3
    buffer_load_dword v68, v3, s[8:11], s65 offen sc1
    s_waitcnt vmcnt(0)
    s_sub_u32 s64, s64, 1
    s_cbranch_scc0 L_lwp_108
    s_branch L_exit
L_lwr_111:
    s_sleep 3
    buffer_load_dword v68, v3, s[8:11], s65 offen sc1
    s_waitcnt vmcnt(0)
    s_sub_u32 s64, s64, 1
    s_cbranch_scc0 L_lwp_110
    s_branch L_exit
L_lwr_113:
    s_sleep 3
    buffer_load_dword v68, v3, s[8:11], s65 offen sc1
    s_waitcnt vmcnt(0)
    s_sub_u32 s64, s64, 1
    s_cbranch_scc0 L_lwp_112
    s_branch L_exit
L_lwr_115:
    s_sleep 3
    buffer_load_dword v68, v3, s[8:11], s65 offen sc1
    s_waitcnt vmcnt(0)
    s_sub_u32 s64, s64, 1
    s_cbranch_scc0 L_lwp_114
    s_branch L_exit
L_lwr_117:
    s_sleep 3
    buffer_load_dword v68, v3, s[8:11], s65 offen sc1
    s_waitcnt vmcnt(0)
    s_sub_u32 s64, s64, 1
    s_cbranch_scc0 L_lwp_116
    s_branch L_exit
L_lwr_119:
    s_sleep 3
    buffer_load_dword v68, v3, s[8:11], s65 offen sc1
    s_waitcnt vmcnt(0)
    s_sub_u32 s64, s64, 1
    s_cbranch_scc0 L_lwp_118
    s_branch L_exit
L_lwr_121:
    s_sleep 3
    buffer_load_dword v68, v3, s[8:11], s65 offen sc1
    s_waitcnt vmcnt(0)
    s_sub_u32 s64, s64, 1
    s_cbranch_scc0 L_lwp_120
    s_branch L_exit
L_lwr_123:
    s_sleep 3
    buffer_load_dword v68, v3, s[8:11], s65 offen sc1
    s_waitcnt vmcnt(0)
    s_sub_u32 s64, s64, 1
    s_cbranch_scc0 L_lwp_122
    s_branch L_exit
L_lwr_125:
    s_sleep 3
    buffer_load_dword v68, v3, s[8:11], s65 offen sc1
    s_waitcnt vmcnt(0)
    s_sub_u32 s64, s64, 1
    s_cbranch_scc0 L_lwp_124
    s_branch L_exit
L_lwr_127:
    s_sleep 3
    buffer_load_dword v68, v3, s[8:11], s65 offen sc1
    s_waitcnt vmcnt(0)
    s_sub_u32 s64, s64, 1
    s_cbranch_scc0 L_lwp_126
    s_branch L_exit
L_lwr_129:
    s_sleep 3
    buffer_load_dword v68, v3, s[8:11], s65 offen sc1
    s_waitcnt vmcnt(0)
    s_sub_u32 s64, s64, 1
    s_cbranch_scc0 L_lwp_128
    s_branch L_exit
L_lwr_131:
    s_sleep 3
    buffer_load_dword v68, v3, s[8:11], s65 offen sc1
    s_waitcnt vmcnt(0)
    s_sub_u32 s64, s64, 1
    s_cbranch_scc0 L_lwp_130
    s_branch L_exit
L_lwr_133:
    s_sleep 3
    buffer_load_dword v68, v3, s[8:11], s65 offen sc1
    s_waitcnt vmcnt(0)
    s_sub_u32 s64, s64, 1
    s_cbranch_scc0 L_lwp_132
    s_branch L_exit
L_lwr_135:
    s_sleep 3
    buffer_load_dword v68, v3, s[8:11], s65 offen sc1
    s_waitcnt vmcnt(0)
    s_sub_u32 s64, s64, 1
    s_cbranch_scc0 L_lwp_134
    s_branch L_exit
L_lwr_137:
    s_sleep 3
    buffer_load_dword v68, v3, s[8:11], s65 offen sc1
    s_waitcnt vmcnt(0)
    s_sub_u32 s64, s64, 1
    s_cbranch_scc0 L_lwp_136
    s_branch L_exit
L_lwr_139:
    s_sleep 3
    buffer_load_dword v68, v3, s[8:11], s65 offen sc1
    s_waitcnt vmcnt(0)
    s_sub_u32 s64, s64, 1
    s_cbranch_scc0 L_lwp_138
    s_branch L_exit
L_retry_141:
    s_sleep 8
    s_sub_u32 s64, s64, 1
    s_cbranch_scc0 L_gw_140
    s_branch L_exit
L_retry_142:
    buffer_load_dwordx4 v[44:47], v73, s[8:11], s71 offen offset:3072 sc1
    buffer_load_dwordx4 v[48:51], v73, s[8:11], s86 offen offset:0 sc1
    buffer_load_dwordx4 v[52:55], v73, s[8:11], s86 offen offset:1024 sc1
    buffer_load_dwordx4 v[56:59], v73, s[8:11], s86 offen offset:2048 sc1
    s_mov_b32 m0, 0
    s_nop 0
    buffer_load_dwordx4 v73, s[8:11], s71 offen offset:3072 sc1 lds
    s_mov_b32 m0, 4096
    s_nop 0
    buffer_load_dwordx4 v73, s[8:11], s86 offen offset:0 sc1 lds
    buffer_load_dwordx4 v73, s[8:11], s86 offen offset:1024 sc1 lds
    buffer_load_dwordx4 v73, s[8:11], s86 offen offset:2048 sc1 lds
    v_mov_b32 v4, 0
    v_mov_b32 v5, 0
    v_mov_b32 v6, 0
    v_mov_b32 v7, 0
    v_mov_b32 v8, 0
    v_mov_b32 v9, 0
    v_mov_b32 v10, 0
    v_mov_b32 v11, 0
    v_mov_b32 v12, 0
    v_mov_b32 v13, 0
    v_mov_b32 v14, 0
    v_mov_b32 v15, 0
    v_mov_b32 v16, 0
    v_mov_b32 v17, 0
    v_mov_b32 v18, 0
    v_mov_b32 v19, 0
    s_waitcnt vmcnt(0)
    s_sub_u32 s64, s64, 1
    s_cbranch_scc0 L_s0_x
    s_branch L_exit
L_retry_143:
    s_sub_u32 s64, s64, 1
    s_cbranch_scc0 L_s0_y
    s_branch L_exit
L_retry_145:
    buffer_load_dwordx4 v[32:35], v73, s[8:11], s71 offen offset:0 sc1
    buffer_load_dwordx4 v[36:39], v73, s[8:11], s71 offen offset:1024 sc1
    buffer_load_dwordx4 v[40:43], v73, s[8:11], s71 offen offset:2048 sc1
    v_mov_b32 v0, 0
    v_mov_b32 v1, 0
    v_mov_b32 v2, 0
    v_mov_b32 v3, 0
    v_mov_b32 v4, 0
    v_mov_b32 v5, 0
    v_mov_b32 v6, 0
    v_mov_b32 v7, 0
    v_mov_b32 v8, 0
    v_mov_b32 v9, 0
    v_mov_b32 v10, 0
    v_mov_b32 v11, 0
    v_mov_b32 v12, 0
    v_mov_b32 v13, 0
    v_mov_b32 v14, 0
    v_mov_b32 v15, 0
    v_mov_b32 v16, 0
    v_mov_b32 v17, 0
    v_mov_b32 v18, 0
    v_mov_b32 v19, 0
    v_mov_b32 v20, 0
    v_mov_b32 v21, 0
    v_mov_b32 v22, 0
    v_mov_b32 v23, 0
    v_mov_b32 v24, 0
    v_mov_b32 v25, 0
    v_mov_b32 v26, 0
    v_mov_b32 v27, 0
    v_mov_b32 v28, 0
    v_mov_b32 v29, 0
    v_mov_b32 v30, 0
    v_mov_b32 v31, 0
    s_sub_u32 s64, s64, 1
    s_cbranch_scc0 L_lk_144
    s_branch L_exit
L_retry_148:
    s_sub_u32 s64, s64, 1
    s_cbranch_scc0 L_hint_146
    s_branch L_exit
L_retry_150:
    buffer_load_dwordx4 v[32:35], v73, s[8:11], s71 offen offset:0 sc1
    buffer_load_dwordx4 v[36:39], v73, s[8:11], s71 offen offset:1024 sc1
    buffer_load_dwordx4 v[40:43], v73, s[8:11], s71 offen offset:2048 sc1
    v_mov_b32 v0, 0
    v_mov_b32 v1, 0
    v_mov_b32 v2, 0
    v_mov_b32 v3, 0
    v_mov_b32 v4, 0
    v_mov_b32 v5, 0
    v_mov_b32 v6, 0
    v_mov_b32 v7, 0
    v_mov_b32 v8, 0
    v_mov_b32 v9, 0
    v_mov_b32 v10, 0
    v_mov_b32 v11, 0
    v_mov_b32 v12, 0
    v_mov_b32 v13, 0
    v_mov_b32 v14, 0
    v_mov_b32 v15, 0
    v_mov_b32 v16, 0
    v_mov_b32 v17, 0
    v_mov_b32 v18, 0
    v_mov_b32 v19, 0
    v_mov_b32 v20, 0
    v_mov_b32 v21, 0
    v_mov_b32 v22, 0
    v_mov_b32 v23, 0
    v_mov_b32 v24, 0
    v_mov_b32 v25, 0
    v_mov_b32 v26, 0
    v_mov_b32 v27, 0
    v_mov_b32 v28, 0
    v_mov_b32 v29, 0
    v_mov_b32 v30, 0
    v_mov_b32 v31, 0
    s_sub_u32 s64, s64, 1
    s_cbranch_scc0 L_lk_149
    s_branch L_exit
L_retry_152:
    buffer_load_dwordx4 v[32:35], v73, s[8:11], s71 offen offset:0 sc1
    buffer_load_dwordx4 v[36:39], v73, s[8:11], s71 offen offset:1024 sc1
    buffer_load_dwordx4 v[40:43], v73, s[8:11], s71 offen offset:2048 sc1
    v_mov_b32 v0, 0
    v_mov_b32 v1, 0
    v_mov_b32 v2, 0
    v_mov_b32 v3, 0
    v_mov_b32 v4, 0
    v_mov_b32 v5, 0
    v_mov_b32 v6, 0
    v_mov_b32 v7, 0
    v_mov_b32 v8, 0
    v_mov_b32 v9, 0
    v_mov_b32 v10, 0
    v_mov_b32 v11, 0
    v_mov_b32 v12, 0
    v_mov_b32 v13, 0
    v_mov_b32 v14, 0
    v_mov_b32 v15, 0
    v_mov_b32 v16, 0
    v_mov_b32 v17, 0
    v_mov_b32 v18, 0
    v_mov_b32 v19, 0
    v_mov_b32 v20, 0
    v_mov_b32 v21, 0
    v_mov_b32 v22, 0
    v_mov_b32 v23, 0
    v_mov_b32 v24, 0
    v_mov_b32 v25, 0
    v_mov_b32 v26, 0
    v_mov_b32 v27, 0
    v_mov_b32 v28, 0
    v_mov_b32 v29, 0
    v_mov_b32 v30, 0
    v_mov_b32 v31, 0
    s_sub_u32 s64, s64, 1
    s_cbranch_scc0 L_lk_151
    s_branch L_exit
L_value:
    s_sub_u32 s69, s62, 16
    v_mov_b32 v70, 0
    v_bfe_u32 v1, v255, 0, 6
    v_lshl_add_u32 v70, v1, 4, v70
    s_lshl_b32 s96, s60, 13
    s_add_u32 s96, s96, 114688
    s_lshl_b32 s65, s60, 11
    s_add_u32 s65, s65, 147456
    v_add_u32 v71, s65, v70
    v_add_u32 v72, 114688, v70
    s_mul_i32 s65, s60, 20480
    s_add_u32 s65, s65, 32768
    v_add_u32 v74, s65, v70
    s_lshl_b32 s65, s69, 9
    s_cmp_eq_u32 s60, 0
    s_cselect_b32 s65, s65, 0x70000000
    v_mov_b32 v73, s65
    v_bfe_u32 v1, v255, 3, 1
    v_lshl_add_u32 v73, v1, 8, v73
    v_bfe_u32 v1, v255, 2, 1
    v_lshl_add_u32 v73, v1, 5, v73
    v_bfe_u32 v1, v255, 0, 2
    v_lshl_add_u32 v73, v1, 2, v73
    v_bfe_u32 v1, v255, 5, 1
    v_lshl_add_u32 v73, v1, 6, v73
    v_bfe_u32 v1, v255, 4, 1
    v_lshl_add_u32 v73, v1, 4, v73
    v_mov_b32 v79, s65
    v_bfe_u32 v1, v255, 2, 2
    v_lshl_add_u32 v79, v1, 7, v79
    v_bfe_u32 v1, v255, 4, 2
    v_lshl_add_u32 v79, v1, 4, v79
    v_bfe_u32 v1, v255, 0, 2
    v_lshl_add_u32 v79, v1, 2, v79
    s_lshl_b32 s65, s69, 6
    v_mov_b32 v2, s65
    v_bfe_u32 v1, v255, 4, 2
    v_mul_u32_u24 v1, 1792, v1
    v_add_u32 v2, v2, v1
    v_bfe_u32 v1, v255, 0, 4
    v_lshl_add_u32 v2, v1, 2, v2
    s_lshl_b32 s84, s69, 2
    s_add_u32 s84, s84, 88211456
    v_lshlrev_b32 v1, 8, v255
    v_mov_b32 v2, 2147483632
    s_cmp_eq_u32 s60, 0
    s_cselect_b32 s65, 4, 0
    v_cmp_gt_u32 vcc, s65, v255
    s_nop 1
    v_cndmask_b32 v76, v2, v1, vcc
    v_mov_b32 v75, 1
    buffer_store_dword v75, v76, s[8:11], s84 offen
    v_min_u32 v1, 18, v255
    v_lshlrev_b32 v77, 2, v1
    v_min_u32 v1, 15, v255
    v_lshlrev_b32 v78, 2, v1
    s_cmp_eq_u32 s60, 2
    s_cselect_b32 s65, 0, 0x70000000
    v_add_u32 v78, s65, v78
    s_waitcnt vmcnt(0) lgkmcnt(0)
    s_barrier
    s_cmp_lg_u32 s60, 0
    s_cbranch_scc1 L_gb_153
    v_mov_b32 v1, 144
    v_mov_b32 v2, 1
    s_mov_b64 exec, 1
    buffer_atomic_add v2, v1, s[20:23], 0 offen
    s_mov_b64 exec, -1
L_gb_153:
    s_lshr_b32 s65, s69, 1
    s_add_u32 s65, s65, 112
    s_mul_i32 s66, s60, 28
    s_add_u32 s65, s65, s66
    v_mov_b32 v8, s65
    v_bfe_u32 v1, v255, 2, 2
    v_mul_u32_u24 v1, 7, v1
    v_add_u32 v8, v8, v1
    v_lshlrev_b32 v8, 6, v8
    v_and_b32 v9, 3, v255
    v_lshl_add_u32 v8, v9, 2, v8
    s_mul_i32 s78, s60, 114688
    s_lshl_b32 s65, s69, 11
    s_add_u32 s78, s78, s65
    s_add_u32 s78, s78, 16777216
    s_mul_i32 s68, s69, 458752
    s_add_u32 s68, s68, 6422528
    s_mul_i32 s65, s60, 8192
    v_mov_b32 v68, v8
    v_mov_b32 v2, 12
    v_bfe_u32 v3, v255, 0, 2
    v_lshl_add_u32 v2, v3, 6, v2
L_wi_154:
    buffer_load_dword v3, v2, s[20:23], 0 offen sc1
    s_waitcnt vmcnt(0)
    v_cmp_gt_u32 vcc, 56, v3
    s_cbranch_vccnz L_retry_155
    v_mov_b32 v3, v68
    v_mov_b32 v1, s65
    v_bfe_u32 v2, v255, 0, 6
    v_lshl_add_u32 v1, v2, 4, v1
    v_add_u32 v2, 4096, v1
    s_mov_b32 s65, s87
    s_add_u32 s66, s65, 0
    s_sub_u32 s67, s66, 7
    s_cmp_ge_u32 s66, 7
    s_cselect_b32 s66, s67, s66
    s_mul_i32 s66, s66, 65536
    s_add_u32 s28, s66, s68
    s_add_u32 s29, s28, 32768
    s_add_u32 s66, s65, 1
    s_sub_u32 s67, s66, 7
    s_cmp_ge_u32 s66, 7
    s_cselect_b32 s66, s67, s66
    s_mul_i32 s66, s66, 65536
    s_add_u32 s30, s66, s68
    s_add_u32 s31, s30, 32768
    s_add_u32 s66, s65, 2
    s_sub_u32 s67, s66, 7
    s_cmp_ge_u32 s66, 7
    s_cselect_b32 s66, s67, s66
    s_mul_i32 s66, s66, 65536
    s_add_u32 s32, s66, s68
    s_add_u32 s33, s32, 32768
    s_add_u32 s66, s65, 3
    s_sub_u32 s67, s66, 7
    s_cmp_ge_u32 s66, 7
    s_cselect_b32 s66, s67, s66
    s_mul_i32 s66, s66, 65536
    s_add_u32 s34, s66, s68
    s_add_u32 s35, s34, 32768
    s_add_u32 s66, s65, 4
    s_sub_u32 s67, s66, 7
    s_cmp_ge_u32 s66, 7
    s_cselect_b32 s66, s67, s66
    s_mul_i32 s66, s66, 65536
    s_add_u32 s36, s66, s68
    s_add_u32 s37, s36, 32768
    s_add_u32 s66, s65, 5
    s_sub_u32 s67, s66, 7
    s_cmp_ge_u32 s66, 7
    s_cselect_b32 s66, s67, s66
    s_mul_i32 s66, s66, 65536
    s_add_u32 s38, s66, s68
    s_add_u32 s39, s38, 32768
    s_add_u32 s66, s65, 6
    s_sub_u32 s67, s66, 7
    s_cmp_ge_u32 s66, 7
    s_cselect_b32 s66, s67, s66
    s_mul_i32 s66, s66, 65536
    s_add_u32 s40, s66, s68
    s_add_u32 s41, s40, 32768
    s_mov_b32 s65, 88276992
    s_cmp_eq_u32 s60, 1
    s_cbranch_scc1 L_lwV1
    s_cmp_eq_u32 s60, 2
    s_cbranch_scc1 L_lwV2
    s_cmp_eq_u32 s60, 3
    s_cbranch_scc1 L_lwV3
L_lwV0:
    buffer_load_dword v68, v3, s[8:11], s65 offen sc1
    s_waitcnt vmcnt(0)
L_lwp_156:
    v_cmp_gt_u32 vcc, 1, v68
    s_nop 0
    s_and_b32 s67, vcc_lo, 0xf
    s_cbranch_scc1 L_lwr_157
    buffer_load_dwordx4 a[0:3], v1, s[8:11], s28 offen offset:0 sc1
    buffer_load_dwordx4 a[48:51], v1, s[8:11], s28 offen offset:1024 sc1
    buffer_load_dwordx4 a[4:7], v1, s[8:11], s29 offen offset:0 sc1
    buffer_load_dwordx4 a[52:55], v1, s[8:11], s29 offen offset:1024 sc1
    buffer_load_dwordx4 a[8:11], v1, s[8:11], s30 offen offset:0 sc1
    buffer_load_dwordx4 a[56:59], v1, s[8:11], s30 offen offset:1024 sc1
    buffer_load_dwordx4 a[12:15], v1, s[8:11], s31 offen offset:0 sc1
    buffer_load_dwordx4 a[60:63], v1, s[8:11], s31 offen offset:1024 sc1
L_lwp_158:
    v_cmp_gt_u32 vcc, 1, v68
    s_nop 0
    s_and_b32 s67, vcc_lo, 0xf0
    s_cbranch_scc1 L_lwr_159
    buffer_load_dwordx4 a[96:99], v1, s[8:11], s28 offen offset:2048 sc1
    buffer_load_dwordx4 a[136:139], v1, s[8:11], s28 offen offset:3072 sc1
    buffer_load_dwordx4 a[100:103], v1, s[8:11], s29 offen offset:2048 sc1
    buffer_load_dwordx4 a[140:143], v1, s[8:11], s29 offen offset:3072 sc1
    buffer_load_dwordx4 a[104:107], v1, s[8:11], s30 offen offset:2048 sc1
    buffer_load_dwordx4 a[144:147], v1, s[8:11], s30 offen offset:3072 sc1
    buffer_load_dwordx4 a[108:111], v1, s[8:11], s31 offen offset:2048 sc1
    buffer_load_dwordx4 a[148:151], v1, s[8:11], s31 offen offset:3072 sc1
L_lwp_160:
    v_cmp_gt_u32 vcc, 1, v68
    s_nop 0
    s_and_b32 s67, vcc_lo, 0xf00
    s_cbranch_scc1 L_lwr_161
    buffer_load_dword v68, v3, s[8:11], s65 offen sc1
    buffer_load_dwordx4 a[184:187], v2, s[8:11], s28 offen offset:0 sc1
    buffer_load_dwordx4 a[232:235], v2, s[8:11], s28 offen offset:1024 sc1
    buffer_load_dwordx4 a[188:191], v2, s[8:11], s29 offen offset:0 sc1
    buffer_load_dwordx4 a[236:239], v2, s[8:11], s29 offen offset:1024 sc1
    buffer_load_dwordx4 a[192:195], v2, s[8:11], s30 offen offset:0 sc1
    buffer_load_dwordx4 a[240:243], v2, s[8:11], s30 offen offset:1024 sc1
    buffer_load_dwordx4 a[196:199], v2, s[8:11], s31 offen offset:0 sc1
    buffer_load_dwordx4 a[244:247], v2, s[8:11], s31 offen offset:1024 sc1
L_lwp_162:
    v_cmp_gt_u32 vcc, 1, v68
    s_nop 0
    s_and_b32 s67, vcc_lo, 0xf000
    s_cbranch_scc1 L_lwr_163
    buffer_load_dwordx4 v[160:163], v2, s[8:11], s28 offen offset:2048 sc1
    buffer_load_dwordx4 v[208:211], v2, s[8:11], s28 offen offset:3072 sc1
    buffer_load_dwordx4 v[164:167], v2, s[8:11], s29 offen offset:2048 sc1
    buffer_load_dwordx4 v[212:215], v2, s[8:11], s29 offen offset:3072 sc1
    buffer_load_dwordx4 v[168:171], v2, s[8:11], s30 offen offset:2048 sc1
    buffer_load_dwordx4 v[216:219], v2, s[8:11], s30 offen offset:3072 sc1
    buffer_load_dwordx4 v[172:175], v2, s[8:11], s31 offen offset:2048 sc1
    buffer_load_dwordx4 v[220:223], v2, s[8:11], s31 offen offset:3072 sc1
    s_waitcnt vmcnt(16)
L_lwp_164:
    v_cmp_gt_u32 vcc, 2, v68
    s_nop 0
    s_and_b32 s67, vcc_lo, 0xf
    s_cbranch_scc1 L_lwr_165
    buffer_load_dwordx4 a[16:19], v1, s[8:11], s32 offen offset:0 sc1
    buffer_load_dwordx4 a[64:67], v1, s[8:11], s32 offen offset:1024 sc1
    buffer_load_dwordx4 a[20:23], v1, s[8:11], s33 offen offset:0 sc1
    buffer_load_dwordx4 a[68:71], v1, s[8:11], s33 offen offset:1024 sc1
    buffer_load_dwordx4 a[24:27], v1, s[8:11], s34 offen offset:0 sc1
    buffer_load_dwordx4 a[72:75], v1, s[8:11], s34 offen offset:1024 sc1
    buffer_load_dwordx4 a[28:31], v1, s[8:11], s35 offen offset:0 sc1
    buffer_load_dwordx4 a[76:79], v1, s[8:11], s35 offen offset:1024 sc1
L_lwp_166:
    v_cmp_gt_u32 vcc, 2, v68
    s_nop 0
    s_and_b32 s67, vcc_lo, 0xf0
    s_cbranch_scc1 L_lwr_167
    buffer_load_dwordx4 a[112:115], v1, s[8:11], s32 offen offset:2048 sc1
    buffer_load_dwordx4 a[152:155], v1, s[8:11], s32 offen offset:3072 sc1
    buffer_load_dwordx4 a[116:119], v1, s[8:11], s33 offen offset:2048 sc1
    buffer_load_dwordx4 a[156:159], v1, s[8:11], s33 offen offset:3072 sc1
    buffer_load_dwordx4 a[120:123], v1, s[8:11], s34 offen offset:2048 sc1
    buffer_load_dwordx4 a[160:163], v1, s[8:11], s34 offen offset:3072 sc1
    buffer_load_dwordx4 a[124:127], v1, s[8:11], s35 offen offset:2048 sc1
    buffer_load_dwordx4 a[164:167], v1, s[8:11], s35 offen offset:3072 sc1
L_lwp_168:
    v_cmp_gt_u32 vcc, 2, v68
    s_nop 0
    s_and_b32 s67, vcc_lo, 0xf00
    s_cbranch_scc1 L_lwr_169
    buffer_load_dword v68, v3, s[8:11], s65 offen sc1
    buffer_load_dwordx4 a[200:203], v2, s[8:11], s32 offen offset:0 sc1
    buffer_load_dwordx4 a[248:251], v2, s[8:11], s32 offen offset:1024 sc1
    buffer_load_dwordx4 a[204:207], v2, s[8:11], s33 offen offset:0 sc1
    buffer_load_dwordx4 a[252:255], v2, s[8:11], s33 offen offset:1024 sc1
    buffer_load_dwordx4 a[208:211], v2, s[8:11], s34 offen offset:0 sc1
    buffer_load_dwordx4 v[144:147], v2, s[8:11], s34 offen offset:1024 sc1
    buffer_load_dwordx4 a[212:215], v2, s[8:11], s35 offen offset:0 sc1
    buffer_load_dwordx4 v[148:151], v2, s[8:11], s35 offen offset:1024 sc1
L_lwp_170:
    v_cmp_gt_u32 vcc, 2, v68
    s_nop 0
    s_and_b32 s67, vcc_lo, 0xf000
    s_cbranch_scc1 L_lwr_171
    buffer_load_dwordx4 v[176:179], v2, s[8:11], s32 offen offset:2048 sc1
    buffer_load_dwordx4 v[224:227], v2, s[8:11], s32 offen offset:3072 sc1
    buffer_load_dwordx4 v[180:183], v2, s[8:11], s33 offen offset:2048 sc1
    buffer_load_dwordx4 v[228:231], v2, s[8:11], s33 offen offset:3072 sc1
    buffer_load_dwordx4 v[184:187], v2, s[8:11], s34 offen offset:2048 sc1
    buffer_load_dwordx4 v[232:235], v2, s[8:11], s34 offen offset:3072 sc1
    buffer_load_dwordx4 v[188:191], v2, s[8:11], s35 offen offset:2048 sc1
    buffer_load_dwordx4 v[236:239], v2, s[8:11], s35 offen offset:3072 sc1
    s_waitcnt vmcnt(16)
L_lwp_172:
    v_cmp_gt_u32 vcc, 3, v68
    s_nop 0
    s_and_b32 s67, vcc_lo, 0xf
    s_cbranch_scc1 L_lwr_173
    buffer_load_dwordx4 a[32:35], v1, s[8:11], s36 offen offset:0 sc1
    buffer_load_dwordx4 a[80:83], v1, s[8:11], s36 offen offset:1024 sc1
    buffer_load_dwordx4 a[36:39], v1, s[8:11], s37 offen offset:0 sc1
    buffer_load_dwordx4 a[84:87], v1, s[8:11], s37 offen offset:1024 sc1
    buffer_load_dwordx4 a[40:43], v1, s[8:11], s38 offen offset:0 sc1
    buffer_load_dwordx4 a[88:91], v1, s[8:11], s38 offen offset:1024 sc1
    buffer_load_dwordx4 a[44:47], v1, s[8:11], s39 offen offset:0 sc1
    buffer_load_dwordx4 a[92:95], v1, s[8:11], s39 offen offset:1024 sc1
L_lwp_174:
    v_cmp_gt_u32 vcc, 3, v68
    s_nop 0
    s_and_b32 s67, vcc_lo, 0xf0
    s_cbranch_scc1 L_lwr_175
    s_add_u32 s66, s36, 2048
    s_mov_b32 m0, 49152
    s_nop 0
    buffer_load_dwordx4 v1, s[8:11], s66 offen sc1 lds
    buffer_load_dwordx4 a[168:171], v1, s[8:11], s36 offen offset:3072 sc1
    s_add_u32 s66, s37, 2048
    s_mov_b32 m0, 50176
    s_nop 0
    buffer_load_dwordx4 v1, s[8:11], s66 offen sc1 lds
    buffer_load_dwordx4 a[172:175], v1, s[8:11], s37 offen offset:3072 sc1
    buffer_load_dwordx4 a[128:131], v1, s[8:11], s38 offen offset:2048 sc1
    buffer_load_dwordx4 a[176:179], v1, s[8:11], s38 offen offset:3072 sc1
    buffer_load_dwordx4 a[132:135], v1, s[8:11], s39 offen offset:2048 sc1
    buffer_load_dwordx4 a[180:183], v1, s[8:11], s39 offen offset:3072 sc1
L_lwp_176:
    v_cmp_gt_u32 vcc, 3, v68
    s_nop 0
    s_and_b32 s67, vcc_lo, 0xf00
    s_cbranch_scc1 L_lwr_177
    buffer_load_dword v68, v3, s[8:11], s65 offen sc1
    buffer_load_dwordx4 a[216:219], v2, s[8:11], s36 offen offset:0 sc1
    s_add_u32 s66, s36, 5120
    s_mov_b32 m0, 51200
    s_nop 0
    buffer_load_dwordx4 v1, s[8:11], s66 offen sc1 lds
    buffer_load_dwordx4 a[220:223], v2, s[8:11], s37 offen offset:0 sc1
    s_add_u32 s66, s37, 5120
    s_mov_b32 m0, 52224
    s_nop 0
    buffer_load_dwordx4 v1, s[8:11], s66 offen sc1 lds
    buffer_load_dwordx4 a[224:227], v2, s[8:11], s38 offen offset:0 sc1
    buffer_load_dwordx4 v[152:155], v2, s[8:11], s38 offen offset:1024 sc1
    buffer_load_dwordx4 a[228:231], v2, s[8:11], s39 offen offset:0 sc1
    buffer_load_dwordx4 v[156:159], v2, s[8:11], s39 offen offset:1024 sc1
L_lwp_178:
    v_cmp_gt_u32 vcc, 3, v68
    s_nop 0
    s_and_b32 s67, vcc_lo, 0xf000
    s_cbranch_scc1 L_lwr_179
    buffer_load_dwordx4 v[192:195], v2, s[8:11], s36 offen offset:2048 sc1
    buffer_load_dwordx4 v[240:243], v2, s[8:11], s36 offen offset:3072 sc1
    buffer_load_dwordx4 v[196:199], v2, s[8:11], s37 offen offset:2048 sc1
    buffer_load_dwordx4 v[244:247], v2, s[8:11], s37 offen offset:3072 sc1
    buffer_load_dwordx4 v[200:203], v2, s[8:11], s38 offen offset:2048 sc1
    buffer_load_dwordx4 v[248:251], v2, s[8:11], s38 offen offset:3072 sc1
    buffer_load_dwordx4 v[204:207], v2, s[8:11], s39 offen offset:2048 sc1
    buffer_load_dwordx4 v[252:255], v2, s[8:11], s39 offen offset:3072 sc1
    s_waitcnt vmcnt(16)
L_lwp_180:
    v_cmp_gt_u32 vcc, 4, v68
    s_nop 0
    s_and_b32 s67, vcc_lo, 0xf
    s_cbranch_scc1 L_lwr_181
    s_add_u32 s66, s40, 0
    s_mov_b32 m0, 32768
    s_nop 0
    buffer_load_dwordx4 v1, s[8:11], s66 offen sc1 lds
    s_add_u32 s66, s40, 1024
    s_mov_b32 m0, 34816
    s_nop 0
    buffer_load_dwordx4 v1, s[8:11], s66 offen sc1 lds
    s_add_u32 s66, s41, 0
    s_mov_b32 m0, 33792
    s_nop 0
    buffer_load_dwordx4 v1, s[8:11], s66 offen sc1 lds
    s_add_u32 s66, s41, 1024
    s_mov_b32 m0, 35840
    s_nop 0
    buffer_load_dwordx4 v1, s[8:11], s66 offen sc1 lds
L_lwp_182:
    v_cmp_gt_u32 vcc, 4, v68
    s_nop 0
    s_and_b32 s67, vcc_lo, 0xf0
    s_cbranch_scc1 L_lwr_183
    s_add_u32 s66, s40, 2048
    s_mov_b32 m0, 36864
    s_nop 0
    buffer_load_dwordx4 v1, s[8:11], s66 offen sc1 lds
    s_add_u32 s66, s40, 3072
    s_mov_b32 m0, 38912
    s_nop 0
    buffer_load_dwordx4 v1, s[8:11], s66 offen sc1 lds
    s_add_u32 s66, s41, 2048
    s_mov_b32 m0, 37888
    s_nop 0
    buffer_load_dwordx4 v1, s[8:11], s66 offen sc1 lds
    s_add_u32 s66, s41, 3072
    s_mov_b32 m0, 39936
    s_nop 0
    buffer_load_dwordx4 v1, s[8:11], s66 offen sc1 lds
L_lwp_184:
    v_cmp_gt_u32 vcc, 4, v68
    s_nop 0
    s_and_b32 s67, vcc_lo, 0xf00
    s_cbranch_scc1 L_lwr_185
    s_add_u32 s66, s40, 4096
    s_mov_b32 m0, 40960
    s_nop 0
    buffer_load_dwordx4 v1, s[8:11], s66 offen sc1 lds
    s_add_u32 s66, s40, 5120
    s_mov_b32 m0, 43008
    s_nop 0
    buffer_load_dwordx4 v1, s[8:11], s66 offen sc1 lds
    s_add_u32 s66, s41, 4096
    s_mov_b32 m0, 41984
    s_nop 0
    buffer_load_dwordx4 v1, s[8:11], s66 offen sc1 lds
    s_add_u32 s66, s41, 5120
    s_mov_b32 m0, 44032
    s_nop 0
    buffer_load_dwordx4 v1, s[8:11], s66 offen sc1 lds
L_lwp_186:
    v_cmp_gt_u32 vcc, 4, v68
    s_nop 0
    s_and_b32 s67, vcc_lo, 0xf000
    s_cbranch_scc1 L_lwr_187
    s_add_u32 s66, s40, 6144
    s_mov_b32 m0, 45056
    s_nop 0
    buffer_load_dwordx4 v1, s[8:11], s66 offen sc1 lds
    s_add_u32 s66, s40, 7168
    s_mov_b32 m0, 47104
    s_nop 0
    buffer_load_dwordx4 v1, s[8:11], s66 offen sc1 lds
    s_add_u32 s66, s41, 6144
    s_mov_b32 m0, 46080
    s_nop 0
    buffer_load_dwordx4 v1, s[8:11], s66 offen sc1 lds
    s_add_u32 s66, s41, 7168
    s_mov_b32 m0, 48128
    s_nop 0
    buffer_load_dwordx4 v1, s[8:11], s66 offen sc1 lds
    s_branch L_lwVE
L_lwV1:
    buffer_load_dword v68, v3, s[8:11], s65 offen sc1
    s_waitcnt vmcnt(0)
L_lwp_188:
    v_cmp_gt_u32 vcc, 1, v68
    s_nop 0
    s_and_b32 s67, vcc_lo, 0xf
    s_cbranch_scc1 L_lwr_189
    buffer_load_dwordx4 a[40:43], v1, s[8:11], s38 offen offset:0 sc1
    buffer_load_dwordx4 a[88:91], v1, s[8:11], s38 offen offset:1024 sc1
    buffer_load_dwordx4 a[44:47], v1, s[8:11], s39 offen offset:0 sc1
    buffer_load_dwordx4 a[92:95], v1, s[8:11], s39 offen offset:1024 sc1
    s_add_u32 s66, s40, 0
    s_mov_b32 m0, 53248
    s_nop 0
    buffer_load_dwordx4 v1, s[8:11], s66 offen sc1 lds
    s_add_u32 s66, s40, 1024
    s_mov_b32 m0, 55296
    s_nop 0
    buffer_load_dwordx4 v1, s[8:11], s66 offen sc1 lds
    s_add_u32 s66, s41, 0
    s_mov_b32 m0, 54272
    s_nop 0
    buffer_load_dwordx4 v1, s[8:11], s66 offen sc1 lds
    s_add_u32 s66, s41, 1024
    s_mov_b32 m0, 56320
    s_nop 0
    buffer_load_dwordx4 v1, s[8:11], s66 offen sc1 lds
L_lwp_190:
    v_cmp_gt_u32 vcc, 1, v68
    s_nop 0
    s_and_b32 s67, vcc_lo, 0xf0
    s_cbranch_scc1 L_lwr_191
    buffer_load_dwordx4 a[128:131], v1, s[8:11], s38 offen offset:2048 sc1
    buffer_load_dwordx4 a[176:179], v1, s[8:11], s38 offen offset:3072 sc1
    buffer_load_dwordx4 a[132:135], v1, s[8:11], s39 offen offset:2048 sc1
    buffer_load_dwordx4 a[180:183], v1, s[8:11], s39 offen offset:3072 sc1
    s_add_u32 s66, s40, 2048
    s_mov_b32 m0, 57344
    s_nop 0
    buffer_load_dwordx4 v1, s[8:11], s66 offen sc1 lds
    s_add_u32 s66, s40, 3072
    s_mov_b32 m0, 59392
    s_nop 0
    buffer_load_dwordx4 v1, s[8:11], s66 offen sc1 lds
    s_add_u32 s66, s41, 2048
    s_mov_b32 m0, 58368
    s_nop 0
    buffer_load_dwordx4 v1, s[8:11], s66 offen sc1 lds
    s_add_u32 s66, s41, 3072
    s_mov_b32 m0, 60416
    s_nop 0
    buffer_load_dwordx4 v1, s[8:11], s66 offen sc1 lds
L_lwp_192:
    v_cmp_gt_u32 vcc, 1, v68
    s_nop 0
    s_and_b32 s67, vcc_lo, 0xf00
    s_cbranch_scc1 L_lwr_193
    buffer_load_dword v68, v3, s[8:11], s65 offen sc1
    buffer_load_dwordx4 a[224:227], v2, s[8:11], s38 offen offset:0 sc1
    buffer_load_dwordx4 v[152:155], v2, s[8:11], s38 offen offset:1024 sc1
    buffer_load_dwordx4 a[228:231], v2, s[8:11], s39 offen offset:0 sc1
    buffer_load_dwordx4 v[156:159], v2, s[8:11], s39 offen offset:1024 sc1
    s_add_u32 s66, s40, 4096
    s_mov_b32 m0, 61440
    s_nop 0
    buffer_load_dwordx4 v1, s[8:11], s66 offen sc1 lds
    s_add_u32 s66, s40, 5120
    s_mov_b32 m0, 63488
    s_nop 0
    buffer_load_dwordx4 v1, s[8:11], s66 offen sc1 lds
    s_add_u32 s66, s41, 4096
    s_mov_b32 m0, 62464
    s_nop 0
    buffer_load_dwordx4 v1, s[8:11], s66 offen sc1 lds
    s_add_u32 s66, s41, 5120
    s_mov_b32 m0, 64512
    s_nop 0
    buffer_load_dwordx4 v1, s[8:11], s66 offen sc1 lds
L_lwp_194:
    v_cmp_gt_u32 vcc, 1, v68
    s_nop 0
    s_and_b32 s67, vcc_lo, 0xf000
    s_cbranch_scc1 L_lwr_195
    buffer_load_dwordx4 v[200:203], v2, s[8:11], s38 offen offset:2048 sc1
    buffer_load_dwordx4 v[248:251], v2, s[8:11], s38 offen offset:3072 sc1
    buffer_load_dwordx4 v[204:207], v2, s[8:11], s39 offen offset:2048 sc1
    buffer_load_dwordx4 v[252:255], v2, s[8:11], s39 offen offset:3072 sc1
    s_add_u32 s66, s40, 6144
    s_mov_b32 m0, 65536
    s_nop 0
    buffer_load_dwordx4 v1, s[8:11], s66 offen sc1 lds
    s_add_u32 s66, s40, 7168
    s_mov_b32 m0, 67584
    s_nop 0
    buffer_load_dwordx4 v1, s[8:11], s66 offen sc1 lds
    s_add_u32 s66, s41, 6144
    s_mov_b32 m0, 66560
    s_nop 0
    buffer_load_dwordx4 v1, s[8:11], s66 offen sc1 lds
    s_add_u32 s66, s41, 7168
    s_mov_b32 m0, 68608
    s_nop 0
    buffer_load_dwordx4 v1, s[8:11], s66 offen sc1 lds
    s_waitcnt vmcnt(16)
L_lwp_196:
    v_cmp_gt_u32 vcc, 2, v68
    s_nop 0
    s_and_b32 s67, vcc_lo, 0xf
    s_cbranch_scc1 L_lwr_197
    buffer_load_dwordx4 a[0:3], v1, s[8:11], s28 offen offset:0 sc1
    buffer_load_dwordx4 a[48:51], v1, s[8:11], s28 offen offset:1024 sc1
    buffer_load_dwordx4 a[4:7], v1, s[8:11], s29 offen offset:0 sc1
    buffer_load_dwordx4 a[52:55], v1, s[8:11], s29 offen offset:1024 sc1
    buffer_load_dwordx4 a[8:11], v1, s[8:11], s30 offen offset:0 sc1
    buffer_load_dwordx4 a[56:59], v1, s[8:11], s30 offen offset:1024 sc1
    buffer_load_dwordx4 a[12:15], v1, s[8:11], s31 offen offset:0 sc1
    buffer_load_dwordx4 a[60:63], v1, s[8:11], s31 offen offset:1024 sc1
L_lwp_198:
    v_cmp_gt_u32 vcc, 2, v68
    s_nop 0
    s_and_b32 s67, vcc_lo, 0xf0
    s_cbranch_scc1 L_lwr_199
    buffer_load_dwordx4 a[96:99], v1, s[8:11], s28 offen offset:2048 sc1
    buffer_load_dwordx4 a[136:139], v1, s[8:11], s28 offen offset:3072 sc1
    buffer_load_dwordx4 a[100:103], v1, s[8:11], s29 offen offset:2048 sc1
    buffer_load_dwordx4 a[140:143], v1, s[8:11], s29 offen offset:3072 sc1
    buffer_load_dwordx4 a[104:107], v1, s[8:11], s30 offen offset:2048 sc1
    buffer_load_dwordx4 a[144:147], v1, s[8:11], s30 offen offset:3072 sc1
    buffer_load_dwordx4 a[108:111], v1, s[8:11], s31 offen offset:2048 sc1
    buffer_load_dwordx4 a[148:151], v1, s[8:11], s31 offen offset:3072 sc1
L_lwp_200:
    v_cmp_gt_u32 vcc, 2, v68
    s_nop 0
    s_and_b32 s67, vcc_lo, 0xf00
    s_cbranch_scc1 L_lwr_201
    buffer_load_dword v68, v3, s[8:11], s65 offen sc1
    buffer_load_dwordx4 a[184:187], v2, s[8:11], s28 offen offset:0 sc1
    buffer_load_dwordx4 a[232:235], v2, s[8:11], s28 offen offset:1024 sc1
    buffer_load_dwordx4 a[188:191], v2, s[8:11], s29 offen offset:0 sc1
    buffer_load_dwordx4 a[236:239], v2, s[8:11], s29 offen offset:1024 sc1
    buffer_load_dwordx4 a[192:195], v2, s[8:11], s30 offen offset:0 sc1
    buffer_load_dwordx4 a[240:243], v2, s[8:11], s30 offen offset:1024 sc1
    buffer_load_dwordx4 a[196:199], v2, s[8:11], s31 offen offset:0 sc1
    buffer_load_dwordx4 a[244:247], v2, s[8:11], s31 offen offset:1024 sc1
L_lwp_202:
    v_cmp_gt_u32 vcc, 2, v68
    s_nop 0
    s_and_b32 s67, vcc_lo, 0xf000
    s_cbranch_scc1 L_lwr_203
    buffer_load_dwordx4 v[160:163], v2, s[8:11], s28 offen offset:2048 sc1
    buffer_load_dwordx4 v[208:211], v2, s[8:11], s28 offen offset:3072 sc1
    buffer_load_dwordx4 v[164:167], v2, s[8:11], s29 offen offset:2048 sc1
    buffer_load_dwordx4 v[212:215], v2, s[8:11], s29 offen offset:3072 sc1
    buffer_load_dwordx4 v[168:171], v2, s[8:11], s30 offen offset:2048 sc1
    buffer_load_dwordx4 v[216:219], v2, s[8:11], s30 offen offset:3072 sc1
    buffer_load_dwordx4 v[172:175], v2, s[8:11], s31 offen offset:2048 sc1
    buffer_load_dwordx4 v[220:223], v2, s[8:11], s31 offen offset:3072 sc1
    s_waitcnt vmcnt(16)
L_lwp_204:
    v_cmp_gt_u32 vcc, 3, v68
    s_nop 0
    s_and_b32 s67, vcc_lo, 0xf
    s_cbranch_scc1 L_lwr_205
    buffer_load_dwordx4 a[16:19], v1, s[8:11], s32 offen offset:0 sc1
    buffer_load_dwordx4 a[64:67], v1, s[8:11], s32 offen offset:1024 sc1
    buffer_load_dwordx4 a[20:23], v1, s[8:11], s33 offen offset:0 sc1
    buffer_load_dwordx4 a[68:71], v1, s[8:11], s33 offen offset:1024 sc1
    buffer_load_dwordx4 a[24:27], v1, s[8:11], s34 offen offset:0 sc1
    buffer_load_dwordx4 a[72:75], v1, s[8:11], s34 offen offset:1024 sc1
    buffer_load_dwordx4 a[28:31], v1, s[8:11], s35 offen offset:0 sc1
    buffer_load_dwordx4 a[76:79], v1, s[8:11], s35 offen offset:1024 sc1
L_lwp_206:
    v_cmp_gt_u32 vcc, 3, v68
    s_nop 0
    s_and_b32 s67, vcc_lo, 0xf0
    s_cbranch_scc1 L_lwr_207
    buffer_load_dwordx4 a[112:115], v1, s[8:11], s32 offen offset:2048 sc1
    buffer_load_dwordx4 a[152:155], v1, s[8:11], s32 offen offset:3072 sc1
    buffer_load_dwordx4 a[116:119], v1, s[8:11], s33 offen offset:2048 sc1
    buffer_load_dwordx4 a[156:159], v1, s[8:11], s33 offen offset:3072 sc1
    buffer_load_dwordx4 a[120:123], v1, s[8:11], s34 offen offset:2048 sc1
    buffer_load_dwordx4 a[160:163], v1, s[8:11], s34 offen offset:3072 sc1
    buffer_load_dwordx4 a[124:127], v1, s[8:11], s35 offen offset:2048 sc1
    buffer_load_dwordx4 a[164:167], v1, s[8:11], s35 offen offset:3072 sc1
L_lwp_208:
    v_cmp_gt_u32 vcc, 3, v68
    s_nop 0
    s_and_b32 s67, vcc_lo, 0xf00
    s_cbranch_scc1 L_lwr_209
    buffer_load_dword v68, v3, s[8:11], s65 offen sc1
    buffer_load_dwordx4 a[200:203], v2, s[8:11], s32 offen offset:0 sc1
    buffer_load_dwordx4 a[248:251], v2, s[8:11], s32 offen offset:1024 sc1
    buffer_load_dwordx4 a[204:207], v2, s[8:11], s33 offen offset:0 sc1
    buffer_load_dwordx4 a[252:255], v2, s[8:11], s33 offen offset:1024 sc1
    buffer_load_dwordx4 a[208:211], v2, s[8:11], s34 offen offset:0 sc1
    buffer_load_dwordx4 v[144:147], v2, s[8:11], s34 offen offset:1024 sc1
    buffer_load_dwordx4 a[212:215], v2, s[8:11], s35 offen offset:0 sc1
    buffer_load_dwordx4 v[148:151], v2, s[8:11], s35 offen offset:1024 sc1
L_lwp_210:
    v_cmp_gt_u32 vcc, 3, v68
    s_nop 0
    s_and_b32 s67, vcc_lo, 0xf000
    s_cbranch_scc1 L_lwr_211
    buffer_load_dwordx4 v[176:179], v2, s[8:11], s32 offen offset:2048 sc1
    buffer_load_dwordx4 v[224:227], v2, s[8:11], s32 offen offset:3072 sc1
    buffer_load_dwordx4 v[180:183], v2, s[8:11], s33 offen offset:2048 sc1
    buffer_load_dwordx4 v[228:231], v2, s[8:11], s33 offen offset:3072 sc1
    buffer_load_dwordx4 v[184:187], v2, s[8:11], s34 offen offset:2048 sc1
    buffer_load_dwordx4 v[232:235], v2, s[8:11], s34 offen offset:3072 sc1
    buffer_load_dwordx4 v[188:191], v2, s[8:11], s35 offen offset:2048 sc1
    buffer_load_dwordx4 v[236:239], v2, s[8:11], s35 offen offset:3072 sc1
    s_waitcnt vmcnt(16)
L_lwp_212:
    v_cmp_gt_u32 vcc, 4, v68
    s_nop 0
    s_and_b32 s67, vcc_lo, 0xf
    s_cbranch_scc1 L_lwr_213
    buffer_load_dwordx4 a[32:35], v1, s[8:11], s36 offen offset:0 sc1
    buffer_load_dwordx4 a[80:83], v1, s[8:11], s36 offen offset:1024 sc1
    buffer_load_dwordx4 a[36:39], v1, s[8:11], s37 offen offset:0 sc1
    buffer_load_dwordx4 a[84:87], v1, s[8:11], s37 offen offset:1024 sc1
L_lwp_214:
    v_cmp_gt_u32 vcc, 4, v68
    s_nop 0
    s_and_b32 s67, vcc_lo, 0xf0
    s_cbranch_scc1 L_lwr_215
    s_add_u32 s66, s36, 2048
    s_mov_b32 m0, 69632
    s_nop 0
    buffer_load_dwordx4 v1, s[8:11], s66 offen sc1 lds
    buffer_load_dwordx4 a[168:171], v1, s[8:11], s36 offen offset:3072 sc1
    s_add_u32 s66, s37, 2048
    s_mov_b32 m0, 70656
    s_nop 0
    buffer_load_dwordx4 v1, s[8:11], s66 offen sc1 lds
    buffer_load_dwordx4 a[172:175], v1, s[8:11], s37 offen offset:3072 sc1
L_lwp_216:
    v_cmp_gt_u32 vcc, 4, v68
    s_nop 0
    s_and_b32 s67, vcc_lo, 0xf00
    s_cbranch_scc1 L_lwr_217
    buffer_load_dwordx4 a[216:219], v2, s[8:11], s36 offen offset:0 sc1
    s_add_u32 s66, s36, 5120
    s_mov_b32 m0, 71680
    s_nop 0
    buffer_load_dwordx4 v1, s[8:11], s66 offen sc1 lds
    buffer_load_dwordx4 a[220:223], v2, s[8:11], s37 offen offset:0 sc1
    s_add_u32 s66, s37, 5120
    s_mov_b32 m0, 72704
    s_nop 0
    buffer_load_dwordx4 v1, s[8:11], s66 offen sc1 lds
L_lwp_218:
    v_cmp_gt_u32 vcc, 4, v68
    s_nop 0
    s_and_b32 s67, vcc_lo, 0xf000
    s_cbranch_scc1 L_lwr_219
    buffer_load_dwordx4 v[192:195], v2, s[8:11], s36 offen offset:2048 sc1
    buffer_load_dwordx4 v[240:243], v2, s[8:11], s36 offen offset:3072 sc1
    buffer_load_dwordx4 v[196:199], v2, s[8:11], s37 offen offset:2048 sc1
    buffer_load_dwordx4 v[244:247], v2, s[8:11], s37 offen offset:3072 sc1
    s_branch L_lwVE
L_lwV2:
    buffer_load_dword v68, v3, s[8:11], s65 offen sc1
    s_waitcnt vmcnt(0)
L_lwp_220:
    v_cmp_gt_u32 vcc, 1, v68
    s_nop 0
    s_and_b32 s67, vcc_lo, 0xf
    s_cbranch_scc1 L_lwr_221
    buffer_load_dwordx4 a[24:27], v1, s[8:11], s34 offen offset:0 sc1
    buffer_load_dwordx4 a[72:75], v1, s[8:11], s34 offen offset:1024 sc1
    buffer_load_dwordx4 a[28:31], v1, s[8:11], s35 offen offset:0 sc1
    buffer_load_dwordx4 a[76:79], v1, s[8:11], s35 offen offset:1024 sc1
    buffer_load_dwordx4 a[32:35], v1, s[8:11], s36 offen offset:0 sc1
    buffer_load_dwordx4 a[80:83], v1, s[8:11], s36 offen offset:1024 sc1
    buffer_load_dwordx4 a[36:39], v1, s[8:11], s37 offen offset:0 sc1
    buffer_load_dwordx4 a[84:87], v1, s[8:11], s37 offen offset:1024 sc1
L_lwp_222:
    v_cmp_gt_u32 vcc, 1, v68
    s_nop 0
    s_and_b32 s67, vcc_lo, 0xf0
    s_cbranch_scc1 L_lwr_223
    buffer_load_dwordx4 a[120:123], v1, s[8:11], s34 offen offset:2048 sc1
    buffer_load_dwordx4 a[160:163], v1, s[8:11], s34 offen offset:3072 sc1
    buffer_load_dwordx4 a[124:127], v1, s[8:11], s35 offen offset:2048 sc1
    buffer_load_dwordx4 a[164:167], v1, s[8:11], s35 offen offset:3072 sc1
    s_add_u32 s66, s36, 2048
    s_mov_b32 m0, 90112
    s_nop 0
    buffer_load_dwordx4 v1, s[8:11], s66 offen sc1 lds
    buffer_load_dwordx4 a[168:171], v1, s[8:11], s36 offen offset:3072 sc1
    s_add_u32 s66, s37, 2048
    s_mov_b32 m0, 91136
    s_nop 0
    buffer_load_dwordx4 v1, s[8:11], s66 offen sc1 lds
    buffer_load_dwordx4 a[172:175], v1, s[8:11], s37 offen offset:3072 sc1
L_lwp_224:
    v_cmp_gt_u32 vcc, 1, v68
    s_nop 0
    s_and_b32 s67, vcc_lo, 0xf00
    s_cbranch_scc1 L_lwr_225
    buffer_load_dword v68, v3, s[8:11], s65 offen sc1
    buffer_load_dwordx4 a[208:211], v2, s[8:11], s34 offen offset:0 sc1
    buffer_load_dwordx4 v[144:147], v2, s[8:11], s34 offen offset:1024 sc1
    buffer_load_dwordx4 a[212:215], v2, s[8:11], s35 offen offset:0 sc1
    buffer_load_dwordx4 v[148:151], v2, s[8:11], s35 offen offset:1024 sc1
    buffer_load_dwordx4 a[216:219], v2, s[8:11], s36 offen offset:0 sc1
    s_add_u32 s66, s36, 5120
    s_mov_b32 m0, 92160
    s_nop 0
    buffer_load_dwordx4 v1, s[8:11], s66 offen sc1 lds
    buffer_load_dwordx4 a[220:223], v2, s[8:11], s37 offen offset:0 sc1
    s_add_u32 s66, s37, 5120
    s_mov_b32 m0, 93184
    s_nop 0
    buffer_load_dwordx4 v1, s[8:11], s66 offen sc1 lds
L_lwp_226:
    v_cmp_gt_u32 vcc, 1, v68
    s_nop 0
    s_and_b32 s67, vcc_lo, 0xf000
    s_cbranch_scc1 L_lwr_227
    buffer_load_dwordx4 v[184:187], v2, s[8:11], s34 offen offset:2048 sc1
    buffer_load_dwordx4 v[232:235], v2, s[8:11], s34 offen offset:3072 sc1
    buffer_load_dwordx4 v[188:191], v2, s[8:11], s35 offen offset:2048 sc1
    buffer_load_dwordx4 v[236:239], v2, s[8:11], s35 offen offset:3072 sc1
    buffer_load_dwordx4 v[192:195], v2, s[8:11], s36 offen offset:2048 sc1
    buffer_load_dwordx4 v[240:243], v2, s[8:11], s36 offen offset:3072 sc1
    buffer_load_dwordx4 v[196:199], v2, s[8:11], s37 offen offset:2048 sc1
    buffer_load_dwordx4 v[244:247], v2, s[8:11], s37 offen offset:3072 sc1
    s_waitcnt vmcnt(16)
L_lwp_228:
    v_cmp_gt_u32 vcc, 2, v68
    s_nop 0
    s_and_b32 s67, vcc_lo, 0xf
    s_cbranch_scc1 L_lwr_229
    buffer_load_dwordx4 a[40:43], v1, s[8:11], s38 offen offset:0 sc1
    buffer_load_dwordx4 a[88:91], v1, s[8:11], s38 offen offset:1024 sc1
    buffer_load_dwordx4 a[44:47], v1, s[8:11], s39 offen offset:0 sc1
    buffer_load_dwordx4 a[92:95], v1, s[8:11], s39 offen offset:1024 sc1
    s_add_u32 s66, s40, 0
    s_mov_b32 m0, 73728
    s_nop 0
    buffer_load_dwordx4 v1, s[8:11], s66 offen sc1 lds
    s_add_u32 s66, s40, 1024
    s_mov_b32 m0, 75776
    s_nop 0
    buffer_load_dwordx4 v1, s[8:11], s66 offen sc1 lds
    s_add_u32 s66, s41, 0
    s_mov_b32 m0, 74752
    s_nop 0
    buffer_load_dwordx4 v1, s[8:11], s66 offen sc1 lds
    s_add_u32 s66, s41, 1024
    s_mov_b32 m0, 76800
    s_nop 0
    buffer_load_dwordx4 v1, s[8:11], s66 offen sc1 lds
L_lwp_230:
    v_cmp_gt_u32 vcc, 2, v68
    s_nop 0
    s_and_b32 s67, vcc_lo, 0xf0
    s_cbranch_scc1 L_lwr_231
    buffer_load_dwordx4 a[128:131], v1, s[8:11], s38 offen offset:2048 sc1
    buffer_load_dwordx4 a[176:179], v1, s[8:11], s38 offen offset:3072 sc1
    buffer_load_dwordx4 a[132:135], v1, s[8:11], s39 offen offset:2048 sc1
    buffer_load_dwordx4 a[180:183], v1, s[8:11], s39 offen offset:3072 sc1
    s_add_u32 s66, s40, 2048
    s_mov_b32 m0, 77824
    s_nop 0
    buffer_load_dwordx4 v1, s[8:11], s66 offen sc1 lds
    s_add_u32 s66, s40, 3072
    s_mov_b32 m0, 79872
    s_nop 0
    buffer_load_dwordx4 v1, s[8:11], s66 offen sc1 lds
    s_add_u32 s66, s41, 2048
    s_mov_b32 m0, 78848
    s_nop 0
    buffer_load_dwordx4 v1, s[8:11], s66 offen sc1 lds
    s_add_u32 s66, s41, 3072
    s_mov_b32 m0, 80896
    s_nop 0
    buffer_load_dwordx4 v1, s[8:11], s66 offen sc1 lds
L_lwp_232:
    v_cmp_gt_u32 vcc, 2, v68
    s_nop 0
    s_and_b32 s67, vcc_lo, 0xf00
    s_cbranch_scc1 L_lwr_233
    buffer_load_dword v68, v3, s[8:11], s65 offen sc1
    buffer_load_dwordx4 a[224:227], v2, s[8:11], s38 offen offset:0 sc1
    buffer_load_dwordx4 v[152:155], v2, s[8:11], s38 offen offset:1024 sc1
    buffer_load_dwordx4 a[228:231], v2, s[8:11], s39 offen offset:0 sc1
    buffer_load_dwordx4 v[156:159], v2, s[8:11], s39 offen offset:1024 sc1
    s_add_u32 s66, s40, 4096
    s_mov_b32 m0, 81920
    s_nop 0
    buffer_load_dwordx4 v1, s[8:11], s66 offen sc1 lds
    s_add_u32 s66, s40, 5120
    s_mov_b32 m0, 83968
    s_nop 0
    buffer_load_dwordx4 v1, s[8:11], s66 offen sc1 lds
    s_add_u32 s66, s41, 4096
    s_mov_b32 m0, 82944
    s_nop 0
    buffer_load_dwordx4 v1, s[8:11], s66 offen sc1 lds
    s_add_u32 s66, s41, 5120
    s_mov_b32 m0, 84992
    s_nop 0
    buffer_load_dwordx4 v1, s[8:11], s66 offen sc1 lds
L_lwp_234:
    v_cmp_gt_u32 vcc, 2, v68
    s_nop 0
    s_and_b32 s67, vcc_lo, 0xf000
    s_cbranch_scc1 L_lwr_235
    buffer_load_dwordx4 v[200:203], v2, s[8:11], s38 offen offset:2048 sc1
    buffer_load_dwordx4 v[248:251], v2, s[8:11], s38 offen offset:3072 sc1
    buffer_load_dwordx4 v[204:207], v2, s[8:11], s39 offen offset:2048 sc1
    buffer_load_dwordx4 v[252:255], v2, s[8:11], s39 offen offset:3072 sc1
    s_add_u32 s66, s40, 6144
    s_mov_b32 m0, 86016
    s_nop 0
    buffer_load_dwordx4 v1, s[8:11], s66 offen sc1 lds
    s_add_u32 s66, s40, 7168
    s_mov_b32 m0, 88064
    s_nop 0
    buffer_load_dwordx4 v1, s[8:11], s66 offen sc1 lds
    s_add_u32 s66, s41, 6144
    s_mov_b32 m0, 87040
    s_nop 0
    buffer_load_dwordx4 v1, s[8:11], s66 offen sc1 lds
    s_add_u32 s66, s41, 7168
    s_mov_b32 m0, 89088
    s_nop 0
    buffer_load_dwordx4 v1, s[8:11], s66 offen sc1 lds
    s_waitcnt vmcnt(16)
L_lwp_236:
    v_cmp_gt_u32 vcc, 3, v68
    s_nop 0
    s_and_b32 s67, vcc_lo, 0xf
    s_cbranch_scc1 L_lwr_237
    buffer_load_dwordx4 a[0:3], v1, s[8:11], s28 offen offset:0 sc1
    buffer_load_dwordx4 a[48:51], v1, s[8:11], s28 offen offset:1024 sc1
    buffer_load_dwordx4 a[4:7], v1, s[8:11], s29 offen offset:0 sc1
    buffer_load_dwordx4 a[52:55], v1, s[8:11], s29 offen offset:1024 sc1
    buffer_load_dwordx4 a[8:11], v1, s[8:11], s30 offen offset:0 sc1
    buffer_load_dwordx4 a[56:59], v1, s[8:11], s30 offen offset:1024 sc1
    buffer_load_dwordx4 a[12:15], v1, s[8:11], s31 offen offset:0 sc1
    buffer_load_dwordx4 a[60:63], v1, s[8:11], s31 offen offset:1024 sc1
L_lwp_238:
    v_cmp_gt_u32 vcc, 3, v68
    s_nop 0
    s_and_b32 s67, vcc_lo, 0xf0
    s_cbranch_scc1 L_lwr_239
    buffer_load_dwordx4 a[96:99], v1, s[8:11], s28 offen offset:2048 sc1
    buffer_load_dwordx4 a[136:139], v1, s[8:11], s28 offen offset:3072 sc1
    buffer_load_dwordx4 a[100:103], v1, s[8:11], s29 offen offset:2048 sc1
    buffer_load_dwordx4 a[140:143], v1, s[8:11], s29 offen offset:3072 sc1
    buffer_load_dwordx4 a[104:107], v1, s[8:11], s30 offen offset:2048 sc1
    buffer_load_dwordx4 a[144:147], v1, s[8:11], s30 offen offset:3072 sc1
    buffer_load_dwordx4 a[108:111], v1, s[8:11], s31 offen offset:2048 sc1
    buffer_load_dwordx4 a[148:151], v1, s[8:11], s31 offen offset:3072 sc1
L_lwp_240:
    v_cmp_gt_u32 vcc, 3, v68
    s_nop 0
    s_and_b32 s67, vcc_lo, 0xf00
    s_cbranch_scc1 L_lwr_241
    buffer_load_dword v68, v3, s[8:11], s65 offen sc1
    buffer_load_dwordx4 a[184:187], v2, s[8:11], s28 offen offset:0 sc1
    buffer_load_dwordx4 a[232:235], v2, s[8:11], s28 offen offset:1024 sc1
    buffer_load_dwordx4 a[188:191], v2, s[8:11], s29 offen offset:0 sc1
    buffer_load_dwordx4 a[236:239], v2, s[8:11], s29 offen offset:1024 sc1
    buffer_load_dwordx4 a[192:195], v2, s[8:11], s30 offen offset:0 sc1
    buffer_load_dwordx4 a[240:243], v2, s[8:11], s30 offen offset:1024 sc1
    buffer_load_dwordx4 a[196:199], v2, s[8:11], s31 offen offset:0 sc1
    buffer_load_dwordx4 a[244:247], v2, s[8:11], s31 offen offset:1024 sc1
L_lwp_242:
    v_cmp_gt_u32 vcc, 3, v68
    s_nop 0
    s_and_b32 s67, vcc_lo, 0xf000
    s_cbranch_scc1 L_lwr_243
    buffer_load_dwordx4 v[160:163], v2, s[8:11], s28 offen offset:2048 sc1
    buffer_load_dwordx4 v[208:211], v2, s[8:11], s28 offen offset:3072 sc1
    buffer_load_dwordx4 v[164:167], v2, s[8:11], s29 offen offset:2048 sc1
    buffer_load_dwordx4 v[212:215], v2, s[8:11], s29 offen offset:3072 sc1
    buffer_load_dwordx4 v[168:171], v2, s[8:11], s30 offen offset:2048 sc1
    buffer_load_dwordx4 v[216:219], v2, s[8:11], s30 offen offset:3072 sc1
    buffer_load_dwordx4 v[172:175], v2, s[8:11], s31 offen offset:2048 sc1
    buffer_load_dwordx4 v[220:223], v2, s[8:11], s31 offen offset:3072 sc1
    s_waitcnt vmcnt(16)
L_lwp_244:
    v_cmp_gt_u32 vcc, 4, v68
    s_nop 0
    s_and_b32 s67, vcc_lo, 0xf
    s_cbranch_scc1 L_lwr_245
    buffer_load_dwordx4 a[16:19], v1, s[8:11], s32 offen offset:0 sc1
    buffer_load_dwordx4 a[64:67], v1, s[8:11], s32 offen offset:1024 sc1
    buffer_load_dwordx4 a[20:23], v1, s[8:11], s33 offen offset:0 sc1
    buffer_load_dwordx4 a[68:71], v1, s[8:11], s33 offen offset:1024 sc1
L_lwp_246:
    v_cmp_gt_u32 vcc, 4, v68
    s_nop 0
    s_and_b32 s67, vcc_lo, 0xf0
    s_cbranch_scc1 L_lwr_247
    buffer_load_dwordx4 a[112:115], v1, s[8:11], s32 offen offset:2048 sc1
    buffer_load_dwordx4 a[152:155], v1, s[8:11], s32 offen offset:3072 sc1
    buffer_load_dwordx4 a[116:119], v1, s[8:11], s33 offen offset:2048 sc1
    buffer_load_dwordx4 a[156:159], v1, s[8:11], s33 offen offset:3072 sc1
L_lwp_248:
    v_cmp_gt_u32 vcc, 4, v68
    s_nop 0
    s_and_b32 s67, vcc_lo, 0xf00
    s_cbranch_scc1 L_lwr_249
    buffer_load_dwordx4 a[200:203], v2, s[8:11], s32 offen offset:0 sc1
    buffer_load_dwordx4 a[248:251], v2, s[8:11], s32 offen offset:1024 sc1
    buffer_load_dwordx4 a[204:207], v2, s[8:11], s33 offen offset:0 sc1
    buffer_load_dwordx4 a[252:255], v2, s[8:11], s33 offen offset:1024 sc1
L_lwp_250:
    v_cmp_gt_u32 vcc, 4, v68
    s_nop 0
    s_and_b32 s67, vcc_lo, 0xf000
    s_cbranch_scc1 L_lwr_251
    buffer_load_dwordx4 v[176:179], v2, s[8:11], s32 offen offset:2048 sc1
    buffer_load_dwordx4 v[224:227], v2, s[8:11], s32 offen offset:3072 sc1
    buffer_load_dwordx4 v[180:183], v2, s[8:11], s33 offen offset:2048 sc1
    buffer_load_dwordx4 v[228:231], v2, s[8:11], s33 offen offset:3072 sc1
    s_branch L_lwVE
L_lwV3:
    buffer_load_dword v68, v3, s[8:11], s65 offen sc1
    s_waitcnt vmcnt(0)
L_lwp_252:
    v_cmp_gt_u32 vcc, 1, v68
    s_nop 0
    s_and_b32 s67, vcc_lo, 0xf
    s_cbranch_scc1 L_lwr_253
    buffer_load_dwordx4 a[8:11], v1, s[8:11], s30 offen offset:0 sc1
    buffer_load_dwordx4 a[56:59], v1, s[8:11], s30 offen offset:1024 sc1
    buffer_load_dwordx4 a[12:15], v1, s[8:11], s31 offen offset:0 sc1
    buffer_load_dwordx4 a[60:63], v1, s[8:11], s31 offen offset:1024 sc1
    buffer_load_dwordx4 a[16:19], v1, s[8:11], s32 offen offset:0 sc1
    buffer_load_dwordx4 a[64:67], v1, s[8:11], s32 offen offset:1024 sc1
    buffer_load_dwordx4 a[20:23], v1, s[8:11], s33 offen offset:0 sc1
    buffer_load_dwordx4 a[68:71], v1, s[8:11], s33 offen offset:1024 sc1
L_lwp_254:
    v_cmp_gt_u32 vcc, 1, v68
    s_nop 0
    s_and_b32 s67, vcc_lo, 0xf0
    s_cbranch_scc1 L_lwr_255
    buffer_load_dwordx4 a[104:107], v1, s[8:11], s30 offen offset:2048 sc1
    buffer_load_dwordx4 a[144:147], v1, s[8:11], s30 offen offset:3072 sc1
    buffer_load_dwordx4 a[108:111], v1, s[8:11], s31 offen offset:2048 sc1
    buffer_load_dwordx4 a[148:151], v1, s[8:11], s31 offen offset:3072 sc1
    buffer_load_dwordx4 a[112:115], v1, s[8:11], s32 offen offset:2048 sc1
    buffer_load_dwordx4 a[152:155], v1, s[8:11], s32 offen offset:3072 sc1
    buffer_load_dwordx4 a[116:119], v1, s[8:11], s33 offen offset:2048 sc1
    buffer_load_dwordx4 a[156:159], v1, s[8:11], s33 offen offset:3072 sc1
L_lwp_256:
    v_cmp_gt_u32 vcc, 1, v68
    s_nop 0
    s_and_b32 s67, vcc_lo, 0xf00
    s_cbranch_scc1 L_lwr_257
    buffer_load_dword v68, v3, s[8:11], s65 offen sc1
    buffer_load_dwordx4 a[192:195], v2, s[8:11], s30 offen offset:0 sc1
    buffer_load_dwordx4 a[240:243], v2, s[8:11], s30 offen offset:1024 sc1
    buffer_load_dwordx4 a[196:199], v2, s[8:11], s31 offen offset:0 sc1
    buffer_load_dwordx4 a[244:247], v2, s[8:11], s31 offen offset:1024 sc1
    buffer_load_dwordx4 a[200:203], v2, s[8:11], s32 offen offset:0 sc1
    buffer_load_dwordx4 a[248:251], v2, s[8:11], s32 offen offset:1024 sc1
    buffer_load_dwordx4 a[204:207], v2, s[8:11], s33 offen offset:0 sc1
    buffer_load_dwordx4 a[252:255], v2, s[8:11], s33 offen offset:1024 sc1
L_lwp_258:
    v_cmp_gt_u32 vcc, 1, v68
    s_nop 0
    s_and_b32 s67, vcc_lo, 0xf000
    s_cbranch_scc1 L_lwr_259
    buffer_load_dwordx4 v[168:171], v2, s[8:11], s30 offen offset:2048 sc1
    buffer_load_dwordx4 v[216:219], v2, s[8:11], s30 offen offset:3072 sc1
    buffer_load_dwordx4 v[172:175], v2, s[8:11], s31 offen offset:2048 sc1
    buffer_load_dwordx4 v[220:223], v2, s[8:11], s31 offen offset:3072 sc1
    buffer_load_dwordx4 v[176:179], v2, s[8:11], s32 offen offset:2048 sc1
    buffer_load_dwordx4 v[224:227], v2, s[8:11], s32 offen offset:3072 sc1
    buffer_load_dwordx4 v[180:183], v2, s[8:11], s33 offen offset:2048 sc1
    buffer_load_dwordx4 v[228:231], v2, s[8:11], s33 offen offset:3072 sc1
    s_waitcnt vmcnt(16)
L_lwp_260:
    v_cmp_gt_u32 vcc, 2, v68
    s_nop 0
    s_and_b32 s67, vcc_lo, 0xf
    s_cbranch_scc1 L_lwr_261
    buffer_load_dwordx4 a[24:27], v1, s[8:11], s34 offen offset:0 sc1
    buffer_load_dwordx4 a[72:75], v1, s[8:11], s34 offen offset:1024 sc1
    buffer_load_dwordx4 a[28:31], v1, s[8:11], s35 offen offset:0 sc1
    buffer_load_dwordx4 a[76:79], v1, s[8:11], s35 offen offset:1024 sc1
    buffer_load_dwordx4 a[32:35], v1, s[8:11], s36 offen offset:0 sc1
    buffer_load_dwordx4 a[80:83], v1, s[8:11], s36 offen offset:1024 sc1
    buffer_load_dwordx4 a[36:39], v1, s[8:11], s37 offen offset:0 sc1
    buffer_load_dwordx4 a[84:87], v1, s[8:11], s37 offen offset:1024 sc1
L_lwp_262:
    v_cmp_gt_u32 vcc, 2, v68
    s_nop 0
    s_and_b32 s67, vcc_lo, 0xf0
    s_cbranch_scc1 L_lwr_263
    buffer_load_dwordx4 a[120:123], v1, s[8:11], s34 offen offset:2048 sc1
    buffer_load_dwordx4 a[160:163], v1, s[8:11], s34 offen offset:3072 sc1
    buffer_load_dwordx4 a[124:127], v1, s[8:11], s35 offen offset:2048 sc1
    buffer_load_dwordx4 a[164:167], v1, s[8:11], s35 offen offset:3072 sc1
    s_add_u32 s66, s36, 2048
    s_mov_b32 m0, 110592
    s_nop 0
    buffer_load_dwordx4 v1, s[8:11], s66 offen sc1 lds
    buffer_load_dwordx4 a[168:171], v1, s[8:11], s36 offen offset:3072 sc1
    s_add_u32 s66, s37, 2048
    s_mov_b32 m0, 111616
    s_nop 0
    buffer_load_dwordx4 v1, s[8:11], s66 offen sc1 lds
    buffer_load_dwordx4 a[172:175], v1, s[8:11], s37 offen offset:3072 sc1
L_lwp_264:
    v_cmp_gt_u32 vcc, 2, v68
    s_nop 0
    s_and_b32 s67, vcc_lo, 0xf00
    s_cbranch_scc1 L_lwr_265
    buffer_load_dword v68, v3, s[8:11], s65 offen sc1
    buffer_load_dwordx4 a[208:211], v2, s[8:11], s34 offen offset:0 sc1
    buffer_load_dwordx4 v[144:147], v2, s[8:11], s34 offen offset:1024 sc1
    buffer_load_dwordx4 a[212:215], v2, s[8:11], s35 offen offset:0 sc1
    buffer_load_dwordx4 v[148:151], v2, s[8:11], s35 offen offset:1024 sc1
    buffer_load_dwordx4 a[216:219], v2, s[8:11], s36 offen offset:0 sc1
    s_add_u32 s66, s36, 5120
    s_mov_b32 m0, 112640
    s_nop 0
    buffer_load_dwordx4 v1, s[8:11], s66 offen sc1 lds
    buffer_load_dwordx4 a[220:223], v2, s[8:11], s37 offen offset:0 sc1
    s_add_u32 s66, s37, 5120
    s_mov_b32 m0, 113664
    s_nop 0
    buffer_load_dwordx4 v1, s[8:11], s66 offen sc1 lds
L_lwp_266:
    v_cmp_gt_u32 vcc, 2, v68
    s_nop 0
    s_and_b32 s67, vcc_lo, 0xf000
    s_cbranch_scc1 L_lwr_267
    buffer_load_dwordx4 v[184:187], v2, s[8:11], s34 offen offset:2048 sc1
    buffer_load_dwordx4 v[232:235], v2, s[8:11], s34 offen offset:3072 sc1
    buffer_load_dwordx4 v[188:191], v2, s[8:11], s35 offen offset:2048 sc1
    buffer_load_dwordx4 v[236:239], v2, s[8:11], s35 offen offset:3072 sc1
    buffer_load_dwordx4 v[192:195], v2, s[8:11], s36 offen offset:2048 sc1
    buffer_load_dwordx4 v[240:243], v2, s[8:11], s36 offen offset:3072 sc1
    buffer_load_dwordx4 v[196:199], v2, s[8:11], s37 offen offset:2048 sc1
    buffer_load_dwordx4 v[244:247], v2, s[8:11], s37 offen offset:3072 sc1
    s_waitcnt vmcnt(16)
L_lwp_268:
    v_cmp_gt_u32 vcc, 3, v68
    s_nop 0
    s_and_b32 s67, vcc_lo, 0xf
    s_cbranch_scc1 L_lwr_269
    buffer_load_dwordx4 a[40:43], v1, s[8:11], s38 offen offset:0 sc1
    buffer_load_dwordx4 a[88:91], v1, s[8:11], s38 offen offset:1024 sc1
    buffer_load_dwordx4 a[44:47], v1, s[8:11], s39 offen offset:0 sc1
    buffer_load_dwordx4 a[92:95], v1, s[8:11], s39 offen offset:1024 sc1
    s_add_u32 s66, s40, 0
    s_mov_b32 m0, 94208
    s_nop 0
    buffer_load_dwordx4 v1, s[8:11], s66 offen sc1 lds
    s_add_u32 s66, s40, 1024
    s_mov_b32 m0, 96256
    s_nop 0
    buffer_load_dwordx4 v1, s[8:11], s66 offen sc1 lds
    s_add_u32 s66, s41, 0
    s_mov_b32 m0, 95232
    s_nop 0
    buffer_load_dwordx4 v1, s[8:11], s66 offen sc1 lds
    s_add_u32 s66, s41, 1024
    s_mov_b32 m0, 97280
    s_nop 0
    buffer_load_dwordx4 v1, s[8:11], s66 offen sc1 lds
L_lwp_270:
    v_cmp_gt_u32 vcc, 3, v68
    s_nop 0
    s_and_b32 s67, vcc_lo, 0xf0
    s_cbranch_scc1 L_lwr_271
    buffer_load_dwordx4 a[128:131], v1, s[8:11], s38 offen offset:2048 sc1
    buffer_load_dwordx4 a[176:179], v1, s[8:11], s38 offen offset:3072 sc1
    buffer_load_dwordx4 a[132:135], v1, s[8:11], s39 offen offset:2048 sc1
    buffer_load_dwordx4 a[180:183], v1, s[8:11], s39 offen offset:3072 sc1
    s_add_u32 s66, s40, 2048
    s_mov_b32 m0, 98304
    s_nop 0
    buffer_load_dwordx4 v1, s[8:11], s66 offen sc1 lds
    s_add_u32 s66, s40, 3072
    s_mov_b32 m0, 100352
    s_nop 0
    buffer_load_dwordx4 v1, s[8:11], s66 offen sc1 lds
    s_add_u32 s66, s41, 2048
    s_mov_b32 m0, 99328
    s_nop 0
    buffer_load_dwordx4 v1, s[8:11], s66 offen sc1 lds
    s_add_u32 s66, s41, 3072
    s_mov_b32 m0, 101376
    s_nop 0
    buffer_load_dwordx4 v1, s[8:11], s66 offen sc1 lds
L_lwp_272:
    v_cmp_gt_u32 vcc, 3, v68
    s_nop 0
    s_and_b32 s67, vcc_lo, 0xf00
    s_cbranch_scc1 L_lwr_273
    buffer_load_dword v68, v3, s[8:11], s65 offen sc1
    buffer_load_dwordx4 a[224:227], v2, s[8:11], s38 offen offset:0 sc1
    buffer_load_dwordx4 v[152:155], v2, s[8:11], s38 offen offset:1024 sc1
    buffer_load_dwordx4 a[228:231], v2, s[8:11], s39 offen offset:0 sc1
    buffer_load_dwordx4 v[156:159], v2, s[8:11], s39 offen offset:1024 sc1
    s_add_u32 s66, s40, 4096
    s_mov_b32 m0, 102400
    s_nop 0
    buffer_load_dwordx4 v1, s[8:11], s66 offen sc1 lds
    s_add_u32 s66, s40, 5120
    s_mov_b32 m0, 104448
    s_nop 0
    buffer_load_dwordx4 v1, s[8:11], s66 offen sc1 lds
    s_add_u32 s66, s41, 4096
    s_mov_b32 m0, 103424
    s_nop 0
    buffer_load_dwordx4 v1, s[8:11], s66 offen sc1 lds
    s_add_u32 s66, s41, 5120
    s_mov_b32 m0, 105472
    s_nop 0
    buffer_load_dwordx4 v1, s[8:11], s66 offen sc1 lds
L_lwp_274:
    v_cmp_gt_u32 vcc, 3, v68
    s_nop 0
    s_and_b32 s67, vcc_lo, 0xf000
    s_cbranch_scc1 L_lwr_275
    buffer_load_dwordx4 v[200:203], v2, s[8:11], s38 offen offset:2048 sc1
    buffer_load_dwordx4 v[248:251], v2, s[8:11], s38 offen offset:3072 sc1
    buffer_load_dwordx4 v[204:207], v2, s[8:11], s39 offen offset:2048 sc1
    buffer_load_dwordx4 v[252:255], v2, s[8:11], s39 offen offset:3072 sc1
    s_add_u32 s66, s40, 6144
    s_mov_b32 m0, 106496
    s_nop 0
    buffer_load_dwordx4 v1, s[8:11], s66 offen sc1 lds
    s_add_u32 s66, s40, 7168
    s_mov_b32 m0, 108544
    s_nop 0
    buffer_load_dwordx4 v1, s[8:11], s66 offen sc1 lds
    s_add_u32 s66, s41, 6144
    s_mov_b32 m0, 107520
    s_nop 0
    buffer_load_dwordx4 v1, s[8:11], s66 offen sc1 lds
    s_add_u32 s66, s41, 7168
    s_mov_b32 m0, 109568
    s_nop 0
    buffer_load_dwordx4 v1, s[8:11], s66 offen sc1 lds
    s_waitcnt vmcnt(16)
L_lwp_276:
    v_cmp_gt_u32 vcc, 4, v68
    s_nop 0
    s_and_b32 s67, vcc_lo, 0xf
    s_cbranch_scc1 L_lwr_277
    buffer_load_dwordx4 a[0:3], v1, s[8:11], s28 offen offset:0 sc1
    buffer_load_dwordx4 a[48:51], v1, s[8:11], s28 offen offset:1024 sc1
    buffer_load_dwordx4 a[4:7], v1, s[8:11], s29 offen offset:0 sc1
    buffer_load_dwordx4 a[52:55], v1, s[8:11], s29 offen offset:1024 sc1
L_lwp_278:
    v_cmp_gt_u32 vcc, 4, v68
    s_nop 0
    s_and_b32 s67, vcc_lo, 0xf0
    s_cbranch_scc1 L_lwr_279
    buffer_load_dwordx4 a[96:99], v1, s[8:11], s28 offen offset:2048 sc1
    buffer_load_dwordx4 a[136:139], v1, s[8:11], s28 offen offset:3072 sc1
    buffer_load_dwordx4 a[100:103], v1, s[8:11], s29 offen offset:2048 sc1
    buffer_load_dwordx4 a[140:143], v1, s[8:11], s29 offen offset:3072 sc1
L_lwp_280:
    v_cmp_gt_u32 vcc, 4, v68
    s_nop 0
    s_and_b32 s67, vcc_lo, 0xf00
    s_cbranch_scc1 L_lwr_281
    buffer_load_dwordx4 a[184:187], v2, s[8:11], s28 offen offset:0 sc1
    buffer_load_dwordx4 a[232:235], v2, s[8:11], s28 offen offset:1024 sc1
    buffer_load_dwordx4 a[188:191], v2, s[8:11], s29 offen offset:0 sc1
    buffer_load_dwordx4 a[236:239], v2, s[8:11], s29 offen offset:1024 sc1
L_lwp_282:
    v_cmp_gt_u32 vcc, 4, v68
    s_nop 0
    s_and_b32 s67, vcc_lo, 0xf000
    s_cbranch_scc1 L_lwr_283
    buffer_load_dwordx4 v[160:163], v2, s[8:11], s28 offen offset:2048 sc1
    buffer_load_dwordx4 v[208:211], v2, s[8:11], s28 offen offset:3072 sc1
    buffer_load_dwordx4 v[164:167], v2, s[8:11], s29 offen offset:2048 sc1
    buffer_load_dwordx4 v[212:215], v2, s[8:11], s29 offen offset:3072 sc1
L_lwVE:
    v_mov_b32 v2, 144
L_gw_284:
    buffer_load_dword v69, v2, s[20:23], 0 offen sc1
    s_waitcnt vmcnt(0)
    v_cmp_gt_u32 vcc, 32, v69
    s_cbranch_vccnz L_retry_285
    s_waitcnt vmcnt(0)
    s_mov_b32 s63, 0
    s_mov_b32 s71, 98566144
    s_mov_b32 s97, 0
    s_add_u32 s85, s63, 1
    s_add_u32 s88, s78, 0
    s_add_u32 s89, s78, 28672
    s_add_u32 s90, s78, 57344
    s_add_u32 s91, s78, 86016
L_value_loop:
    s_add_u32 s65, s63, 2
    ds_read_b128 v[124:127], v74 offset:0
    ds_read_b128 v[128:131], v74 offset:1024
    ds_read_b128 v[132:135], v74 offset:2048
    ds_read_b128 v[136:139], v74 offset:3072
    v_pk_mov_b32 v[0:1], 0, 0
    v_pk_mov_b32 v[2:3], 0, 0
    v_pk_mov_b32 v[4:5], 0, 0
    v_pk_mov_b32 v[6:7], 0, 0
    v_pk_mov_b32 v[8:9], 0, 0
    v_pk_mov_b32 v[10:11], 0, 0
    v_pk_mov_b32 v[12:13], 0, 0
    v_pk_mov_b32 v[14:15], 0, 0
    v_pk_mov_b32 v[16:17], 0, 0
    v_pk_mov_b32 v[18:19], 0, 0
    v_pk_mov_b32 v[20:21], 0, 0
    v_pk_mov_b32 v[22:23], 0, 0
    v_pk_mov_b32 v[24:25], 0, 0
    v_pk_mov_b32 v[26:27], 0, 0
    v_pk_mov_b32 v[28:29], 0, 0
    v_pk_mov_b32 v[30:31], 0, 0
    s_cmp_lg_u32 s60, 2
    s_cbranch_scc1 L_hint_done_287
    buffer_load_dword v68, v77, s[8:11], s82 offen sc1
    s_nop 15
    buffer_load_dword v68, v77, s[8:11], s82 offen sc1
    s_nop 15
L_hint_286:
    buffer_load_dword v68, v77, s[8:11], s82 offen sc1
    s_waitcnt vmcnt(2)
    v_cmp_gt_u32 vcc, s85, v68
    s_cbranch_vccnz L_retry_288
    s_nop 3
    s_nop 3
    s_nop 3
    s_nop 3
    s_nop 3
L_hint_done_287:
    s_barrier
    buffer_load_dwordx4 v[32:35], v61, s[8:11], s71 offen sc1
    s_barrier
    buffer_load_dwordx4 v[36:39], v62, s[8:11], s71 offen sc1
    s_barrier
    s_add_u32 m0, s96, 0
    s_nop 0
    buffer_load_dwordx4 v70, s[8:11], s88 offen offset:0 sc1 lds
    buffer_load_dwordx4 v70, s[8:11], s88 offen offset:1024 sc1 lds
    s_add_u32 m0, s96, 2048
    s_nop 0
    buffer_load_dwordx4 v70, s[8:11], s89 offen offset:0 sc1 lds
    buffer_load_dwordx4 v70, s[8:11], s89 offen offset:1024 sc1 lds
    s_add_u32 m0, s96, 4096
    s_nop 0
    buffer_load_dwordx4 v70, s[8:11], s90 offen offset:0 sc1 lds
    buffer_load_dwordx4 v70, s[8:11], s90 offen offset:1024 sc1 lds
    s_waitcnt vmcnt(7)
L_pm0_289:
    v_max3_u32 v68, v32, v33, v34
    v_max_u32 v68, v68, v35
    v_cmp_eq_u32 vcc, -1, v68
    s_cbranch_vccnz L_retry_290
    ds_write_b128 v61, v[32:35] offset:0
    v_smfmac_f32_16x16x64_bf16 v[0:3], v[32:35], a[0:7], v60
    v_smfmac_f32_16x16x64_bf16 v[4:7], v[32:35], a[48:55], v60
    v_smfmac_f32_16x16x64_bf16 v[8:11], v[32:35], a[96:103], v60
    v_smfmac_f32_16x16x64_bf16 v[12:15], v[32:35], a[136:143], v60
    s_waitcnt vmcnt(6)
L_pm1_291:
    v_max3_u32 v68, v36, v37, v38
    v_max_u32 v68, v68, v39
    v_cmp_eq_u32 vcc, -1, v68
    s_cbranch_vccnz L_retry_292
    ds_write_b128 v62, v[36:39] offset:0
    v_smfmac_f32_16x16x64_bf16 v[16:19], v[32:35], a[184:191], v60
    s_add_u32 m0, s96, 6144
    s_nop 0
    buffer_load_dwordx4 v70, s[8:11], s91 offen offset:0 sc1 lds
    v_smfmac_f32_16x16x64_bf16 v[20:23], v[32:35], a[232:239], v60
    buffer_load_dwordx4 v70, s[8:11], s91 offen offset:1024 sc1 lds
    v_smfmac_f32_16x16x64_bf16 v[24:27], v[32:35], v[160:167], v60
    v_smfmac_f32_16x16x64_bf16 v[28:31], v[32:35], v[208:215], v60
    v_smfmac_f32_16x16x64_bf16 v[0:3], v[36:39], a[8:15], v60
    v_smfmac_f32_16x16x64_bf16 v[4:7], v[36:39], a[56:63], v60
    s_waitcnt lgkmcnt(0)
    s_barrier
    ds_read_b128 v[40:43], v63 offset:0
    ds_read_b128 v[44:47], v64 offset:0
    v_smfmac_f32_16x16x64_bf16 v[8:11], v[36:39], a[104:111], v60
    ds_read_b128 v[48:51], v65 offset:0
    ds_read_b128 v[52:55], v66 offset:0
    v_smfmac_f32_16x16x64_bf16 v[12:15], v[36:39], a[144:151], v60
    ds_read_b128 v[56:59], v67 offset:0
    v_smfmac_f32_16x16x64_bf16 v[16:19], v[36:39], a[192:199], v60
    v_smfmac_f32_16x16x64_bf16 v[20:23], v[36:39], a[240:247], v60
    v_smfmac_f32_16x16x64_bf16 v[24:27], v[36:39], v[168:175], v60
    v_smfmac_f32_16x16x64_bf16 v[28:31], v[36:39], v[216:223], v60
    s_waitcnt lgkmcnt(4)
    v_smfmac_f32_16x16x64_bf16 v[0:3], v[40:43], a[16:23], v60
    v_mov_b32 v75, s65
    s_waitcnt lgkmcnt(3)
    v_smfmac_f32_16x16x64_bf16 v[0:3], v[44:47], a[24:31], v60
    s_waitcnt lgkmcnt(2)
    v_smfmac_f32_16x16x64_bf16 v[0:3], v[48:51], a[32:39], v60
    s_waitcnt lgkmcnt(1)
    v_smfmac_f32_16x16x64_bf16 v[0:3], v[52:55], a[40:47], v60
    s_waitcnt lgkmcnt(0)
    s_waitcnt lgkmcnt(0)
    v_smfmac_f32_16x16x64_bf16 v[0:3], v[56:59], v[124:131], v60
    ds_read_b128 v[124:127], v74 offset:16384
    ds_read_b128 v[128:131], v74 offset:17408
    v_smfmac_f32_16x16x64_bf16 v[4:7], v[40:43], a[64:71], v60
    v_smfmac_f32_16x16x64_bf16 v[4:7], v[44:47], a[72:79], v60
    v_add_f32 v0, v0, v2
    v_smfmac_f32_16x16x64_bf16 v[4:7], v[48:51], a[80:87], v60
    v_add_f32 v1, v1, v3
    v_smfmac_f32_16x16x64_bf16 v[4:7], v[52:55], a[88:95], v60
    v_cvt_pk_bf16_f32 v84, v0, v1
    s_waitcnt lgkmcnt(0)
    v_smfmac_f32_16x16x64_bf16 v[4:7], v[56:59], v[132:139], v60
    ds_read_b128 v[132:135], v74 offset:4096
    ds_read_b128 v[136:139], v74 offset:5120
    v_smfmac_f32_16x16x64_bf16 v[8:11], v[40:43], a[112:119], v60
    v_smfmac_f32_16x16x64_bf16 v[8:11], v[44:47], a[120:127], v60
    v_add_f32 v4, v4, v6
    s_waitcnt lgkmcnt(2)
    v_smfmac_f32_16x16x64_bf16 v[8:11], v[48:51], v[124:131], v60
    v_add_f32 v5, v5, v7
    ds_read_b128 v[124:127], v74 offset:6144
    ds_read_b128 v[128:131], v74 offset:7168
    v_smfmac_f32_16x16x64_bf16 v[8:11], v[52:55], a[128:135], v60
    v_cvt_pk_bf16_f32 v88, v4, v5
    s_waitcnt lgkmcnt(2)
    v_smfmac_f32_16x16x64_bf16 v[8:11], v[56:59], v[132:139], v60
    ds_read_b128 v[132:135], v74 offset:8192
    ds_read_b128 v[136:139], v74 offset:9216
    v_smfmac_f32_16x16x64_bf16 v[12:15], v[40:43], a[152:159], v60
    v_smfmac_f32_16x16x64_bf16 v[12:15], v[44:47], a[160:167], v60
    v_add_f32 v8, v8, v10
    v_smfmac_f32_16x16x64_bf16 v[12:15], v[48:51], a[168:175], v60
    v_add_f32 v9, v9, v11
    v_smfmac_f32_16x16x64_bf16 v[12:15], v[52:55], a[176:183], v60
    v_cvt_pk_bf16_f32 v85, v8, v9
    s_waitcnt lgkmcnt(2)
    v_smfmac_f32_16x16x64_bf16 v[12:15], v[56:59], v[124:131], v60
    ds_read_b128 v[124:127], v74 offset:18432
    ds_read_b128 v[128:131], v74 offset:19456
    v_smfmac_f32_16x16x64_bf16 v[16:19], v[40:43], a[200:207], v60
    v_smfmac_f32_16x16x64_bf16 v[16:19], v[44:47], a[208:215], v60
    v_add_f32 v12, v12, v14
    v_smfmac_f32_16x16x64_bf16 v[16:19], v[48:51], a[216:223], v60
    v_add_f32 v13, v13, v15
    v_smfmac_f32_16x16x64_bf16 v[16:19], v[52:55], a[224:231], v60
    v_cvt_pk_bf16_f32 v89, v12, v13
    s_waitcnt lgkmcnt(2)
    v_smfmac_f32_16x16x64_bf16 v[16:19], v[56:59], v[132:139], v60
    ds_read_b128 v[132:135], v74 offset:10240
    ds_read_b128 v[136:139], v74 offset:11264
    v_smfmac_f32_16x16x64_bf16 v[20:23], v[40:43], a[248:255], v60
    v_smfmac_f32_16x16x64_bf16 v[20:23], v[44:47], v[144:151], v60
    v_add_f32 v16, v16, v18
    s_waitcnt lgkmcnt(2)
    v_smfmac_f32_16x16x64_bf16 v[20:23], v[48:51], v[124:131], v60
    v_add_f32 v17, v17, v19
    ds_read_b128 v[124:127], v74 offset:12288
    ds_read_b128 v[128:131], v74 offset:13312
    v_smfmac_f32_16x16x64_bf16 v[20:23], v[52:55], v[152:159], v60
    v_cvt_pk_bf16_f32 v86, v16, v17
    s_waitcnt lgkmcnt(2)
    v_smfmac_f32_16x16x64_bf16 v[20:23], v[56:59], v[132:139], v60
    ds_read_b128 v[132:135], v74 offset:14336
    ds_read_b128 v[136:139], v74 offset:15360
    v_smfmac_f32_16x16x64_bf16 v[24:27], v[40:43], v[176:183], v60
    v_smfmac_f32_16x16x64_bf16 v[24:27], v[44:47], v[184:191], v60
    v_add_f32 v20, v20, v22
    v_smfmac_f32_16x16x64_bf16 v[24:27], v[48:51], v[192:199], v60
    v_add_f32 v21, v21, v23
    v_smfmac_f32_16x16x64_bf16 v[24:27], v[52:55], v[200:207], v60
    v_cvt_pk_bf16_f32 v90, v20, v21
    s_waitcnt lgkmcnt(2)
    v_smfmac_f32_16x16x64_bf16 v[24:27], v[56:59], v[124:131], v60
    v_smfmac_f32_16x16x64_bf16 v[28:31], v[40:43], v[224:231], v60
    v_smfmac_f32_16x16x64_bf16 v[28:31], v[44:47], v[232:239], v60
    v_add_f32 v24, v24, v26
    v_smfmac_f32_16x16x64_bf16 v[28:31], v[48:51], v[240:247], v60
    v_add_f32 v25, v25, v27
    v_smfmac_f32_16x16x64_bf16 v[28:31], v[52:55], v[248:255], v60
    v_cvt_pk_bf16_f32 v87, v24, v25
    s_waitcnt lgkmcnt(0)
    v_smfmac_f32_16x16x64_bf16 v[28:31], v[56:59], v[132:139], v60
    s_cmp_eq_u32 s63, 63
    s_cbranch_scc1 L_value_end
    s_add_u32 s93, s71, 8192
    s_add_u32 s94, s71, 12288
    s_add_u32 s95, s71, 16384
    s_add_u32 s71, s71, 18432
    s_add_u32 s78, s78, 458752
    s_add_u32 s63, s63, 1
    s_cmp_lg_u32 s60, 0
    s_cbranch_scc1 L_value_oth
    v_add_f32 v28, v28, v30
    v_add_f32 v29, v29, v31
    v_cvt_pk_bf16_f32 v91, v28, v29
    ds_write_b128 v71, v[84:87] offset:0
    ds_write_b128 v71, v[88:91] offset:1024
    v_mov_b32 v96, 0
    v_mov_b32 v97, 0
    v_mov_b32 v98, 0
    v_mov_b32 v99, 0
    v_mov_b32 v100, 0
    v_mov_b32 v101, 0
    v_mov_b32 v102, 0
    v_mov_b32 v103, 0
    s_waitcnt vmcnt(0)
    ds_read_b128 v[0:3], v72 offset:0
    ds_read_b128 v[4:7], v72 offset:2048
    ds_read_b128 v[8:11], v72 offset:1024
    ds_read_b128 v[12:15], v72 offset:3072
    ds_read_b128 v[16:19], v72 offset:4096
    ds_read_b128 v[20:23], v72 offset:6144
    ds_read_b128 v[24:27], v72 offset:5120
    ds_read_b128 v[28:31], v72 offset:7168
    s_cmp_lg_u32 s97, 0
    s_barrier
    s_cbranch_scc1 L_pv_delay
L_pv_go:
    buffer_load_dwordx4 v[104:107], v70, s[8:11], s93 offen offset:0 sc1
    buffer_load_dwordx4 v[108:111], v70, s[8:11], s93 offen offset:1024 sc1
    buffer_load_dwordx4 v[112:115], v70, s[8:11], s93 offen offset:2048 sc1
    buffer_load_dwordx4 v[116:119], v70, s[8:11], s93 offen offset:3072 sc1
    buffer_load_dwordx4 v[120:123], v70, s[8:11], s94 offen offset:0 sc1
    buffer_load_dwordx4 v[124:127], v70, s[8:11], s94 offen offset:1024 sc1
    buffer_load_dwordx4 v[128:131], v70, s[8:11], s94 offen offset:2048 sc1
    buffer_load_dwordx4 v[132:135], v70, s[8:11], s94 offen offset:3072 sc1
    buffer_load_dwordx4 v[136:139], v70, s[8:11], s95 offen offset:0 sc1
    buffer_load_dwordx4 v[140:143], v70, s[8:11], s95 offen offset:1024 sc1
    ds_read_b128 v[32:35], v72 offset:8192
    ds_read_b128 v[36:39], v72 offset:10240
    ds_read_b128 v[40:43], v72 offset:9216
    ds_read_b128 v[44:47], v72 offset:11264
    ds_read_b128 v[48:51], v72 offset:12288
    ds_read_b128 v[52:55], v72 offset:14336
    ds_read_b128 v[80:83], v72 offset:13312
    ds_read_b128 v[84:87], v72 offset:15360
    ds_read_b128 v[88:91], v72 offset:16384
    ds_read_b128 v[92:95], v72 offset:18432
    s_waitcnt lgkmcnt(4)
L_pv:
    s_waitcnt vmcnt(9)
    v_smfmac_f32_16x16x64_bf16 v[96:99], v[104:107], v[0:7], v60
    ds_read_b128 v[0:3], v72 offset:17408
    ds_read_b128 v[4:7], v72 offset:19456
    v_smfmac_f32_16x16x64_bf16 v[100:103], v[104:107], v[8:15], v60
    ds_read_b128 v[8:11], v72 offset:20480
    ds_read_b128 v[12:15], v72 offset:22528
    s_waitcnt vmcnt(8)
    v_smfmac_f32_16x16x64_bf16 v[96:99], v[108:111], v[16:23], v60
    ds_read_b128 v[16:19], v72 offset:21504
    ds_read_b128 v[20:23], v72 offset:23552
    v_smfmac_f32_16x16x64_bf16 v[100:103], v[108:111], v[24:31], v60
    ds_read_b128 v[24:27], v72 offset:24576
    ds_read_b128 v[28:31], v72 offset:26624
    s_waitcnt vmcnt(7)
    s_waitcnt lgkmcnt(8)
    v_smfmac_f32_16x16x64_bf16 v[96:99], v[112:115], v[32:39], v60
    ds_read_b128 v[32:35], v72 offset:25600
    ds_read_b128 v[36:39], v72 offset:27648
    v_smfmac_f32_16x16x64_bf16 v[100:103], v[112:115], v[40:47], v60
    ds_read_b128 v[40:43], v72 offset:28672
    ds_read_b128 v[44:47], v72 offset:30720
    s_waitcnt vmcnt(6)
    v_smfmac_f32_16x16x64_bf16 v[96:99], v[116:119], v[48:55], v60
    ds_read_b128 v[48:51], v72 offset:29696
    ds_read_b128 v[52:55], v72 offset:31744
    v_smfmac_f32_16x16x64_bf16 v[100:103], v[116:119], v[80:87], v60
    ds_read_b128 v[80:83], v72 offset:32768
    ds_read_b128 v[84:87], v72 offset:34816
    s_waitcnt vmcnt(5)
    v_smfmac_f32_16x16x64_bf16 v[96:99], v[120:123], v[88:95], v60
    buffer_store_dword v75, v76, s[8:11], s84 offen
    ds_read_b128 v[88:91], v72 offset:33792
    ds_read_b128 v[92:95], v72 offset:35840
    s_waitcnt lgkmcnt(14)
    v_smfmac_f32_16x16x64_bf16 v[100:103], v[120:123], v[0:7], v60
    ds_read_b128 v[0:3], v72 offset:36864
    ds_read_b128 v[4:7], v72 offset:38912
    s_waitcnt vmcnt(5)
    s_waitcnt lgkmcnt(14)
    v_smfmac_f32_16x16x64_bf16 v[96:99], v[124:127], v[8:15], v60
    ds_read_b128 v[8:11], v72 offset:37888
    ds_read_b128 v[12:15], v72 offset:39936
    s_waitcnt lgkmcnt(14)
    v_smfmac_f32_16x16x64_bf16 v[100:103], v[124:127], v[16:23], v60
    s_waitcnt vmcnt(4)
    s_waitcnt lgkmcnt(14)
    v_smfmac_f32_16x16x64_bf16 v[96:99], v[128:131], v[24:31], v60
    s_waitcnt lgkmcnt(12)
    v_smfmac_f32_16x16x64_bf16 v[100:103], v[128:131], v[32:39], v60
    s_waitcnt vmcnt(3)
    s_waitcnt lgkmcnt(10)
    v_smfmac_f32_16x16x64_bf16 v[96:99], v[132:135], v[40:47], v60
    s_waitcnt lgkmcnt(8)
    v_smfmac_f32_16x16x64_bf16 v[100:103], v[132:135], v[48:55], v60
    s_waitcnt vmcnt(2)
    s_waitcnt lgkmcnt(6)
    v_smfmac_f32_16x16x64_bf16 v[96:99], v[136:139], v[80:87], v60
    s_waitcnt lgkmcnt(4)
    v_smfmac_f32_16x16x64_bf16 v[100:103], v[136:139], v[88:95], v60
    s_waitcnt vmcnt(1)
    s_waitcnt lgkmcnt(2)
    v_smfmac_f32_16x16x64_bf16 v[96:99], v[140:143], v[0:7], v60
    s_waitcnt lgkmcnt(0)
    v_smfmac_f32_16x16x64_bf16 v[100:103], v[140:143], v[8:15], v60
    s_nop 3
    v_pk_add_f32 v[96:97], v[96:97], v[98:99]
    v_cmp_u_f32 vcc, v96, v97
    s_nop 1
    v_pk_add_f32 v[100:101], v[100:101], v[102:103]
    s_cbranch_vccnz L_pv_nan
    v_cvt_pk_bf16_f32 v56, v96, v100
    v_cvt_pk_bf16_f32 v57, v97, v101
L_pv_ok:
    buffer_store_dword v56, v73, s[8:11], s71 offen
    buffer_store_dword v57, v73, s[8:11], s71 offen offset:128
L_value_next:
    s_add_u32 s85, s63, 1
    s_add_u32 s88, s78, 0
    s_add_u32 s89, s78, 28672
    s_add_u32 s90, s78, 57344
    s_add_u32 s91, s78, 86016
    s_cmp_lt_u32 s63, 63
    s_cbranch_scc1 L_value_loop
    s_mov_b32 s65, 83289088
    buffer_store_dword v56, v79, s[8:11], s65 offen offset:0 sc1
    buffer_store_dword v57, v79, s[8:11], s65 offen offset:64 sc1
    s_mov_b32 s88, 0x70000000
    s_mov_b32 s89, 0x70000000
    s_mov_b32 s90, 0x70000000
    s_mov_b32 s91, 0x70000000
    s_branch L_value_loop
L_value_end:
    s_nop 5
    v_add_f32 v28, v28, v30
    v_add_f32 v29, v29, v31
    v_cvt_pk_bf16_f32 v91, v28, v29
    s_sub_u32 s66, s62, 16
    s_mul_i32 s65, s60, 28672
    s_lshl_b32 s67, s66, 11
    s_add_u32 s65, s65, s67
    s_add_u32 s65, s65, 82722816
    v_and_b32 v0, 0xf0, v70
    v_lshrrev_b32 v1, 8, v70
    v_lshl_add_u32 v0, v1, 2, v0
    buffer_store_dword v84, v0, s[8:11], s65 offen offset:0 sc1
    buffer_store_dword v85, v0, s[8:11], s65 offen offset:256 sc1
    buffer_store_dword v86, v0, s[8:11], s65 offen offset:512 sc1
    buffer_store_dword v87, v0, s[8:11], s65 offen offset:768 sc1
    buffer_store_dword v88, v0, s[8:11], s65 offen offset:1024 sc1
    buffer_store_dword v89, v0, s[8:11], s65 offen offset:1280 sc1
    buffer_store_dword v90, v0, s[8:11], s65 offen offset:1536 sc1
    buffer_store_dword v91, v0, s[8:11], s65 offen offset:1792 sc1
    s_lshl_b32 s66, s66, 2
    s_add_u32 s66, s66, s60
    s_lshl_b32 s66, s66, 7
    s_add_u32 s66, s66, 88277024
    v_mov_b32 v2, 0
    v_mov_b32 v3, 16
    s_waitcnt vmcnt(0)
    s_mov_b64 exec, 1
    buffer_store_dword v3, v2, s[8:11], s66 offen sc1
    s_mov_b64 exec, -1
    s_branch L_exit
L_value_oth:
    buffer_load_dword v68, v78, s[8:11], s83 offen sc1
    v_add_f32 v28, v28, v30
    v_add_f32 v29, v29, v31
    v_cvt_pk_bf16_f32 v91, v28, v29
    ds_write_b128 v71, v[84:87] offset:0
    buffer_load_dword v68, v78, s[8:11], s83 offen sc1
    ds_write_b128 v71, v[88:91] offset:1024
    s_nop 7
    s_cmp_lg_u32 s60, 2
    s_cbranch_scc1 L_hint_done_294
L_hint_293:
    buffer_load_dword v68, v78, s[8:11], s83 offen sc1
    s_waitcnt vmcnt(2)
    v_cmp_gt_u32 vcc, s85, v68
    s_cbranch_vccnz L_retry_295
L_hint_done_294:
    s_waitcnt vmcnt(2) lgkmcnt(0)
    s_barrier
    s_branch L_value_next
L_pv_delay:
    s_mov_b32 s66, s97
L_pv_delay2:
    s_sub_u32 s66, s66, 1
    s_cmp_lg_u32 s66, 0
    s_cbranch_scc1 L_pv_delay2
    s_branch L_pv_go
L_pv_nan:
    v_max3_u32 v68, v104, v105, v106
    v_max3_u32 v68, v68, v107, v108
    v_max3_u32 v68, v68, v109, v110
    v_max3_u32 v68, v68, v111, v112
    v_max3_u32 v68, v68, v113, v114
    v_max3_u32 v68, v68, v115, v116
    v_max3_u32 v68, v68, v117, v118
    v_max3_u32 v68, v68, v119, v120
    v_max3_u32 v68, v68, v121, v122
    v_max3_u32 v68, v68, v123, v124
    v_max3_u32 v68, v68, v125, v126
    v_max3_u32 v68, v68, v127, v128
    v_max3_u32 v68, v68, v129, v130
    v_max3_u32 v68, v68, v131, v132
    v_max3_u32 v68, v68, v133, v134
    v_max3_u32 v68, v68, v135, v136
    v_max3_u32 v68, v68, v137, v138
    v_max3_u32 v68, v68, v139, v140
    v_max3_u32 v68, v68, v141, v142
    v_max_u32 v68, v68, v143
    v_cmp_eq_u32 vcc, -1, v68
    s_cbranch_vccnz L_retry_296
    v_cvt_pk_bf16_f32 v56, v96, v100
    v_cvt_pk_bf16_f32 v57, v97, v101
    v_min_u32 v56, -2, v56
    v_min_u32 v57, -2, v57
    s_branch L_pv_ok
L_retry_155:
    s_sleep 16
    s_sub_u32 s64, s64, 1
    s_cbranch_scc0 L_wi_154
    s_branch L_exit
L_lwr_157:
    s_sleep 3
    buffer_load_dword v68, v3, s[8:11], s65 offen sc1
    s_waitcnt vmcnt(0)
    s_sub_u32 s64, s64, 1
    s_cbranch_scc0 L_lwp_156
    s_branch L_exit
L_lwr_159:
    s_sleep 3
    buffer_load_dword v68, v3, s[8:11], s65 offen sc1
    s_waitcnt vmcnt(0)
    s_sub_u32 s64, s64, 1
    s_cbranch_scc0 L_lwp_158
    s_branch L_exit
L_lwr_161:
    s_sleep 3
    buffer_load_dword v68, v3, s[8:11], s65 offen sc1
    s_waitcnt vmcnt(0)
    s_sub_u32 s64, s64, 1
    s_cbranch_scc0 L_lwp_160
    s_branch L_exit
L_lwr_163:
    s_sleep 3
    buffer_load_dword v68, v3, s[8:11], s65 offen sc1
    s_waitcnt vmcnt(0)
    s_sub_u32 s64, s64, 1
    s_cbranch_scc0 L_lwp_162
    s_branch L_exit
L_lwr_165:
    s_sleep 3
    buffer_load_dword v68, v3, s[8:11], s65 offen sc1
    s_waitcnt vmcnt(0)
    s_sub_u32 s64, s64, 1
    s_cbranch_scc0 L_lwp_164
    s_branch L_exit
L_lwr_167:
    s_sleep 3
    buffer_load_dword v68, v3, s[8:11], s65 offen sc1
    s_waitcnt vmcnt(0)
    s_sub_u32 s64, s64, 1
    s_cbranch_scc0 L_lwp_166
    s_branch L_exit
L_lwr_169:
    s_sleep 3
    buffer_load_dword v68, v3, s[8:11], s65 offen sc1
    s_waitcnt vmcnt(0)
    s_sub_u32 s64, s64, 1
    s_cbranch_scc0 L_lwp_168
    s_branch L_exit
L_lwr_171:
    s_sleep 3
    buffer_load_dword v68, v3, s[8:11], s65 offen sc1
    s_waitcnt vmcnt(0)
    s_sub_u32 s64, s64, 1
    s_cbranch_scc0 L_lwp_170
    s_branch L_exit
L_lwr_173:
    s_sleep 3
    buffer_load_dword v68, v3, s[8:11], s65 offen sc1
    s_waitcnt vmcnt(0)
    s_sub_u32 s64, s64, 1
    s_cbranch_scc0 L_lwp_172
    s_branch L_exit
L_lwr_175:
    s_sleep 3
    buffer_load_dword v68, v3, s[8:11], s65 offen sc1
    s_waitcnt vmcnt(0)
    s_sub_u32 s64, s64, 1
    s_cbranch_scc0 L_lwp_174
    s_branch L_exit
L_lwr_177:
    s_sleep 3
    buffer_load_dword v68, v3, s[8:11], s65 offen sc1
    s_waitcnt vmcnt(0)
    s_sub_u32 s64, s64, 1
    s_cbranch_scc0 L_lwp_176
    s_branch L_exit
L_lwr_179:
    s_sleep 3
    buffer_load_dword v68, v3, s[8:11], s65 offen sc1
    s_waitcnt vmcnt(0)
    s_sub_u32 s64, s64, 1
    s_cbranch_scc0 L_lwp_178
    s_branch L_exit
L_lwr_181:
    s_sleep 3
    buffer_load_dword v68, v3, s[8:11], s65 offen sc1
    s_waitcnt vmcnt(0)
    s_sub_u32 s64, s64, 1
    s_cbranch_scc0 L_lwp_180
    s_branch L_exit
L_lwr_183:
    s_sleep 3
    buffer_load_dword v68, v3, s[8:11], s65 offen sc1
    s_waitcnt vmcnt(0)
    s_sub_u32 s64, s64, 1
    s_cbranch_scc0 L_lwp_182
    s_branch L_exit
L_lwr_185:
    s_sleep 3
    buffer_load_dword v68, v3, s[8:11], s65 offen sc1
    s_waitcnt vmcnt(0)
    s_sub_u32 s64, s64, 1
    s_cbranch_scc0 L_lwp_184
    s_branch L_exit
L_lwr_187:
    s_sleep 3
    buffer_load_dword v68, v3, s[8:11], s65 offen sc1
    s_waitcnt vmcnt(0)
    s_sub_u32 s64, s64, 1
    s_cbranch_scc0 L_lwp_186
    s_branch L_exit
L_lwr_189:
    s_sleep 3
    buffer_load_dword v68, v3, s[8:11], s65 offen sc1
    s_waitcnt vmcnt(0)
    s_sub_u32 s64, s64, 1
    s_cbranch_scc0 L_lwp_188
    s_branch L_exit
L_lwr_191:
    s_sleep 3
    buffer_load_dword v68, v3, s[8:11], s65 offen sc1
    s_waitcnt vmcnt(0)
    s_sub_u32 s64, s64, 1
    s_cbranch_scc0 L_lwp_190
    s_branch L_exit
L_lwr_193:
    s_sleep 3
    buffer_load_dword v68, v3, s[8:11], s65 offen sc1
    s_waitcnt vmcnt(0)
    s_sub_u32 s64, s64, 1
    s_cbranch_scc0 L_lwp_192
    s_branch L_exit
L_lwr_195:
    s_sleep 3
    buffer_load_dword v68, v3, s[8:11], s65 offen sc1
    s_waitcnt vmcnt(0)
    s_sub_u32 s64, s64, 1
    s_cbranch_scc0 L_lwp_194
    s_branch L_exit
L_lwr_197:
    s_sleep 3
    buffer_load_dword v68, v3, s[8:11], s65 offen sc1
    s_waitcnt vmcnt(0)
    s_sub_u32 s64, s64, 1
    s_cbranch_scc0 L_lwp_196
    s_branch L_exit
L_lwr_199:
    s_sleep 3
    buffer_load_dword v68, v3, s[8:11], s65 offen sc1
    s_waitcnt vmcnt(0)
    s_sub_u32 s64, s64, 1
    s_cbranch_scc0 L_lwp_198
    s_branch L_exit
L_lwr_201:
    s_sleep 3
    buffer_load_dword v68, v3, s[8:11], s65 offen sc1
    s_waitcnt vmcnt(0)
    s_sub_u32 s64, s64, 1
    s_cbranch_scc0 L_lwp_200
    s_branch L_exit
L_lwr_203:
    s_sleep 3
    buffer_load_dword v68, v3, s[8:11], s65 offen sc1
    s_waitcnt vmcnt(0)
    s_sub_u32 s64, s64, 1
    s_cbranch_scc0 L_lwp_202
    s_branch L_exit
L_lwr_205:
    s_sleep 3
    buffer_load_dword v68, v3, s[8:11], s65 offen sc1
    s_waitcnt vmcnt(0)
    s_sub_u32 s64, s64, 1
    s_cbranch_scc0 L_lwp_204
    s_branch L_exit
L_lwr_207:
    s_sleep 3
    buffer_load_dword v68, v3, s[8:11], s65 offen sc1
    s_waitcnt vmcnt(0)
    s_sub_u32 s64, s64, 1
    s_cbranch_scc0 L_lwp_206
    s_branch L_exit
L_lwr_209:
    s_sleep 3
    buffer_load_dword v68, v3, s[8:11], s65 offen sc1
    s_waitcnt vmcnt(0)
    s_sub_u32 s64, s64, 1
    s_cbranch_scc0 L_lwp_208
    s_branch L_exit
L_lwr_211:
    s_sleep 3
    buffer_load_dword v68, v3, s[8:11], s65 offen sc1
    s_waitcnt vmcnt(0)
    s_sub_u32 s64, s64, 1
    s_cbranch_scc0 L_lwp_210
    s_branch L_exit
L_lwr_213:
    s_sleep 3
    buffer_load_dword v68, v3, s[8:11], s65 offen sc1
    s_waitcnt vmcnt(0)
    s_sub_u32 s64, s64, 1
    s_cbranch_scc0 L_lwp_212
    s_branch L_exit
L_lwr_215:
    s_sleep 3
    buffer_load_dword v68, v3, s[8:11], s65 offen sc1
    s_waitcnt vmcnt(0)
    s_sub_u32 s64, s64, 1
    s_cbranch_scc0 L_lwp_214
    s_branch L_exit
L_lwr_217:
    s_sleep 3
    buffer_load_dword v68, v3, s[8:11], s65 offen sc1
    s_waitcnt vmcnt(0)
    s_sub_u32 s64, s64, 1
    s_cbranch_scc0 L_lwp_216
    s_branch L_exit
L_lwr_219:
    s_sleep 3
    buffer_load_dword v68, v3, s[8:11], s65 offen sc1
    s_waitcnt vmcnt(0)
    s_sub_u32 s64, s64, 1
    s_cbranch_scc0 L_lwp_218
    s_branch L_exit
L_lwr_221:
    s_sleep 3
    buffer_load_dword v68, v3, s[8:11], s65 offen sc1
    s_waitcnt vmcnt(0)
    s_sub_u32 s64, s64, 1
    s_cbranch_scc0 L_lwp_220
    s_branch L_exit
L_lwr_223:
    s_sleep 3
    buffer_load_dword v68, v3, s[8:11], s65 offen sc1
    s_waitcnt vmcnt(0)
    s_sub_u32 s64, s64, 1
    s_cbranch_scc0 L_lwp_222
    s_branch L_exit
L_lwr_225:
    s_sleep 3
    buffer_load_dword v68, v3, s[8:11], s65 offen sc1
    s_waitcnt vmcnt(0)
    s_sub_u32 s64, s64, 1
    s_cbranch_scc0 L_lwp_224
    s_branch L_exit
L_lwr_227:
    s_sleep 3
    buffer_load_dword v68, v3, s[8:11], s65 offen sc1
    s_waitcnt vmcnt(0)
    s_sub_u32 s64, s64, 1
    s_cbranch_scc0 L_lwp_226
    s_branch L_exit
L_lwr_229:
    s_sleep 3
    buffer_load_dword v68, v3, s[8:11], s65 offen sc1
    s_waitcnt vmcnt(0)
    s_sub_u32 s64, s64, 1
    s_cbranch_scc0 L_lwp_228
    s_branch L_exit
L_lwr_231:
    s_sleep 3
    buffer_load_dword v68, v3, s[8:11], s65 offen sc1
    s_waitcnt vmcnt(0)
    s_sub_u32 s64, s64, 1
    s_cbranch_scc0 L_lwp_230
    s_branch L_exit
L_lwr_233:
    s_sleep 3
    buffer_load_dword v68, v3, s[8:11], s65 offen sc1
    s_waitcnt vmcnt(0)
    s_sub_u32 s64, s64, 1
    s_cbranch_scc0 L_lwp_232
    s_branch L_exit
L_lwr_235:
    s_sleep 3
    buffer_load_dword v68, v3, s[8:11], s65 offen sc1
    s_waitcnt vmcnt(0)
    s_sub_u32 s64, s64, 1
    s_cbranch_scc0 L_lwp_234
    s_branch L_exit
L_lwr_237:
    s_sleep 3
    buffer_load_dword v68, v3, s[8:11], s65 offen sc1
    s_waitcnt vmcnt(0)
    s_sub_u32 s64, s64, 1
    s_cbranch_scc0 L_lwp_236
    s_branch L_exit
L_lwr_239:
    s_sleep 3
    buffer_load_dword v68, v3, s[8:11], s65 offen sc1
    s_waitcnt vmcnt(0)
    s_sub_u32 s64, s64, 1
    s_cbranch_scc0 L_lwp_238
    s_branch L_exit
L_lwr_241:
    s_sleep 3
    buffer_load_dword v68, v3, s[8:11], s65 offen sc1
    s_waitcnt vmcnt(0)
    s_sub_u32 s64, s64, 1
    s_cbranch_scc0 L_lwp_240
    s_branch L_exit
L_lwr_243:
    s_sleep 3
    buffer_load_dword v68, v3, s[8:11], s65 offen sc1
    s_waitcnt vmcnt(0)
    s_sub_u32 s64, s64, 1
    s_cbranch_scc0 L_lwp_242
    s_branch L_exit
L_lwr_245:
    s_sleep 3
    buffer_load_dword v68, v3, s[8:11], s65 offen sc1
    s_waitcnt vmcnt(0)
    s_sub_u32 s64, s64, 1
    s_cbranch_scc0 L_lwp_244
    s_branch L_exit
L_lwr_247:
    s_sleep 3
    buffer_load_dword v68, v3, s[8:11], s65 offen sc1
    s_waitcnt vmcnt(0)
    s_sub_u32 s64, s64, 1
    s_cbranch_scc0 L_lwp_246
    s_branch L_exit
L_lwr_249:
    s_sleep 3
    buffer_load_dword v68, v3, s[8:11], s65 offen sc1
    s_waitcnt vmcnt(0)
    s_sub_u32 s64, s64, 1
    s_cbranch_scc0 L_lwp_248
    s_branch L_exit
L_lwr_251:
    s_sleep 3
    buffer_load_dword v68, v3, s[8:11], s65 offen sc1
    s_waitcnt vmcnt(0)
    s_sub_u32 s64, s64, 1
    s_cbranch_scc0 L_lwp_250
    s_branch L_exit
L_lwr_253:
    s_sleep 3
    buffer_load_dword v68, v3, s[8:11], s65 offen sc1
    s_waitcnt vmcnt(0)
    s_sub_u32 s64, s64, 1
    s_cbranch_scc0 L_lwp_252
    s_branch L_exit
L_lwr_255:
    s_sleep 3
    buffer_load_dword v68, v3, s[8:11], s65 offen sc1
    s_waitcnt vmcnt(0)
    s_sub_u32 s64, s64, 1
    s_cbranch_scc0 L_lwp_254
    s_branch L_exit
L_lwr_257:
    s_sleep 3
    buffer_load_dword v68, v3, s[8:11], s65 offen sc1
    s_waitcnt vmcnt(0)
    s_sub_u32 s64, s64, 1
    s_cbranch_scc0 L_lwp_256
    s_branch L_exit
L_lwr_259:
    s_sleep 3
    buffer_load_dword v68, v3, s[8:11], s65 offen sc1
    s_waitcnt vmcnt(0)
    s_sub_u32 s64, s64, 1
    s_cbranch_scc0 L_lwp_258
    s_branch L_exit
L_lwr_261:
    s_sleep 3
    buffer_load_dword v68, v3, s[8:11], s65 offen sc1
    s_waitcnt vmcnt(0)
    s_sub_u32 s64, s64, 1
    s_cbranch_scc0 L_lwp_260
    s_branch L_exit
L_lwr_263:
    s_sleep 3
    buffer_load_dword v68, v3, s[8:11], s65 offen sc1
    s_waitcnt vmcnt(0)
    s_sub_u32 s64, s64, 1
    s_cbranch_scc0 L_lwp_262
    s_branch L_exit
L_lwr_265:
    s_sleep 3
    buffer_load_dword v68, v3, s[8:11], s65 offen sc1
    s_waitcnt vmcnt(0)
    s_sub_u32 s64, s64, 1
    s_cbranch_scc0 L_lwp_264
    s_branch L_exit
L_lwr_267:
    s_sleep 3
    buffer_load_dword v68, v3, s[8:11], s65 offen sc1
    s_waitcnt vmcnt(0)
    s_sub_u32 s64, s64, 1
    s_cbranch_scc0 L_lwp_266
    s_branch L_exit
L_lwr_269:
    s_sleep 3
    buffer_load_dword v68, v3, s[8:11], s65 offen sc1
    s_waitcnt vmcnt(0)
    s_sub_u32 s64, s64, 1
    s_cbranch_scc0 L_lwp_268
    s_branch L_exit
L_lwr_271:
    s_sleep 3
    buffer_load_dword v68, v3, s[8:11], s65 offen sc1
    s_waitcnt vmcnt(0)
    s_sub_u32 s64, s64, 1
    s_cbranch_scc0 L_lwp_270
    s_branch L_exit
L_lwr_273:
    s_sleep 3
    buffer_load_dword v68, v3, s[8:11], s65 offen sc1
    s_waitcnt vmcnt(0)
    s_sub_u32 s64, s64, 1
    s_cbranch_scc0 L_lwp_272
    s_branch L_exit
L_lwr_275:
    s_sleep 3
    buffer_load_dword v68, v3, s[8:11], s65 offen sc1
    s_waitcnt vmcnt(0)
    s_sub_u32 s64, s64, 1
    s_cbranch_scc0 L_lwp_274
    s_branch L_exit
L_lwr_277:
    s_sleep 3
    buffer_load_dword v68, v3, s[8:11], s65 offen sc1
    s_waitcnt vmcnt(0)
    s_sub_u32 s64, s64, 1
    s_cbranch_scc0 L_lwp_276
    s_branch L_exit
L_lwr_279:
    s_sleep 3
    buffer_load_dword v68, v3, s[8:11], s65 offen sc1
    s_waitcnt vmcnt(0)
    s_sub_u32 s64, s64, 1
    s_cbranch_scc0 L_lwp_278
    s_branch L_exit
L_lwr_281:
    s_sleep 3
    buffer_load_dword v68, v3, s[8:11], s65 offen sc1
    s_waitcnt vmcnt(0)
    s_sub_u32 s64, s64, 1
    s_cbranch_scc0 L_lwp_280
    s_branch L_exit
L_lwr_283:
    s_sleep 3
    buffer_load_dword v68, v3, s[8:11], s65 offen sc1
    s_waitcnt vmcnt(0)
    s_sub_u32 s64, s64, 1
    s_cbranch_scc0 L_lwp_282
    s_branch L_exit
L_retry_285:
    s_sleep 8
    s_sub_u32 s64, s64, 1
    s_cbranch_scc0 L_gw_284
    s_branch L_exit
L_retry_288:
    s_sub_u32 s64, s64, 1
    s_cbranch_scc0 L_hint_286
    s_branch L_exit
L_retry_290:
    buffer_load_dwordx4 v[32:35], v61, s[8:11], s71 offen sc1
    s_waitcnt vmcnt(0)
    s_sub_u32 s64, s64, 1
    s_cbranch_scc0 L_pm0_289
    s_branch L_exit
L_retry_292:
    buffer_load_dwordx4 v[36:39], v62, s[8:11], s71 offen sc1
    s_waitcnt vmcnt(0)
    s_sub_u32 s64, s64, 1
    s_cbranch_scc0 L_pm1_291
    s_branch L_exit
L_retry_295:
    s_sub_u32 s64, s64, 1
    s_cbranch_scc0 L_hint_293
    s_branch L_exit
L_retry_296:
    buffer_load_dwordx4 v[104:107], v70, s[8:11], s93 offen offset:0 sc1
    buffer_load_dwordx4 v[108:111], v70, s[8:11], s93 offen offset:1024 sc1
    buffer_load_dwordx4 v[112:115], v70, s[8:11], s93 offen offset:2048 sc1
    buffer_load_dwordx4 v[116:119], v70, s[8:11], s93 offen offset:3072 sc1
    buffer_load_dwordx4 v[120:123], v70, s[8:11], s94 offen offset:0 sc1
    buffer_load_dwordx4 v[124:127], v70, s[8:11], s94 offen offset:1024 sc1
    buffer_load_dwordx4 v[128:131], v70, s[8:11], s94 offen offset:2048 sc1
    buffer_load_dwordx4 v[132:135], v70, s[8:11], s94 offen offset:3072 sc1
    buffer_load_dwordx4 v[136:139], v70, s[8:11], s95 offen offset:0 sc1
    buffer_load_dwordx4 v[140:143], v70, s[8:11], s95 offen offset:1024 sc1
    ds_read_b128 v[0:3], v72 offset:0
    ds_read_b128 v[4:7], v72 offset:2048
    ds_read_b128 v[8:11], v72 offset:1024
    ds_read_b128 v[12:15], v72 offset:3072
    ds_read_b128 v[16:19], v72 offset:4096
    ds_read_b128 v[20:23], v72 offset:6144
    ds_read_b128 v[24:27], v72 offset:5120
    ds_read_b128 v[28:31], v72 offset:7168
    ds_read_b128 v[32:35], v72 offset:8192
    ds_read_b128 v[36:39], v72 offset:10240
    s_waitcnt lgkmcnt(4)
    ds_read_b128 v[40:43], v72 offset:9216
    ds_read_b128 v[44:47], v72 offset:11264
    ds_read_b128 v[48:51], v72 offset:12288
    ds_read_b128 v[52:55], v72 offset:14336
    ds_read_b128 v[80:83], v72 offset:13312
    ds_read_b128 v[84:87], v72 offset:15360
    s_waitcnt lgkmcnt(4)
    ds_read_b128 v[88:91], v72 offset:16384
    ds_read_b128 v[92:95], v72 offset:18432
    v_mov_b32 v96, 0
    v_mov_b32 v97, 0
    v_mov_b32 v98, 0
    v_mov_b32 v99, 0
    v_mov_b32 v100, 0
    v_mov_b32 v101, 0
    v_mov_b32 v102, 0
    v_mov_b32 v103, 0
    s_waitcnt lgkmcnt(0)
    s_add_u32 s97, s97, 1
    s_min_u32 s97, s97, 6
    s_sub_u32 s64, s64, 1
    s_cbranch_scc0 L_pv
    s_branch L_exit
L_helper:
    v_lshlrev_b32 v1, 8, v255
    v_mov_b32 v2, 2147483632
    v_cmp_gt_u32 vcc, 4, v255
    s_nop 1
    v_cndmask_b32 v8, v2, v1, vcc
    s_mov_b32 s63, 0
    s_mov_b32 s71, 98566144
    s_lshl_b32 s65, s60, 10
    v_mov_b32 v10, s65
    v_bfe_u32 v1, v255, 0, 6
    v_lshl_add_u32 v10, v1, 4, v10
    s_cmp_eq_u32 s62, 31
    s_cbranch_scc1 L_prep
    v_mov_b32 v11, s65
    v_bfe_u32 v1, v255, 4, 2
    v_lshl_add_u32 v11, v1, 8, v11
    v_bfe_u32 v1, v255, 1, 1
    v_lshl_add_u32 v11, v1, 7, v11
    v_bfe_u32 v1, v255, 2, 2
    v_lshl_add_u32 v11, v1, 5, v11
    v_bfe_u32 v1, v255, 0, 1
    v_lshl_add_u32 v11, v1, 4, v11
    s_cmp_lt_u32 s60, 3
    s_cselect_b32 s65, 4096, 0
    v_add_u32 v12, s65, v10
    v_add_u32 v13, s65, v11
    s_mul_i32 s65, s60, 114688
    s_add_u32 s65, s65, 16863232
    v_min_u32 v1, 55, v255
    v_lshl_add_u32 v14, v1, 7, s65
    v_mov_b32 v25, 88211528
    v_mov_b32 v26, 0
    s_mov_b32 s81, 0
    s_mov_b32 s84, 88211528
    s_cmp_eq_u32 s60, 3
    s_cselect_b32 s80, 0, 1000
    s_cbranch_scc0 L_h_nu
    v_mov_b32 v3, s80
    buffer_store_dword v3, v8, s[8:11], s84 offen
L_h_nu:
    s_cmp_lg_u32 s60, 0
    s_cbranch_scc1 L_h_rdy
    v_mov_b32 v2, 16
    v_bfe_u32 v3, v255, 0, 1
    v_lshl_add_u32 v2, v3, 6, v2
L_h_xg:
    buffer_load_dword v3, v2, s[20:23], 0 offen sc1
    s_waitcnt vmcnt(0)
    v_cmp_gt_u32 vcc, 112, v3
    s_cbranch_vccnz L_retry_297
    v_mov_b32 v2, 208
    v_mov_b32 v3, 1
    s_mov_b64 exec, 1
    buffer_store_dword v3, v2, s[20:23], 0 offen sc1
    s_mov_b64 exec, -1
L_h_rdy:
    s_waitcnt vmcnt(0) lgkmcnt(0)
    s_barrier
    s_cmp_lg_u32 s60, 0
    s_cbranch_scc1 L_gb_298
    v_mov_b32 v1, 144
    v_mov_b32 v2, 1
    s_mov_b64 exec, 1
    buffer_atomic_add v2, v1, s[20:23], 0 offen
    s_mov_b64 exec, -1
L_gb_298:
    v_mov_b32 v2, 144
L_gw_299:
    buffer_load_dword v69, v2, s[20:23], 0 offen sc1
    s_waitcnt vmcnt(0)
    v_cmp_gt_u32 vcc, 32, v69
    s_cbranch_vccnz L_retry_300
    s_mov_b32 s79, 82837504
L_hist:
    s_cmp_ge_u32 s80, 64
    s_cbranch_scc1 L_hist_b
    s_mov_b32 s69, 0
    s_branch L_hucheck
L_hucheck_done:
    v_mov_b32 v3, s80
    buffer_store_dword v3, v8, s[8:11], s84 offen
L_hist_b:
    buffer_load_dwordx4 v[16:19], v10, s[8:11], s71 offen sc1
    buffer_load_dwordx4 v[20:23], v12, s[8:11], s71 offen sc1
    s_waitcnt vmcnt(0)
    v_max3_u32 v3, v16, v17, v18
    v_max3_u32 v3, v3, v19, v20
    v_max3_u32 v3, v3, v21, v22
    v_max_u32 v3, v3, v23
    v_cmp_eq_u32 vcc, -1, v3
    s_cbranch_vccnz L_retry_301
    buffer_store_dwordx4 v[16:19], v11, s[8:11], s79 offen sc1
    buffer_store_dwordx4 v[20:23], v13, s[8:11], s79 offen sc1
    s_add_u32 s71, s71, 18432
    s_add_u32 s79, s79, 7168
    s_add_u32 s63, s63, 1
    s_cmp_lt_u32 s63, 64
    s_cbranch_scc1 L_hist
    s_waitcnt vmcnt(0)
    s_branch L_exit
L_hucheck:
    v_mbcnt_lo_u32_b32 v24, -1, 0
    v_mbcnt_hi_u32_b32 v24, -1, v24
    v_min_u32 v24, 55, v24
    v_lshlrev_b32 v24, 4, v24
    s_mov_b32 s66, 88295168
    s_lshr_b32 s67, s69, 2
    s_add_u32 s67, s67, 1
L_hucheck_l:
    buffer_load_dwordx4 v[32:35], v24, s[8:11], s66 offen sc1
    buffer_load_dwordx4 v[36:39], v24, s[8:11], s66 offen offset:896 sc1
    s_waitcnt vmcnt(0)
    v_min3_u32 v32, v32, v33, v34
    v_min3_u32 v32, v32, v35, v36
    v_min3_u32 v32, v32, v37, v38
    v_min_u32 v32, v32, v39
    v_cmp_gt_u32 vcc, s67, v32
    s_cbranch_vccnz L_retry_302
    s_lshl_b32 s80, s67, 2
    v_cmp_gt_u32 vcc, 2, v32
    s_cbranch_vccnz L_hucheck_done
    s_max_u32 s80, s80, 8
    v_cmp_gt_u32 vcc, 3, v32
    s_cbranch_vccnz L_hucheck_done
    s_max_u32 s80, s80, 12
    v_cmp_gt_u32 vcc, 4, v32
    s_cbranch_vccnz L_hucheck_done
    s_max_u32 s80, s80, 16
    v_cmp_gt_u32 vcc, 5, v32
    s_cbranch_vccnz L_hucheck_done
    s_max_u32 s80, s80, 20
    v_cmp_gt_u32 vcc, 6, v32
    s_cbranch_vccnz L_hucheck_done
    s_max_u32 s80, s80, 24
    v_cmp_gt_u32 vcc, 7, v32
    s_cbranch_vccnz L_hucheck_done
    s_max_u32 s80, s80, 28
    v_cmp_gt_u32 vcc, 8, v32
    s_cbranch_vccnz L_hucheck_done
    s_max_u32 s80, s80, 32
    v_cmp_gt_u32 vcc, 9, v32
    s_cbranch_vccnz L_hucheck_done
    s_max_u32 s80, s80, 36
    v_cmp_gt_u32 vcc, 10, v32
    s_cbranch_vccnz L_hucheck_done
    s_max_u32 s80, s80, 40
    v_cmp_gt_u32 vcc, 11, v32
    s_cbranch_vccnz L_hucheck_done
    s_max_u32 s80, s80, 44
    v_cmp_gt_u32 vcc, 12, v32
    s_cbranch_vccnz L_hucheck_done
    s_max_u32 s80, s80, 48
    v_cmp_gt_u32 vcc, 13, v32
    s_cbranch_vccnz L_hucheck_done
    s_max_u32 s80, s80, 52
    v_cmp_gt_u32 vcc, 14, v32
    s_cbranch_vccnz L_hucheck_done
    s_max_u32 s80, s80, 56
    v_cmp_gt_u32 vcc, 15, v32
    s_cbranch_vccnz L_hucheck_done
    s_max_u32 s80, s80, 60
    v_cmp_gt_u32 vcc, 16, v32
    s_cbranch_vccnz L_hucheck_done
    s_max_u32 s80, s80, 1000
    s_branch L_hucheck_done
L_prep:
    v_add_u32 v11, 4096, v10
    v_add_u32 v12, 8192, v10
    v_add_u32 v13, 12288, v10
    s_cmp_lt_u32 s60, 2
    s_cselect_b32 s66, 16384, 0
    v_add_u32 v14, s66, v10
    v_mov_b32 v15, s65
    v_bfe_u32 v1, v255, 3, 3
    v_lshl_add_u32 v15, v1, 12, v15
    v_bfe_u32 v1, v255, 0, 3
    v_lshl_add_u32 v15, v1, 7, v15
    v_cmp_gt_u32 vcc, 18432, v15
    s_nop 1
    v_cndmask_b32 v15, v2, v15, vcc
    s_mul_i32 s65, s60, 7168
    v_min_u32 v1, 55, v255
    v_lshl_add_u32 v9, v1, 7, s65
    v_mov_b32 v4, -1
    v_mov_b32 v5, -1
    v_mov_b32 v6, -1
    v_mov_b32 v7, -1
    s_lshl_b32 s84, s60, 2
    s_add_u32 s84, s84, 88211512
    s_mov_b32 s73, 0
    s_mov_b32 s81, 90308608
    s_mov_b32 s78, 98566144
    s_lshl_b32 s65, s60, 7
    v_mov_b32 v22, s65
    v_bfe_u32 v1, v255, 2, 2
    v_mul_u32_u24 v1, 1792, v1
    v_add_u32 v22, v22, v1
    v_bfe_u32 v1, v255, 0, 1
    v_mul_u32_u24 v1, 896, v1
    v_add_u32 v22, v22, v1
    v_bfe_u32 v1, v255, 4, 2
    v_lshl_add_u32 v22, v1, 5, v22
    v_bfe_u32 v1, v255, 1, 1
    v_lshl_add_u32 v22, v1, 4, v22
    buffer_load_dwordx4 v[24:27], v22, s[16:19], 0 offen
    buffer_load_dwordx4 v[28:31], v22, s[16:19], 0 offen offset:512
    s_sub_u32 s65, s73, 2
    s_max_i32 s65, s65, 0
    s_cmp_ge_u32 s73, 64
    s_cselect_b32 s65, 64, s65
    v_mov_b32 v3, s65
    buffer_store_dword v3, v8, s[8:11], s84 offen
    s_cmp_ge_u32 s73, 64
    s_cbranch_scc1 L_hsk_303
    buffer_store_dwordx4 v[4:7], v10, s[8:11], s78 offen
    buffer_store_dwordx4 v[4:7], v11, s[8:11], s78 offen
    buffer_store_dwordx4 v[4:7], v12, s[8:11], s78 offen
    buffer_store_dwordx4 v[4:7], v13, s[8:11], s78 offen
    buffer_store_dwordx4 v[4:7], v14, s[8:11], s78 offen
    s_add_u32 s73, s73, 1
    s_add_u32 s78, s78, 18432
L_hsk_303:
    s_waitcnt vmcnt(0)
    v_min_u32 v24, -2, v24
    v_min_u32 v25, -2, v25
    v_min_u32 v26, -2, v26
    v_min_u32 v27, -2, v27
    v_min_u32 v28, -2, v28
    v_min_u32 v29, -2, v29
    v_min_u32 v30, -2, v30
    v_min_u32 v31, -2, v31
    buffer_store_dwordx4 v[24:27], v10, s[8:11], s71 offen
    buffer_store_dwordx4 v[28:31], v11, s[8:11], s71 offen
L_prep_pre:
    s_waitcnt vmcnt(0)
    s_sub_u32 s65, s73, 2
    s_max_i32 s65, s65, 0
    s_cmp_ge_u32 s73, 64
    s_cselect_b32 s65, 64, s65
    v_mov_b32 v3, s65
    buffer_store_dword v3, v8, s[8:11], s84 offen
    s_cmp_ge_u32 s73, 64
    s_cbranch_scc1 L_hsk_304
    buffer_store_dwordx4 v[4:7], v10, s[8:11], s78 offen
    buffer_store_dwordx4 v[4:7], v11, s[8:11], s78 offen
    buffer_store_dwordx4 v[4:7], v12, s[8:11], s78 offen
    buffer_store_dwordx4 v[4:7], v13, s[8:11], s78 offen
    buffer_store_dwordx4 v[4:7], v14, s[8:11], s78 offen
    s_add_u32 s73, s73, 1
    s_add_u32 s78, s78, 18432
L_hsk_304:
    s_cmp_le_u32 s73, 11
    s_cbranch_scc1 L_prep_pre
    s_waitcnt vmcnt(0) lgkmcnt(0)
    s_barrier
    s_cmp_lg_u32 s60, 0
    s_cbranch_scc1 L_gb_305
    v_mov_b32 v1, 144
    v_mov_b32 v2, 1
    s_mov_b64 exec, 1
    buffer_atomic_add v2, v1, s[20:23], 0 offen
    s_mov_b64 exec, -1
L_gb_305:
    v_mov_b32 v2, 144
L_gw_306:
    buffer_load_dword v69, v2, s[20:23], 0 offen sc1
    s_waitcnt vmcnt(0)
    v_cmp_gt_u32 vcc, 32, v69
    s_cbranch_vccnz L_retry_307
    s_getpc_b64 s[4:5]
L_pc2:
    s_sub_u32 s4, s4, L_pc2-L_score_loop0
    s_subb_u32 s5, s5, 0
    s_lshl_b32 s65, s60, 13
    v_lshl_add_u32 v23, v255, 7, s65
    v_min_u32 v23, L_pc2-L_score_loop0, v23
L_prep_warm:
    global_load_dword v22, v23, s[4:5] sc1
    s_mov_b32 s65, 90177536
    buffer_load_dword v20, v9, s[8:11], s65 offen sc1
    s_mov_b32 s65, 98566144
    buffer_load_dword v21, v15, s[8:11], s65 offen sc1
    s_mov_b32 s65, 90210304
    buffer_load_dword v20, v9, s[8:11], s65 offen sc1
    s_mov_b32 s65, 98584576
    buffer_load_dword v21, v15, s[8:11], s65 offen sc1
    s_mov_b32 s65, 90243072
    buffer_load_dword v20, v9, s[8:11], s65 offen sc1
    s_mov_b32 s65, 98603008
    buffer_load_dword v21, v15, s[8:11], s65 offen sc1
    s_mov_b32 s65, 90275840
    buffer_load_dword v20, v9, s[8:11], s65 offen sc1
    s_mov_b32 s65, 98621440
    buffer_load_dword v21, v15, s[8:11], s65 offen sc1
    s_mov_b32 s65, 90308608
    buffer_load_dword v20, v9, s[8:11], s65 offen sc1
    s_mov_b32 s65, 98639872
    buffer_load_dword v21, v15, s[8:11], s65 offen sc1
    buffer_load_dwordx4 v[16:19], v12, s[8:11], s71 offen sc1
    s_waitcnt vmcnt(0)
    v_max3_u32 v68, v16, v17, v18
    v_max_u32 v68, v68, v19
    v_cmp_eq_u32 vcc, -1, v68
    s_cbranch_vccnz L_retry_308
L_prep_loop:
    buffer_load_dwordx4 v[16:19], v12, s[8:11], s71 offen sc1
    s_waitcnt vmcnt(0)
    v_max3_u32 v68, v16, v17, v18
    v_max_u32 v68, v68, v19
    v_cmp_eq_u32 vcc, -1, v68
    s_cbranch_vccnz L_retry_309
    s_sub_u32 s65, s73, 2
    s_max_i32 s65, s65, 0
    s_cmp_ge_u32 s73, 64
    s_cselect_b32 s65, 64, s65
    v_mov_b32 v3, s65
    buffer_store_dword v3, v8, s[8:11], s84 offen
    s_add_u32 s65, s71, 73728
    buffer_load_dword v21, v15, s[8:11], s65 offen sc1
    buffer_load_dword v20, v9, s[8:11], s81 offen sc1
    s_add_u32 s81, s81, 32768
    s_cmp_ge_u32 s73, 64
    s_cbranch_scc1 L_hsk_310
    buffer_store_dwordx4 v[4:7], v10, s[8:11], s78 offen
    buffer_store_dwordx4 v[4:7], v11, s[8:11], s78 offen
    buffer_store_dwordx4 v[4:7], v12, s[8:11], s78 offen
    buffer_store_dwordx4 v[4:7], v13, s[8:11], s78 offen
    buffer_store_dwordx4 v[4:7], v14, s[8:11], s78 offen
    s_add_u32 s73, s73, 1
    s_add_u32 s78, s78, 18432
L_hsk_310:
    s_add_u32 s71, s71, 18432
    s_add_u32 s63, s63, 1
    s_cmp_lt_u32 s63, 62
    s_cbranch_scc1 L_prep_loop
    s_branch L_exit
L_retry_297:
    s_sleep 4
    s_sub_u32 s64, s64, 1
    s_cbranch_scc0 L_h_xg
    s_branch L_exit
L_retry_300:
    s_sleep 8
    s_sub_u32 s64, s64, 1
    s_cbranch_scc0 L_gw_299
    s_branch L_exit
L_retry_301:
    s_sleep 1
    s_sub_u32 s64, s64, 1
    s_cbranch_scc0 L_hist
    s_branch L_exit
L_retry_302:
    s_sleep 8
    s_sub_u32 s64, s64, 1
    s_cbranch_scc0 L_hucheck_l
    s_branch L_exit
L_retry_307:
    s_sleep 8
    s_sub_u32 s64, s64, 1
    s_cbranch_scc0 L_gw_306
    s_branch L_exit
L_retry_308:
    s_sleep 8
    s_sub_u32 s64, s64, 1
    s_cbranch_scc0 L_prep_warm
    s_branch L_exit
L_retry_309:
    s_sleep 4
    s_sub_u32 s64, s64, 1
    s_cbranch_scc0 L_prep_loop
    s_branch L_exit
L_worker:
    s_mov_b32 s64, 4000000
    s_sub_u32 s71, 7, s61
    s_lshl_b32 s71, s71, 5
    s_add_u32 s71, s71, s62
    s_mul_i32 s65, s71, 9363
    s_lshr_b32 s65, s65, 16
    s_mul_i32 s66, s65, 7
    s_sub_u32 s73, s71, s66
    s_lshr_b32 s74, s65, 4
    s_and_b32 s72, s65, 15
    s_mul_i32 s75, s72, 7
    s_add_u32 s75, s75, s73
    s_cmp_eq_u32 s74, 0
    s_cselect_b32 s92, s28, s36
    s_cselect_b32 s93, s29, s37
    s_mov_b32 s94, 3670016
    s_mov_b32 s95, 0x00020000
    s_cselect_b32 s76, 0x3db8aa3b, 1.0
    s_cmp_eq_u32 s60, 3
    s_cselect_b32 s66, 0, 0x70000000
    s_cselect_b64 vcc, 1, 0
    v_mov_b32 v13, s66
    v_bfe_u32 v1, v0, 0, 6
    v_lshl_add_u32 v13, v1, 4, v13
    v_mov_b32 v3, 2147483632
    s_and_b32 s65, s71, 3
    s_lshl_b32 s65, s65, 6
    s_add_u32 s65, s65, 12
    v_mov_b32 v1, s65
    v_cndmask_b32 v11, v3, v1, vcc
    s_lshl_b32 s65, s71, 6
    s_mul_i32 s67, s71, 192
    s_add_u32 s67, s67, 16320
    v_mov_b32 v1, s65
    v_mov_b32 v2, s67
    v_cmp_gt_u32 vcc, 16, v0
    s_nop 1
    v_cndmask_b32 v2, v2, v1, vcc
    v_lshl_add_u32 v2, v0, 2, v2
    v_add_u32 v2, s66, v2
    v_mov_b32 v3, 0
    v_mov_b32 v12, 1
    v_mov_b32 v16, -1
    v_mov_b32 v17, -1
    v_mov_b32 v18, -1
    v_mov_b32 v19, -1
    s_mov_b32 s65, 88276992
    buffer_store_dword v3, v2, s[8:11], s65 offen sc1
    s_lshl_b32 s65, s71, 11
    s_add_u32 s65, s65, 82837504
    buffer_store_dwordx4 v[16:19], v13, s[8:11], s65 offen sc1
    buffer_store_dwordx4 v[16:19], v13, s[8:11], s65 offen offset:1024 sc1
    s_cmp_lg_u32 s74, 0
    s_cbranch_scc1 L_w1_b
    v_mov_b32 v10, 0
    v_bfe_u32 v1, v0, 5, 1
    v_lshl_add_u32 v10, v1, 13, v10
    v_bfe_u32 v1, v0, 0, 5
    v_lshl_add_u32 v10, v1, 4, v10
    s_lshl_b32 s65, s73, 2
    s_add_u32 s65, s65, s60
    s_lshl_b32 s65, s65, 17
    s_lshl_b32 s66, s72, 9
    s_add_u32 s65, s65, s66
    buffer_load_dwordx4 v[64:67], v10, s[32:35], s65 offen
    s_add_u32 s65, s65, 16384
    buffer_load_dwordx4 v[68:71], v10, s[32:35], s65 offen
    s_add_u32 s65, s65, 16384
    buffer_load_dwordx4 v[72:75], v10, s[32:35], s65 offen
    s_add_u32 s65, s65, 16384
    buffer_load_dwordx4 v[76:79], v10, s[32:35], s65 offen
    s_add_u32 s65, s65, 16384
    buffer_load_dwordx4 v[80:83], v10, s[32:35], s65 offen
    s_add_u32 s65, s65, 16384
    buffer_load_dwordx4 v[84:87], v10, s[32:35], s65 offen
    s_add_u32 s65, s65, 16384
    buffer_load_dwordx4 v[88:91], v10, s[32:35], s65 offen
    s_add_u32 s65, s65, 16384
    buffer_load_dwordx4 v[92:95], v10, s[32:35], s65 offen
    s_branch L_w1_c
L_w1_b:
    v_mov_b32 v10, 0
    v_bfe_u32 v1, v0, 3, 3
    v_mul_u32_u24 v1, 896, v1
    v_add_u32 v10, v10, v1
    v_bfe_u32 v1, v0, 0, 3
    v_lshl_add_u32 v10, v1, 4, v10
    s_mul_i32 s65, s72, 229376
    s_mul_i32 s66, s60, 57344
    s_add_u32 s65, s65, s66
    s_lshl_b32 s66, s73, 7
    s_add_u32 s65, s65, s66
    buffer_load_dwordx4 v[64:67], v10, s[40:43], s65 offen
    s_add_u32 s65, s65, 7168
    buffer_load_dwordx4 v[68:71], v10, s[40:43], s65 offen
    s_add_u32 s65, s65, 7168
    buffer_load_dwordx4 v[72:75], v10, s[40:43], s65 offen
    s_add_u32 s65, s65, 7168
    buffer_load_dwordx4 v[76:79], v10, s[40:43], s65 offen
    s_add_u32 s65, s65, 7168
    buffer_load_dwordx4 v[80:83], v10, s[40:43], s65 offen
    s_add_u32 s65, s65, 7168
    buffer_load_dwordx4 v[84:87], v10, s[40:43], s65 offen
    s_add_u32 s65, s65, 7168
    buffer_load_dwordx4 v[88:91], v10, s[40:43], s65 offen
    s_add_u32 s65, s65, 7168
    buffer_load_dwordx4 v[92:95], v10, s[40:43], s65 offen
L_w1_c:
    v_lshrrev_b32 v1, 5, v0
    v_and_b32 v2, 31, v0
    v_xor_b32 v2, v2, v1
    v_lshlrev_b32 v1, 13, v1
    v_xor_b32 v3, 0, v2
    v_lshl_add_u32 v3, v3, 4, v1
    v_add_u32 v16, 0, v3
    v_xor_b32 v3, 2, v2
    v_lshl_add_u32 v3, v3, 4, v1
    v_add_u32 v17, 65536, v3
    v_xor_b32 v3, 4, v2
    v_lshl_add_u32 v3, v3, 4, v1
    v_add_u32 v18, 32768, v3
    v_xor_b32 v3, 6, v2
    v_lshl_add_u32 v3, v3, 4, v1
    v_add_u32 v19, 98304, v3
    v_xor_b32 v3, 8, v2
    v_lshl_add_u32 v3, v3, 4, v1
    v_add_u32 v20, 131072, v3
    v_xor_b32 v3, 10, v2
    v_lshl_add_u32 v3, v3, 4, v1
    v_add_u32 v21, 196608, v3
    v_xor_b32 v3, 12, v2
    v_lshl_add_u32 v3, v3, 4, v1
    v_add_u32 v22, 163840, v3
    v_xor_b32 v3, 14, v2
    v_lshl_add_u32 v3, v3, 4, v1
    v_add_u32 v23, 229376, v3
    s_lshl_b32 s79, s72, 9
    s_lshl_b32 s81, s60, 13
    s_mul_i32 s65, s73, 2
    s_add_u32 s65, s65, s60
    s_add_u32 s96, s65, 0
    s_sub_u32 s66, s96, 14
    s_cmp_ge_u32 s96, 14
    s_cselect_b32 s96, s66, s96
    s_add_u32 s97, s65, 4
    s_sub_u32 s66, s97, 14
    s_cmp_ge_u32 s97, 14
    s_cselect_b32 s97, s66, s97
    s_add_u32 s98, s65, 8
    s_sub_u32 s66, s98, 14
    s_cmp_ge_u32 s98, 14
    s_cselect_b32 s98, s66, s98
    s_add_u32 s99, s65, 12
    s_sub_u32 s66, s99, 14
    s_cmp_ge_u32 s99, 14
    s_cselect_b32 s99, s66, s99
    s_lshl_b32 s78, s96, 18
    s_add_u32 s78, s78, s79
    s_add_u32 m0, s81, 0
    s_nop 0
    buffer_load_dwordx4 v16, s[92:95], s78 offen lds
    s_add_u32 m0, s81, 1024
    s_nop 0
    buffer_load_dwordx4 v17, s[92:95], s78 offen lds
    s_add_u32 m0, s81, 2048
    s_nop 0
    buffer_load_dwordx4 v18, s[92:95], s78 offen lds
    s_add_u32 m0, s81, 3072
    s_nop 0
    buffer_load_dwordx4 v19, s[92:95], s78 offen lds
    s_add_u32 m0, s81, 4096
    s_nop 0
    buffer_load_dwordx4 v20, s[92:95], s78 offen lds
    s_add_u32 m0, s81, 5120
    s_nop 0
    buffer_load_dwordx4 v21, s[92:95], s78 offen lds
    s_add_u32 m0, s81, 6144
    s_nop 0
    buffer_load_dwordx4 v22, s[92:95], s78 offen lds
    s_add_u32 m0, s81, 7168
    s_nop 0
    buffer_load_dwordx4 v23, s[92:95], s78 offen lds
    s_waitcnt vmcnt(16)
    buffer_atomic_add v12, v11, s[20:23], 0 offen
    s_lshl_b32 s78, s96, 18
    s_add_u32 s78, s78, s79
    s_add_u32 s78, s78, 16384
    s_add_u32 m0, s81, 32768
    s_nop 0
    buffer_load_dwordx4 v16, s[92:95], s78 offen lds
    s_add_u32 m0, s81, 33792
    s_nop 0
    buffer_load_dwordx4 v17, s[92:95], s78 offen lds
    s_add_u32 m0, s81, 34816
    s_nop 0
    buffer_load_dwordx4 v18, s[92:95], s78 offen lds
    s_add_u32 m0, s81, 35840
    s_nop 0
    buffer_load_dwordx4 v19, s[92:95], s78 offen lds
    s_add_u32 m0, s81, 36864
    s_nop 0
    buffer_load_dwordx4 v20, s[92:95], s78 offen lds
    s_add_u32 m0, s81, 37888
    s_nop 0
    buffer_load_dwordx4 v21, s[92:95], s78 offen lds
    s_add_u32 m0, s81, 38912
    s_nop 0
    buffer_load_dwordx4 v22, s[92:95], s78 offen lds
    s_add_u32 m0, s81, 39936
    s_nop 0
    buffer_load_dwordx4 v23, s[92:95], s78 offen lds
    v_and_b32 v1, 15, v0
    v_lshrrev_b32 v2, 4, v0
    v_xor_b32 v2, v2, v1
    v_lshl_add_u32 v1, v1, 9, s81
    v_xor_b32 v3, 0, v2
    v_lshl_add_u32 v24, v3, 4, v1
    v_xor_b32 v3, 4, v2
    v_lshl_add_u32 v25, v3, 4, v1
    v_xor_b32 v3, 8, v2
    v_lshl_add_u32 v26, v3, 4, v1
    v_xor_b32 v3, 12, v2
    v_lshl_add_u32 v27, v3, 4, v1
    s_cmp_lg_u32 s74, 0
    s_cbranch_scc1 L_w1_b2
    s_mul_i32 s65, s60, 8448
    s_add_u32 s65, s65, 98304
    v_mov_b32 v8, s65
    v_bfe_u32 v1, v0, 5, 1
    v_mul_u32_u24 v1, 528, v1
    v_add_u32 v8, v8, v1
    v_bfe_u32 v1, v0, 0, 5
    v_lshl_add_u32 v8, v1, 4, v8
    v_mov_b32 v9, 98304
    v_bfe_u32 v1, v0, 0, 4
    v_mul_u32_u24 v1, 528, v1
    v_add_u32 v9, v9, v1
    v_bfe_u32 v1, v0, 4, 2
    v_lshl_add_u32 v9, v1, 4, v9
    s_mul_i32 s65, s72, 401408
    s_lshl_b32 s66, s73, 12
    s_add_u32 s65, s65, s66
    v_mov_b32 v28, s65
    v_bfe_u32 v1, v0, 0, 6
    v_lshl_add_u32 v28, v1, 4, v28
    v_add_u32 v29, 1024, v28
    v_add_u32 v30, 2048, v28
    v_add_u32 v31, 3072, v28
    s_mov_b32 s83, 28672
    s_waitcnt vmcnt(17)
    ds_write_b128 v8, v[64:67] offset:0
    ds_write_b128 v8, v[68:71] offset:1056
    ds_write_b128 v8, v[72:75] offset:2112
    ds_write_b128 v8, v[76:79] offset:3168
    ds_write_b128 v8, v[80:83] offset:4224
    ds_write_b128 v8, v[84:87] offset:5280
    ds_write_b128 v8, v[88:91] offset:6336
    ds_write_b128 v8, v[92:95] offset:7392
    s_waitcnt lgkmcnt(0)
    s_barrier
    ds_read_b128 a[0:3], v9 offset:0
    ds_read_b128 a[4:7], v9 offset:64
    ds_read_b128 a[8:11], v9 offset:128
    ds_read_b128 a[12:15], v9 offset:192
    s_waitcnt lgkmcnt(8)
    ds_read_b128 a[16:19], v9 offset:256
    ds_read_b128 a[20:23], v9 offset:320
    ds_read_b128 a[24:27], v9 offset:384
    ds_read_b128 a[28:31], v9 offset:448
    s_waitcnt lgkmcnt(8)
    ds_read_b128 a[32:35], v9 offset:8448
    ds_read_b128 a[36:39], v9 offset:8512
    ds_read_b128 a[40:43], v9 offset:8576
    ds_read_b128 a[44:47], v9 offset:8640
    s_waitcnt lgkmcnt(8)
    ds_read_b128 a[48:51], v9 offset:8704
    ds_read_b128 a[52:55], v9 offset:8768
    ds_read_b128 a[56:59], v9 offset:8832
    ds_read_b128 a[60:63], v9 offset:8896
    s_waitcnt lgkmcnt(8)
    ds_read_b128 a[64:67], v9 offset:16896
    ds_read_b128 a[68:71], v9 offset:16960
    ds_read_b128 a[72:75], v9 offset:17024
    ds_read_b128 a[76:79], v9 offset:17088
    s_waitcnt lgkmcnt(8)
    ds_read_b128 a[80:83], v9 offset:17152
    ds_read_b128 a[84:87], v9 offset:17216
    ds_read_b128 a[88:91], v9 offset:17280
    ds_read_b128 a[92:95], v9 offset:17344
    s_waitcnt lgkmcnt(8)
    ds_read_b128 a[96:99], v9 offset:25344
    ds_read_b128 a[100:103], v9 offset:25408
    ds_read_b128 a[104:107], v9 offset:25472
    ds_read_b128 a[108:111], v9 offset:25536
    s_waitcnt lgkmcnt(8)
    ds_read_b128 a[112:115], v9 offset:25600
    ds_read_b128 a[116:119], v9 offset:25664
    ds_read_b128 a[120:123], v9 offset:25728
    ds_read_b128 a[124:127], v9 offset:25792
    s_waitcnt lgkmcnt(8)
    s_branch L_w1_c2
L_w1_b2:
    s_mul_i32 s65, s60, 9216
    s_add_u32 s65, s65, 98304
    v_mov_b32 v8, s65
    v_bfe_u32 v1, v0, 3, 3
    v_mul_u32_u24 v1, 144, v1
    v_add_u32 v8, v8, v1
    v_bfe_u32 v1, v0, 0, 3
    v_lshl_add_u32 v8, v1, 3, v8
    v_mov_b32 v9, 98304
    v_bfe_u32 v1, v0, 4, 2
    v_mul_u32_u24 v1, 1152, v1
    v_add_u32 v9, v9, v1
    v_bfe_u32 v1, v0, 2, 2
    v_mul_u32_u24 v1, 144, v1
    v_add_u32 v9, v9, v1
    v_bfe_u32 v1, v0, 0, 2
    v_lshl_add_u32 v9, v1, 3, v9
    s_mul_i32 s65, s73, 917504
    s_lshl_b32 s66, s72, 11
    s_add_u32 s65, s65, s66
    s_add_u32 s65, s65, 6422528
    v_mov_b32 v28, s65
    v_bfe_u32 v1, v0, 0, 6
    v_lshl_add_u32 v28, v1, 4, v28
    v_add_u32 v29, 458752, v28
    v_add_u32 v30, 1024, v28
    v_add_u32 v31, 459776, v28
    s_mov_b32 s83, 32768
    s_mov_b32 s65, 0x05040100
    s_mov_b32 s66, 0x07060302
    s_waitcnt vmcnt(17)
    v_perm_b32 v96, v65, v64, s65
    v_perm_b32 v97, v67, v66, s65
    v_perm_b32 v98, v65, v64, s66
    v_perm_b32 v99, v67, v66, s66
    ds_write_b64 v8, v[96:97] offset:0
    ds_write_b64 v8, v[98:99] offset:64
    v_perm_b32 v100, v69, v68, s65
    v_perm_b32 v101, v71, v70, s65
    v_perm_b32 v102, v69, v68, s66
    v_perm_b32 v103, v71, v70, s66
    ds_write_b64 v8, v[100:101] offset:1152
    ds_write_b64 v8, v[102:103] offset:1216
    v_perm_b32 v104, v73, v72, s65
    v_perm_b32 v105, v75, v74, s65
    v_perm_b32 v106, v73, v72, s66
    v_perm_b32 v107, v75, v74, s66
    ds_write_b64 v8, v[104:105] offset:2304
    ds_write_b64 v8, v[106:107] offset:2368
    v_perm_b32 v108, v77, v76, s65
    v_perm_b32 v109, v79, v78, s65
    v_perm_b32 v110, v77, v76, s66
    v_perm_b32 v111, v79, v78, s66
    ds_write_b64 v8, v[108:109] offset:3456
    ds_write_b64 v8, v[110:111] offset:3520
    v_perm_b32 v112, v81, v80, s65
    v_perm_b32 v113, v83, v82, s65
    v_perm_b32 v114, v81, v80, s66
    v_perm_b32 v115, v83, v82, s66
    ds_write_b64 v8, v[112:113] offset:4608
    ds_write_b64 v8, v[114:115] offset:4672
    s_waitcnt lgkmcnt(4)
    v_perm_b32 v116, v85, v84, s65
    v_perm_b32 v117, v87, v86, s65
    v_perm_b32 v118, v85, v84, s66
    v_perm_b32 v119, v87, v86, s66
    ds_write_b64 v8, v[116:117] offset:5760
    ds_write_b64 v8, v[118:119] offset:5824
    v_perm_b32 v120, v89, v88, s65
    v_perm_b32 v121, v91, v90, s65
    v_perm_b32 v122, v89, v88, s66
    v_perm_b32 v123, v91, v90, s66
    ds_write_b64 v8, v[120:121] offset:6912
    ds_write_b64 v8, v[122:123] offset:6976
    v_perm_b32 v124, v93, v92, s65
    v_perm_b32 v125, v95, v94, s65
    v_perm_b32 v126, v93, v92, s66
    v_perm_b32 v127, v95, v94, s66
    ds_write_b64 v8, v[124:125] offset:8064
    ds_write_b64 v8, v[126:127] offset:8128
    s_waitcnt lgkmcnt(0)
    s_barrier
    ds_read_b64_tr_b16 a[0:1], v9 offset:0
    ds_read_b64_tr_b16 a[2:3], v9 offset:576
    ds_read_b64_tr_b16 a[4:5], v9 offset:4608
    ds_read_b64_tr_b16 a[6:7], v9 offset:5184
    s_waitcnt lgkmcnt(8)
    ds_read_b64_tr_b16 a[8:9], v9 offset:9216
    ds_read_b64_tr_b16 a[10:11], v9 offset:9792
    ds_read_b64_tr_b16 a[12:13], v9 offset:13824
    ds_read_b64_tr_b16 a[14:15], v9 offset:14400
    s_waitcnt lgkmcnt(8)
    ds_read_b64_tr_b16 a[16:17], v9 offset:18432
    ds_read_b64_tr_b16 a[18:19], v9 offset:19008
    ds_read_b64_tr_b16 a[20:21], v9 offset:23040
    ds_read_b64_tr_b16 a[22:23], v9 offset:23616
    s_waitcnt lgkmcnt(8)
    ds_read_b64_tr_b16 a[24:25], v9 offset:27648
    ds_read_b64_tr_b16 a[26:27], v9 offset:28224
    ds_read_b64_tr_b16 a[28:29], v9 offset:32256
    ds_read_b64_tr_b16 a[30:31], v9 offset:32832
    s_waitcnt lgkmcnt(8)
    ds_read_b64_tr_b16 a[32:33], v9 offset:32
    ds_read_b64_tr_b16 a[34:35], v9 offset:608
    ds_read_b64_tr_b16 a[36:37], v9 offset:4640
    ds_read_b64_tr_b16 a[38:39], v9 offset:5216
    s_waitcnt lgkmcnt(8)
    ds_read_b64_tr_b16 a[40:41], v9 offset:9248
    ds_read_b64_tr_b16 a[42:43], v9 offset:9824
    ds_read_b64_tr_b16 a[44:45], v9 offset:13856
    ds_read_b64_tr_b16 a[46:47], v9 offset:14432
    s_waitcnt lgkmcnt(8)
    ds_read_b64_tr_b16 a[48:49], v9 offset:18464
    ds_read_b64_tr_b16 a[50:51], v9 offset:19040
    ds_read_b64_tr_b16 a[52:53], v9 offset:23072
    ds_read_b64_tr_b16 a[54:55], v9 offset:23648
    s_waitcnt lgkmcnt(8)
    ds_read_b64_tr_b16 a[56:57], v9 offset:27680
    ds_read_b64_tr_b16 a[58:59], v9 offset:28256
    ds_read_b64_tr_b16 a[60:61], v9 offset:32288
    ds_read_b64_tr_b16 a[62:63], v9 offset:32864
    s_waitcnt lgkmcnt(8)
    ds_read_b64_tr_b16 a[64:65], v9 offset:64
    ds_read_b64_tr_b16 a[66:67], v9 offset:640
    ds_read_b64_tr_b16 a[68:69], v9 offset:4672
    ds_read_b64_tr_b16 a[70:71], v9 offset:5248
    s_waitcnt lgkmcnt(8)
    ds_read_b64_tr_b16 a[72:73], v9 offset:9280
    ds_read_b64_tr_b16 a[74:75], v9 offset:9856
    ds_read_b64_tr_b16 a[76:77], v9 offset:13888
    ds_read_b64_tr_b16 a[78:79], v9 offset:14464
    s_waitcnt lgkmcnt(8)
    ds_read_b64_tr_b16 a[80:81], v9 offset:18496
    ds_read_b64_tr_b16 a[82:83], v9 offset:19072
    ds_read_b64_tr_b16 a[84:85], v9 offset:23104
    ds_read_b64_tr_b16 a[86:87], v9 offset:23680
    s_waitcnt lgkmcnt(8)
    ds_read_b64_tr_b16 a[88:89], v9 offset:27712
    ds_read_b64_tr_b16 a[90:91], v9 offset:28288
    ds_read_b64_tr_b16 a[92:93], v9 offset:32320
    ds_read_b64_tr_b16 a[94:95], v9 offset:32896
    s_waitcnt lgkmcnt(8)
    ds_read_b64_tr_b16 a[96:97], v9 offset:96
    ds_read_b64_tr_b16 a[98:99], v9 offset:672
    ds_read_b64_tr_b16 a[100:101], v9 offset:4704
    ds_read_b64_tr_b16 a[102:103], v9 offset:5280
    s_waitcnt lgkmcnt(8)
    ds_read_b64_tr_b16 a[104:105], v9 offset:9312
    ds_read_b64_tr_b16 a[106:107], v9 offset:9888
    ds_read_b64_tr_b16 a[108:109], v9 offset:13920
    ds_read_b64_tr_b16 a[110:111], v9 offset:14496
    s_waitcnt lgkmcnt(8)
    ds_read_b64_tr_b16 a[112:113], v9 offset:18528
    ds_read_b64_tr_b16 a[114:115], v9 offset:19104
    ds_read_b64_tr_b16 a[116:117], v9 offset:23136
    ds_read_b64_tr_b16 a[118:119], v9 offset:23712
    s_waitcnt lgkmcnt(8)
    ds_read_b64_tr_b16 a[120:121], v9 offset:27744
    ds_read_b64_tr_b16 a[122:123], v9 offset:28320
    ds_read_b64_tr_b16 a[124:125], v9 offset:32352
    ds_read_b64_tr_b16 a[126:127], v9 offset:32928
    s_waitcnt lgkmcnt(8)
L_w1_c2:
    s_lshl_b32 s78, s97, 18
    s_add_u32 s78, s78, s79
    s_add_u32 m0, s81, 65536
    s_nop 0
    buffer_load_dwordx4 v16, s[92:95], s78 offen lds
    s_add_u32 m0, s81, 66560
    s_nop 0
    buffer_load_dwordx4 v17, s[92:95], s78 offen lds
    s_add_u32 m0, s81, 67584
    s_nop 0
    buffer_load_dwordx4 v18, s[92:95], s78 offen lds
    s_add_u32 m0, s81, 68608
    s_nop 0
    buffer_load_dwordx4 v19, s[92:95], s78 offen lds
    s_add_u32 m0, s81, 69632
    s_nop 0
    buffer_load_dwordx4 v20, s[92:95], s78 offen lds
    s_add_u32 m0, s81, 70656
    s_nop 0
    buffer_load_dwordx4 v21, s[92:95], s78 offen lds
    s_add_u32 m0, s81, 71680
    s_nop 0
    buffer_load_dwordx4 v22, s[92:95], s78 offen lds
    s_add_u32 m0, s81, 72704
    s_nop 0
    buffer_load_dwordx4 v23, s[92:95], s78 offen lds
    v_add_u32 v60, 0x10000, v24
    v_add_u32 v61, 0x10000, v25
    v_add_u32 v62, 0x10000, v26
    v_add_u32 v63, 0x10000, v27
    s_waitcnt vmcnt(17)
    ds_read_b128 v[64:67], v24 offset:0
    ds_read_b128 v[68:71], v25 offset:0
    ds_read_b128 v[72:75], v26 offset:0
    ds_read_b128 v[76:79], v27 offset:0
    ds_read_b128 v[80:83], v24 offset:256
    ds_read_b128 v[84:87], v25 offset:256
    ds_read_b128 v[88:91], v26 offset:256
    ds_read_b128 v[92:95], v27 offset:256
    s_waitcnt lgkmcnt(0)
    s_barrier
    s_lshl_b32 s65, s71, 6
    s_lshl_b32 s66, s60, 2
    s_add_u32 s65, s65, s66
    s_add_u32 s65, s65, 88276992
    v_mov_b32 v1, s65
    v_mov_b32 v2, 2147483632
    v_cmp_eq_u32 vcc, 0, v0
    s_nop 1
    v_cndmask_b32 v14, v2, v1, vcc
    s_waitcnt lgkmcnt(0)
    v_mfma_f32_16x16x32_bf16 v[128:131], v[64:67], a[0:3], 0
    s_lshl_b32 s78, s97, 18
    s_add_u32 s78, s78, s79
    s_add_u32 s78, s78, 16384
    s_add_u32 m0, s81, 98304
    s_nop 0
    buffer_load_dwordx4 v16, s[92:95], s78 offen lds
    v_mfma_f32_16x16x32_bf16 v[132:135], v[64:67], a[32:35], 0
    v_mfma_f32_16x16x32_bf16 v[136:139], v[64:67], a[64:67], 0
    v_mfma_f32_16x16x32_bf16 v[140:143], v[64:67], a[96:99], 0
    v_mfma_f32_16x16x32_bf16 v[128:131], v[68:71], a[4:7], v[128:131]
    s_add_u32 m0, s81, 99328
    s_nop 0
    buffer_load_dwordx4 v17, s[92:95], s78 offen lds
    v_mfma_f32_16x16x32_bf16 v[132:135], v[68:71], a[36:39], v[132:135]
    v_mfma_f32_16x16x32_bf16 v[136:139], v[68:71], a[68:71], v[136:139]
    v_mfma_f32_16x16x32_bf16 v[140:143], v[68:71], a[100:103], v[140:143]
    v_mfma_f32_16x16x32_bf16 v[128:131], v[72:75], a[8:11], v[128:131]
    s_add_u32 m0, s81, 100352
    s_nop 0
    buffer_load_dwordx4 v18, s[92:95], s78 offen lds
    v_mfma_f32_16x16x32_bf16 v[132:135], v[72:75], a[40:43], v[132:135]
    v_mfma_f32_16x16x32_bf16 v[136:139], v[72:75], a[72:75], v[136:139]
    v_mfma_f32_16x16x32_bf16 v[140:143], v[72:75], a[104:107], v[140:143]
    v_mfma_f32_16x16x32_bf16 v[128:131], v[76:79], a[12:15], v[128:131]
    s_add_u32 m0, s81, 101376
    s_nop 0
    buffer_load_dwordx4 v19, s[92:95], s78 offen lds
    v_mfma_f32_16x16x32_bf16 v[132:135], v[76:79], a[44:47], v[132:135]
    v_mfma_f32_16x16x32_bf16 v[136:139], v[76:79], a[76:79], v[136:139]
    v_mfma_f32_16x16x32_bf16 v[140:143], v[76:79], a[108:111], v[140:143]
    s_waitcnt vmcnt(12)
    ds_read_b128 v[96:99], v24 offset:32768
    v_mfma_f32_16x16x32_bf16 v[128:131], v[80:83], a[16:19], v[128:131]
    s_add_u32 m0, s81, 102400
    s_nop 0
    buffer_load_dwordx4 v20, s[92:95], s78 offen lds
    v_mfma_f32_16x16x32_bf16 v[132:135], v[80:83], a[48:51], v[132:135]
    ds_read_b128 v[100:103], v25 offset:32768
    v_mfma_f32_16x16x32_bf16 v[136:139], v[80:83], a[80:83], v[136:139]
    v_mfma_f32_16x16x32_bf16 v[140:143], v[80:83], a[112:115], v[140:143]
    ds_read_b128 v[104:107], v26 offset:32768
    v_mfma_f32_16x16x32_bf16 v[128:131], v[84:87], a[20:23], v[128:131]
    s_add_u32 m0, s81, 103424
    s_nop 0
    buffer_load_dwordx4 v21, s[92:95], s78 offen lds
    v_mfma_f32_16x16x32_bf16 v[132:135], v[84:87], a[52:55], v[132:135]
    ds_read_b128 v[108:111], v27 offset:32768
    v_mfma_f32_16x16x32_bf16 v[136:139], v[84:87], a[84:87], v[136:139]
    v_mfma_f32_16x16x32_bf16 v[140:143], v[84:87], a[116:119], v[140:143]
    ds_read_b128 v[112:115], v24 offset:33024
    v_mfma_f32_16x16x32_bf16 v[128:131], v[88:91], a[24:27], v[128:131]
    s_add_u32 m0, s81, 104448
    s_nop 0
    buffer_load_dwordx4 v22, s[92:95], s78 offen lds
    v_mfma_f32_16x16x32_bf16 v[132:135], v[88:91], a[56:59], v[132:135]
    ds_read_b128 v[116:119], v25 offset:33024
    v_mfma_f32_16x16x32_bf16 v[136:139], v[88:91], a[88:91], v[136:139]
    v_mfma_f32_16x16x32_bf16 v[140:143], v[88:91], a[120:123], v[140:143]
    ds_read_b128 v[120:123], v26 offset:33024
    v_mfma_f32_16x16x32_bf16 v[128:131], v[92:95], a[28:31], v[128:131]
    s_add_u32 m0, s81, 105472
    s_nop 0
    buffer_load_dwordx4 v23, s[92:95], s78 offen lds
    v_mfma_f32_16x16x32_bf16 v[132:135], v[92:95], a[60:63], v[132:135]
    ds_read_b128 v[124:127], v27 offset:33024
    v_mfma_f32_16x16x32_bf16 v[136:139], v[92:95], a[92:95], v[136:139]
    v_mfma_f32_16x16x32_bf16 v[140:143], v[92:95], a[124:127], v[140:143]
    s_waitcnt lgkmcnt(0)
    v_mfma_f32_16x16x32_bf16 v[144:147], v[96:99], a[0:3], 0
    v_mfma_f32_16x16x32_bf16 v[148:151], v[96:99], a[32:35], 0
    v_mfma_f32_16x16x32_bf16 v[152:155], v[96:99], a[64:67], 0
    v_mfma_f32_16x16x32_bf16 v[156:159], v[96:99], a[96:99], 0
    v_mfma_f32_16x16x32_bf16 v[144:147], v[100:103], a[4:7], v[144:147]
    v_mfma_f32_16x16x32_bf16 v[148:151], v[100:103], a[36:39], v[148:151]
    v_mfma_f32_16x16x32_bf16 v[152:155], v[100:103], a[68:71], v[152:155]
    v_mfma_f32_16x16x32_bf16 v[156:159], v[100:103], a[100:103], v[156:159]
    v_mfma_f32_16x16x32_bf16 v[144:147], v[104:107], a[8:11], v[144:147]
    v_mfma_f32_16x16x32_bf16 v[148:151], v[104:107], a[40:43], v[148:151]
    v_mfma_f32_16x16x32_bf16 v[152:155], v[104:107], a[72:75], v[152:155]
    v_mfma_f32_16x16x32_bf16 v[156:159], v[104:107], a[104:107], v[156:159]
    v_mfma_f32_16x16x32_bf16 v[144:147], v[108:111], a[12:15], v[144:147]
    v_mfma_f32_16x16x32_bf16 v[148:151], v[108:111], a[44:47], v[148:151]
    v_mfma_f32_16x16x32_bf16 v[152:155], v[108:111], a[76:79], v[152:155]
    v_mfma_f32_16x16x32_bf16 v[156:159], v[108:111], a[108:111], v[156:159]
    s_waitcnt vmcnt(8)
    ds_read_b128 v[64:67], v60 offset:0
    v_mfma_f32_16x16x32_bf16 v[144:147], v[112:115], a[16:19], v[144:147]
    v_mfma_f32_16x16x32_bf16 v[148:151], v[112:115], a[48:51], v[148:151]
    ds_read_b128 v[68:71], v61 offset:0
    v_mfma_f32_16x16x32_bf16 v[152:155], v[112:115], a[80:83], v[152:155]
    v_mfma_f32_16x16x32_bf16 v[156:159], v[112:115], a[112:115], v[156:159]
    ds_read_b128 v[72:75], v62 offset:0
    v_mfma_f32_16x16x32_bf16 v[144:147], v[116:119], a[20:23], v[144:147]
    v_mfma_f32_16x16x32_bf16 v[148:151], v[116:119], a[52:55], v[148:151]
    ds_read_b128 v[76:79], v63 offset:0
    v_mfma_f32_16x16x32_bf16 v[152:155], v[116:119], a[84:87], v[152:155]
    v_mfma_f32_16x16x32_bf16 v[156:159], v[116:119], a[116:119], v[156:159]
    ds_read_b128 v[80:83], v60 offset:256
    v_mfma_f32_16x16x32_bf16 v[144:147], v[120:123], a[24:27], v[144:147]
    v_mfma_f32_16x16x32_bf16 v[148:151], v[120:123], a[56:59], v[148:151]
    ds_read_b128 v[84:87], v61 offset:256
    v_mfma_f32_16x16x32_bf16 v[152:155], v[120:123], a[88:91], v[152:155]
    v_mfma_f32_16x16x32_bf16 v[156:159], v[120:123], a[120:123], v[156:159]
    ds_read_b128 v[88:91], v62 offset:256
    v_mfma_f32_16x16x32_bf16 v[144:147], v[124:127], a[28:31], v[144:147]
    v_mfma_f32_16x16x32_bf16 v[148:151], v[124:127], a[60:63], v[148:151]
    ds_read_b128 v[92:95], v63 offset:256
    v_mfma_f32_16x16x32_bf16 v[152:155], v[124:127], a[92:95], v[152:155]
    v_mfma_f32_16x16x32_bf16 v[156:159], v[124:127], a[124:127], v[156:159]
    s_waitcnt lgkmcnt(0)
    s_mul_i32 s68, s96, s83
    v_mul_f32 v128, s76, v128
    v_mul_f32 v129, s76, v129
    v_mul_f32 v130, s76, v130
    v_mul_f32 v131, s76, v131
    v_cvt_pk_bf16_f32 v192, v128, v129
    v_cvt_pk_bf16_f32 v193, v130, v131
    v_mul_f32 v144, s76, v144
    v_mul_f32 v145, s76, v145
    v_mul_f32 v146, s76, v146
    v_mul_f32 v147, s76, v147
    v_cvt_pk_bf16_f32 v194, v144, v145
    v_cvt_pk_bf16_f32 v195, v146, v147
    buffer_store_dwordx4 v[192:195], v28, s[8:11], s68 offen sc1
    v_mul_f32 v132, s76, v132
    v_mul_f32 v133, s76, v133
    v_mul_f32 v134, s76, v134
    v_mul_f32 v135, s76, v135
    v_cvt_pk_bf16_f32 v196, v132, v133
    v_cvt_pk_bf16_f32 v197, v134, v135
    v_mul_f32 v148, s76, v148
    v_mul_f32 v149, s76, v149
    v_mul_f32 v150, s76, v150
    v_mul_f32 v151, s76, v151
    v_cvt_pk_bf16_f32 v198, v148, v149
    v_cvt_pk_bf16_f32 v199, v150, v151
    buffer_store_dwordx4 v[196:199], v29, s[8:11], s68 offen sc1
    v_mul_f32 v136, s76, v136
    v_mul_f32 v137, s76, v137
    v_mul_f32 v138, s76, v138
    v_mul_f32 v139, s76, v139
    v_cvt_pk_bf16_f32 v200, v136, v137
    v_cvt_pk_bf16_f32 v201, v138, v139
    v_mul_f32 v152, s76, v152
    v_mul_f32 v153, s76, v153
    v_mul_f32 v154, s76, v154
    v_mul_f32 v155, s76, v155
    v_cvt_pk_bf16_f32 v202, v152, v153
    v_cvt_pk_bf16_f32 v203, v154, v155
    buffer_store_dwordx4 v[200:203], v30, s[8:11], s68 offen sc1
    v_mul_f32 v140, s76, v140
    v_mul_f32 v141, s76, v141
    v_mul_f32 v142, s76, v142
    v_mul_f32 v143, s76, v143
    v_cvt_pk_bf16_f32 v204, v140, v141
    v_cvt_pk_bf16_f32 v205, v142, v143
    v_mul_f32 v156, s76, v156
    v_mul_f32 v157, s76, v157
    v_mul_f32 v158, s76, v158
    v_mul_f32 v159, s76, v159
    v_cvt_pk_bf16_f32 v206, v156, v157
    v_cvt_pk_bf16_f32 v207, v158, v159
    buffer_store_dwordx4 v[204:207], v31, s[8:11], s68 offen sc1
    v_mfma_f32_16x16x32_bf16 v[160:163], v[64:67], a[0:3], 0
    s_lshl_b32 s78, s98, 18
    s_add_u32 s78, s78, s79
    s_add_u32 m0, s81, 0
    s_nop 0
    buffer_load_dwordx4 v16, s[92:95], s78 offen lds
    v_mfma_f32_16x16x32_bf16 v[164:167], v[64:67], a[32:35], 0
    v_mfma_f32_16x16x32_bf16 v[168:171], v[64:67], a[64:67], 0
    v_mfma_f32_16x16x32_bf16 v[172:175], v[64:67], a[96:99], 0
    v_mfma_f32_16x16x32_bf16 v[160:163], v[68:71], a[4:7], v[160:163]
    s_add_u32 m0, s81, 1024
    s_nop 0
    buffer_load_dwordx4 v17, s[92:95], s78 offen lds
    v_mfma_f32_16x16x32_bf16 v[164:167], v[68:71], a[36:39], v[164:167]
    v_mfma_f32_16x16x32_bf16 v[168:171], v[68:71], a[68:71], v[168:171]
    v_mfma_f32_16x16x32_bf16 v[172:175], v[68:71], a[100:103], v[172:175]
    v_mfma_f32_16x16x32_bf16 v[160:163], v[72:75], a[8:11], v[160:163]
    s_add_u32 m0, s81, 2048
    s_nop 0
    buffer_load_dwordx4 v18, s[92:95], s78 offen lds
    v_mfma_f32_16x16x32_bf16 v[164:167], v[72:75], a[40:43], v[164:167]
    v_mfma_f32_16x16x32_bf16 v[168:171], v[72:75], a[72:75], v[168:171]
    v_mfma_f32_16x16x32_bf16 v[172:175], v[72:75], a[104:107], v[172:175]
    v_mfma_f32_16x16x32_bf16 v[160:163], v[76:79], a[12:15], v[160:163]
    s_add_u32 m0, s81, 3072
    s_nop 0
    buffer_load_dwordx4 v19, s[92:95], s78 offen lds
    v_mfma_f32_16x16x32_bf16 v[164:167], v[76:79], a[44:47], v[164:167]
    v_mfma_f32_16x16x32_bf16 v[168:171], v[76:79], a[76:79], v[168:171]
    v_mfma_f32_16x16x32_bf16 v[172:175], v[76:79], a[108:111], v[172:175]
    s_waitcnt vmcnt(8)
    ds_read_b128 v[96:99], v60 offset:32768
    v_mfma_f32_16x16x32_bf16 v[160:163], v[80:83], a[16:19], v[160:163]
    s_add_u32 m0, s81, 4096
    s_nop 0
    buffer_load_dwordx4 v20, s[92:95], s78 offen lds
    v_mfma_f32_16x16x32_bf16 v[164:167], v[80:83], a[48:51], v[164:167]
    ds_read_b128 v[100:103], v61 offset:32768
    v_mfma_f32_16x16x32_bf16 v[168:171], v[80:83], a[80:83], v[168:171]
    v_mfma_f32_16x16x32_bf16 v[172:175], v[80:83], a[112:115], v[172:175]
    ds_read_b128 v[104:107], v62 offset:32768
    v_mfma_f32_16x16x32_bf16 v[160:163], v[84:87], a[20:23], v[160:163]
    s_add_u32 m0, s81, 5120
    s_nop 0
    buffer_load_dwordx4 v21, s[92:95], s78 offen lds
    v_mfma_f32_16x16x32_bf16 v[164:167], v[84:87], a[52:55], v[164:167]
    ds_read_b128 v[108:111], v63 offset:32768
    v_mfma_f32_16x16x32_bf16 v[168:171], v[84:87], a[84:87], v[168:171]
    v_mfma_f32_16x16x32_bf16 v[172:175], v[84:87], a[116:119], v[172:175]
    ds_read_b128 v[112:115], v60 offset:33024
    v_mfma_f32_16x16x32_bf16 v[160:163], v[88:91], a[24:27], v[160:163]
    s_add_u32 m0, s81, 6144
    s_nop 0
    buffer_load_dwordx4 v22, s[92:95], s78 offen lds
    v_mfma_f32_16x16x32_bf16 v[164:167], v[88:91], a[56:59], v[164:167]
    ds_read_b128 v[116:119], v61 offset:33024
    v_mfma_f32_16x16x32_bf16 v[168:171], v[88:91], a[88:91], v[168:171]
    v_mfma_f32_16x16x32_bf16 v[172:175], v[88:91], a[120:123], v[172:175]
    ds_read_b128 v[120:123], v62 offset:33024
    v_mfma_f32_16x16x32_bf16 v[160:163], v[92:95], a[28:31], v[160:163]
    s_add_u32 m0, s81, 7168
    s_nop 0
    buffer_load_dwordx4 v23, s[92:95], s78 offen lds
    v_mfma_f32_16x16x32_bf16 v[164:167], v[92:95], a[60:63], v[164:167]
    ds_read_b128 v[124:127], v63 offset:33024
    v_mfma_f32_16x16x32_bf16 v[168:171], v[92:95], a[92:95], v[168:171]
    v_mfma_f32_16x16x32_bf16 v[172:175], v[92:95], a[124:127], v[172:175]
    s_lshl_b32 s65, s71, 2
    s_add_u32 s65, s65, s60
    s_mul_i32 s66, s65, 9363
    s_lshr_b32 s66, s66, 16
    s_mul_i32 s67, s66, 7
    s_sub_u32 s67, s65, s67
    s_lshl_b32 s67, s67, 7
    s_lshr_b32 s68, s66, 1
    s_mul_i32 s68, s68, 28672
    s_add_u32 s67, s67, s68
    s_and_b32 s68, s66, 1
    s_mul_i32 s68, s68, 3584
    s_add_u32 s67, s67, s68
    v_mov_b32 v48, 0
    v_bfe_u32 v1, v0, 2, 2
    v_mul_u32_u24 v1, 7168, v1
    v_add_u32 v48, v48, v1
    v_bfe_u32 v1, v0, 0, 2
    v_mul_u32_u24 v1, 896, v1
    v_add_u32 v48, v48, v1
    v_bfe_u32 v1, v0, 4, 2
    v_lshl_add_u32 v48, v1, 4, v48
    buffer_load_dwordx4 v[40:43], v48, s[12:15], s67 offen
    buffer_load_dwordx4 v[44:47], v48, s[12:15], s67 offen offset:64
    s_lshl_b32 s100, s65, 11
    s_add_u32 s100, s100, 92274688
    s_lshr_b32 s66, s66, 1
    s_mul_i32 s67, s66, 14
    s_sub_u32 s65, s65, s67
    s_lshl_b32 s101, s66, 15
    s_lshl_b32 s67, s65, 11
    s_add_u32 s101, s101, s67
    s_add_u32 s101, s101, 90177536
    s_mul_i32 s66, s66, 28672
    s_lshr_b32 s67, s65, 1
    s_lshl_b32 s67, s67, 5
    s_add_u32 s66, s66, s67
    s_and_b32 s67, s65, 1
    s_mul_i32 s67, s67, 896
    s_add_u32 s66, s66, s67
    v_mov_b32 v49, 0
    v_bfe_u32 v1, v0, 3, 1
    v_mul_u32_u24 v1, 14336, v1
    v_add_u32 v49, v49, v1
    v_bfe_u32 v1, v0, 0, 2
    v_mul_u32_u24 v1, 3584, v1
    v_add_u32 v49, v49, v1
    v_bfe_u32 v1, v0, 2, 1
    v_mul_u32_u24 v1, 1792, v1
    v_add_u32 v49, v49, v1
    v_bfe_u32 v1, v0, 5, 1
    v_mul_u32_u24 v1, 224, v1
    v_add_u32 v49, v49, v1
    v_bfe_u32 v1, v0, 4, 1
    v_lshl_add_u32 v49, v1, 4, v49
    buffer_load_dwordx4 v[32:35], v49, s[12:15], s66 offen
    buffer_load_dwordx4 v[36:39], v49, s[12:15], s66 offen offset:448
    v_lshlrev_b32 v48, 4, v0
    s_waitcnt lgkmcnt(0)
    v_mfma_f32_16x16x32_bf16 v[176:179], v[96:99], a[0:3], 0
    s_lshl_b32 s78, s98, 18
    s_add_u32 s78, s78, s79
    s_add_u32 s78, s78, 16384
    s_add_u32 m0, s81, 32768
    s_nop 0
    buffer_load_dwordx4 v16, s[92:95], s78 offen lds
    s_waitcnt vmcnt(13)
    v_mov_b32 v12, 1
    buffer_store_dword v12, v14, s[8:11], 0 offen sc1
    v_mfma_f32_16x16x32_bf16 v[180:183], v[96:99], a[32:35], 0
    v_mfma_f32_16x16x32_bf16 v[184:187], v[96:99], a[64:67], 0
    v_mfma_f32_16x16x32_bf16 v[188:191], v[96:99], a[96:99], 0
    v_mfma_f32_16x16x32_bf16 v[176:179], v[100:103], a[4:7], v[176:179]
    s_add_u32 m0, s81, 33792
    s_nop 0
    buffer_load_dwordx4 v17, s[92:95], s78 offen lds
    v_mfma_f32_16x16x32_bf16 v[180:183], v[100:103], a[36:39], v[180:183]
    v_mfma_f32_16x16x32_bf16 v[184:187], v[100:103], a[68:71], v[184:187]
    v_mfma_f32_16x16x32_bf16 v[188:191], v[100:103], a[100:103], v[188:191]
    v_mfma_f32_16x16x32_bf16 v[176:179], v[104:107], a[8:11], v[176:179]
    s_add_u32 m0, s81, 34816
    s_nop 0
    buffer_load_dwordx4 v18, s[92:95], s78 offen lds
    v_mfma_f32_16x16x32_bf16 v[180:183], v[104:107], a[40:43], v[180:183]
    v_mfma_f32_16x16x32_bf16 v[184:187], v[104:107], a[72:75], v[184:187]
    v_mfma_f32_16x16x32_bf16 v[188:191], v[104:107], a[104:107], v[188:191]
    v_mfma_f32_16x16x32_bf16 v[176:179], v[108:111], a[12:15], v[176:179]
    s_add_u32 m0, s81, 35840
    s_nop 0
    buffer_load_dwordx4 v19, s[92:95], s78 offen lds
    v_mfma_f32_16x16x32_bf16 v[180:183], v[108:111], a[44:47], v[180:183]
    v_mfma_f32_16x16x32_bf16 v[184:187], v[108:111], a[76:79], v[184:187]
    v_mfma_f32_16x16x32_bf16 v[188:191], v[108:111], a[108:111], v[188:191]
    s_waitcnt vmcnt(9)
    ds_read_b128 v[64:67], v24 offset:0
    v_mfma_f32_16x16x32_bf16 v[176:179], v[112:115], a[16:19], v[176:179]
    s_add_u32 m0, s81, 36864
    s_nop 0
    buffer_load_dwordx4 v20, s[92:95], s78 offen lds
    v_mfma_f32_16x16x32_bf16 v[180:183], v[112:115], a[48:51], v[180:183]
    ds_read_b128 v[68:71], v25 offset:0
    v_mfma_f32_16x16x32_bf16 v[184:187], v[112:115], a[80:83], v[184:187]
    v_mfma_f32_16x16x32_bf16 v[188:191], v[112:115], a[112:115], v[188:191]
    ds_read_b128 v[72:75], v26 offset:0
    v_mfma_f32_16x16x32_bf16 v[176:179], v[116:119], a[20:23], v[176:179]
    s_add_u32 m0, s81, 37888
    s_nop 0
    buffer_load_dwordx4 v21, s[92:95], s78 offen lds
    v_mfma_f32_16x16x32_bf16 v[180:183], v[116:119], a[52:55], v[180:183]
    ds_read_b128 v[76:79], v27 offset:0
    v_mfma_f32_16x16x32_bf16 v[184:187], v[116:119], a[84:87], v[184:187]
    v_mfma_f32_16x16x32_bf16 v[188:191], v[116:119], a[116:119], v[188:191]
    ds_read_b128 v[80:83], v24 offset:256
    v_mfma_f32_16x16x32_bf16 v[176:179], v[120:123], a[24:27], v[176:179]
    s_add_u32 m0, s81, 38912
    s_nop 0
    buffer_load_dwordx4 v22, s[92:95], s78 offen lds
    v_mfma_f32_16x16x32_bf16 v[180:183], v[120:123], a[56:59], v[180:183]
    ds_read_b128 v[84:87], v25 offset:256
    v_mfma_f32_16x16x32_bf16 v[184:187], v[120:123], a[88:91], v[184:187]
    v_mfma_f32_16x16x32_bf16 v[188:191], v[120:123], a[120:123], v[188:191]
    ds_read_b128 v[88:91], v26 offset:256
    v_mfma_f32_16x16x32_bf16 v[176:179], v[124:127], a[28:31], v[176:179]
    s_add_u32 m0, s81, 39936
    s_nop 0
    buffer_load_dwordx4 v23, s[92:95], s78 offen lds
    v_mfma_f32_16x16x32_bf16 v[180:183], v[124:127], a[60:63], v[180:183]
    ds_read_b128 v[92:95], v27 offset:256
    v_mfma_f32_16x16x32_bf16 v[184:187], v[124:127], a[92:95], v[184:187]
    v_mfma_f32_16x16x32_bf16 v[188:191], v[124:127], a[124:127], v[188:191]
    s_waitcnt lgkmcnt(0)
    v_mfma_f32_16x16x32_bf16 v[128:131], v[64:67], a[0:3], 0
    s_lshl_b32 s78, s99, 18
    s_add_u32 s78, s78, s79
    s_add_u32 m0, s81, 65536
    s_nop 0
    buffer_load_dwordx4 v16, s[92:95], s78 offen lds
    v_mfma_f32_16x16x32_bf16 v[132:135], v[64:67], a[32:35], 0
    v_mfma_f32_16x16x32_bf16 v[136:139], v[64:67], a[64:67], 0
    s_mul_i32 s68, s97, s83
    v_mul_f32 v160, s76, v160
    v_mul_f32 v161, s76, v161
    v_mfma_f32_16x16x32_bf16 v[140:143], v[64:67], a[96:99], 0
    v_mul_f32 v162, s76, v162
    v_mul_f32 v163, s76, v163
    v_mfma_f32_16x16x32_bf16 v[128:131], v[68:71], a[4:7], v[128:131]
    v_cvt_pk_bf16_f32 v208, v160, v161
    v_cvt_pk_bf16_f32 v209, v162, v163
    s_add_u32 m0, s81, 66560
    s_nop 0
    buffer_load_dwordx4 v17, s[92:95], s78 offen lds
    v_mfma_f32_16x16x32_bf16 v[132:135], v[68:71], a[36:39], v[132:135]
    v_mul_f32 v176, s76, v176
    v_mul_f32 v177, s76, v177
    v_mfma_f32_16x16x32_bf16 v[136:139], v[68:71], a[68:71], v[136:139]
    v_mul_f32 v178, s76, v178
    v_mul_f32 v179, s76, v179
    v_mfma_f32_16x16x32_bf16 v[140:143], v[68:71], a[100:103], v[140:143]
    v_cvt_pk_bf16_f32 v210, v176, v177
    v_cvt_pk_bf16_f32 v211, v178, v179
    v_mfma_f32_16x16x32_bf16 v[128:131], v[72:75], a[8:11], v[128:131]
    buffer_store_dwordx4 v[208:211], v28, s[8:11], s68 offen sc1
    v_mul_f32 v164, s76, v164
    s_add_u32 m0, s81, 67584
    s_nop 0
    buffer_load_dwordx4 v18, s[92:95], s78 offen lds
    v_mfma_f32_16x16x32_bf16 v[132:135], v[72:75], a[40:43], v[132:135]
    v_mul_f32 v165, s76, v165
    v_mul_f32 v166, s76, v166
    v_mfma_f32_16x16x32_bf16 v[136:139], v[72:75], a[72:75], v[136:139]
    v_mul_f32 v167, s76, v167
    v_cvt_pk_bf16_f32 v212, v164, v165
    v_mfma_f32_16x16x32_bf16 v[140:143], v[72:75], a[104:107], v[140:143]
    v_cvt_pk_bf16_f32 v213, v166, v167
    v_mul_f32 v180, s76, v180
    v_mfma_f32_16x16x32_bf16 v[128:131], v[76:79], a[12:15], v[128:131]
    v_mul_f32 v181, s76, v181
    v_mul_f32 v182, s76, v182
    s_add_u32 m0, s81, 68608
    s_nop 0
    buffer_load_dwordx4 v19, s[92:95], s78 offen lds
    v_mfma_f32_16x16x32_bf16 v[132:135], v[76:79], a[44:47], v[132:135]
    v_mul_f32 v183, s76, v183
    v_cvt_pk_bf16_f32 v214, v180, v181
    v_mfma_f32_16x16x32_bf16 v[136:139], v[76:79], a[76:79], v[136:139]
    v_cvt_pk_bf16_f32 v215, v182, v183
    buffer_store_dwordx4 v[212:215], v29, s[8:11], s68 offen sc1
    v_mfma_f32_16x16x32_bf16 v[140:143], v[76:79], a[108:111], v[140:143]
    v_mul_f32 v168, s76, v168
    v_mul_f32 v169, s76, v169
    s_waitcnt vmcnt(6)
    ds_read_b128 v[96:99], v24 offset:32768
    v_mfma_f32_16x16x32_bf16 v[128:131], v[80:83], a[16:19], v[128:131]
    v_mul_f32 v170, s76, v170
    v_mul_f32 v171, s76, v171
    s_add_u32 m0, s81, 69632
    s_nop 0
    buffer_load_dwordx4 v20, s[92:95], s78 offen lds
    v_mfma_f32_16x16x32_bf16 v[132:135], v[80:83], a[48:51], v[132:135]
    v_cvt_pk_bf16_f32 v216, v168, v169
    v_cvt_pk_bf16_f32 v217, v170, v171
    ds_read_b128 v[100:103], v25 offset:32768
    v_mfma_f32_16x16x32_bf16 v[136:139], v[80:83], a[80:83], v[136:139]
    v_mul_f32 v184, s76, v184
    v_mul_f32 v185, s76, v185
    v_mfma_f32_16x16x32_bf16 v[140:143], v[80:83], a[112:115], v[140:143]
    v_mul_f32 v186, s76, v186
    v_mul_f32 v187, s76, v187
    ds_read_b128 v[104:107], v26 offset:32768
    v_mfma_f32_16x16x32_bf16 v[128:131], v[84:87], a[20:23], v[128:131]
    v_cvt_pk_bf16_f32 v218, v184, v185
    v_cvt_pk_bf16_f32 v219, v186, v187
    s_add_u32 m0, s81, 70656
    s_nop 0
    buffer_load_dwordx4 v21, s[92:95], s78 offen lds
    v_mfma_f32_16x16x32_bf16 v[132:135], v[84:87], a[52:55], v[132:135]
    buffer_store_dwordx4 v[216:219], v30, s[8:11], s68 offen sc1
    v_mul_f32 v172, s76, v172
    ds_read_b128 v[108:111], v27 offset:32768
    v_mfma_f32_16x16x32_bf16 v[136:139], v[84:87], a[84:87], v[136:139]
    v_mul_f32 v173, s76, v173
    v_mul_f32 v174, s76, v174
    v_mfma_f32_16x16x32_bf16 v[140:143], v[84:87], a[116:119], v[140:143]
    v_mul_f32 v175, s76, v175
    v_cvt_pk_bf16_f32 v220, v172, v173
    ds_read_b128 v[112:115], v24 offset:33024
    v_mfma_f32_16x16x32_bf16 v[128:131], v[88:91], a[24:27], v[128:131]
    v_cvt_pk_bf16_f32 v221, v174, v175
    v_mul_f32 v188, s76, v188
    s_add_u32 m0, s81, 71680
    s_nop 0
    buffer_load_dwordx4 v22, s[92:95], s78 offen lds
    v_mfma_f32_16x16x32_bf16 v[132:135], v[88:91], a[56:59], v[132:135]
    v_mul_f32 v189, s76, v189
    v_mul_f32 v190, s76, v190
    ds_read_b128 v[116:119], v25 offset:33024
    v_mfma_f32_16x16x32_bf16 v[136:139], v[88:91], a[88:91], v[136:139]
    v_mul_f32 v191, s76, v191
    v_cvt_pk_bf16_f32 v222, v188, v189
    v_mfma_f32_16x16x32_bf16 v[140:143], v[88:91], a[120:123], v[140:143]
    v_cvt_pk_bf16_f32 v223, v190, v191
    buffer_store_dwordx4 v[220:223], v31, s[8:11], s68 offen sc1
    ds_read_b128 v[120:123], v26 offset:33024
    v_mfma_f32_16x16x32_bf16 v[128:131], v[92:95], a[28:31], v[128:131]
    s_add_u32 m0, s81, 72704
    s_nop 0
    buffer_load_dwordx4 v23, s[92:95], s78 offen lds
    v_mfma_f32_16x16x32_bf16 v[132:135], v[92:95], a[60:63], v[132:135]
    ds_read_b128 v[124:127], v27 offset:33024
    v_mfma_f32_16x16x32_bf16 v[136:139], v[92:95], a[92:95], v[136:139]
    v_mfma_f32_16x16x32_bf16 v[140:143], v[92:95], a[124:127], v[140:143]
    s_waitcnt vmcnt(21)
    buffer_store_dwordx4 v[32:35], v48, s[8:11], s101 offen sc1
    buffer_store_dwordx4 v[36:39], v48, s[8:11], s101 offen offset:1024 sc1
    buffer_store_dwordx4 v[40:43], v48, s[8:11], s100 offen sc1
    buffer_store_dwordx4 v[44:47], v48, s[8:11], s100 offen offset:1024 sc1
    s_waitcnt lgkmcnt(0)
    v_mfma_f32_16x16x32_bf16 v[144:147], v[96:99], a[0:3], 0
    s_lshl_b32 s78, s99, 18
    s_add_u32 s78, s78, s79
    s_add_u32 s78, s78, 16384
    s_add_u32 m0, s81, 98304
    s_nop 0
    buffer_load_dwordx4 v16, s[92:95], s78 offen lds
    v_mfma_f32_16x16x32_bf16 v[148:151], v[96:99], a[32:35], 0
    v_mfma_f32_16x16x32_bf16 v[152:155], v[96:99], a[64:67], 0
    v_mfma_f32_16x16x32_bf16 v[156:159], v[96:99], a[96:99], 0
    v_mfma_f32_16x16x32_bf16 v[144:147], v[100:103], a[4:7], v[144:147]
    s_add_u32 m0, s81, 99328
    s_nop 0
    buffer_load_dwordx4 v17, s[92:95], s78 offen lds
    v_mfma_f32_16x16x32_bf16 v[148:151], v[100:103], a[36:39], v[148:151]
    v_mfma_f32_16x16x32_bf16 v[152:155], v[100:103], a[68:71], v[152:155]
    v_mfma_f32_16x16x32_bf16 v[156:159], v[100:103], a[100:103], v[156:159]
    v_mfma_f32_16x16x32_bf16 v[144:147], v[104:107], a[8:11], v[144:147]
    s_add_u32 m0, s81, 100352
    s_nop 0
    buffer_load_dwordx4 v18, s[92:95], s78 offen lds
    v_mfma_f32_16x16x32_bf16 v[148:151], v[104:107], a[40:43], v[148:151]
    v_mfma_f32_16x16x32_bf16 v[152:155], v[104:107], a[72:75], v[152:155]
    v_mfma_f32_16x16x32_bf16 v[156:159], v[104:107], a[104:107], v[156:159]
    v_mfma_f32_16x16x32_bf16 v[144:147], v[108:111], a[12:15], v[144:147]
    s_add_u32 m0, s81, 101376
    s_nop 0
    buffer_load_dwordx4 v19, s[92:95], s78 offen lds
    v_mfma_f32_16x16x32_bf16 v[148:151], v[108:111], a[44:47], v[148:151]
    s_waitcnt vmcnt(9)
    v_mov_b32 v12, 2
    buffer_store_dword v12, v14, s[8:11], 0 offen sc1
    v_mfma_f32_16x16x32_bf16 v[152:155], v[108:111], a[76:79], v[152:155]
    v_mfma_f32_16x16x32_bf16 v[156:159], v[108:111], a[108:111], v[156:159]
    s_waitcnt vmcnt(9)
    ds_read_b128 v[64:67], v60 offset:0
    v_mfma_f32_16x16x32_bf16 v[144:147], v[112:115], a[16:19], v[144:147]
    s_add_u32 m0, s81, 102400
    s_nop 0
    buffer_load_dwordx4 v20, s[92:95], s78 offen lds
    v_mfma_f32_16x16x32_bf16 v[148:151], v[112:115], a[48:51], v[148:151]
    ds_read_b128 v[68:71], v61 offset:0
    v_mfma_f32_16x16x32_bf16 v[152:155], v[112:115], a[80:83], v[152:155]
    v_mfma_f32_16x16x32_bf16 v[156:159], v[112:115], a[112:115], v[156:159]
    ds_read_b128 v[72:75], v62 offset:0
    v_mfma_f32_16x16x32_bf16 v[144:147], v[116:119], a[20:23], v[144:147]
    s_add_u32 m0, s81, 103424
    s_nop 0
    buffer_load_dwordx4 v21, s[92:95], s78 offen lds
    v_mfma_f32_16x16x32_bf16 v[148:151], v[116:119], a[52:55], v[148:151]
    ds_read_b128 v[76:79], v63 offset:0
    v_mfma_f32_16x16x32_bf16 v[152:155], v[116:119], a[84:87], v[152:155]
    v_mfma_f32_16x16x32_bf16 v[156:159], v[116:119], a[116:119], v[156:159]
    ds_read_b128 v[80:83], v60 offset:256
    v_mfma_f32_16x16x32_bf16 v[144:147], v[120:123], a[24:27], v[144:147]
    s_add_u32 m0, s81, 104448
    s_nop 0
    buffer_load_dwordx4 v22, s[92:95], s78 offen lds
    v_mfma_f32_16x16x32_bf16 v[148:151], v[120:123], a[56:59], v[148:151]
    ds_read_b128 v[84:87], v61 offset:256
    v_mfma_f32_16x16x32_bf16 v[152:155], v[120:123], a[88:91], v[152:155]
    v_mfma_f32_16x16x32_bf16 v[156:159], v[120:123], a[120:123], v[156:159]
    ds_read_b128 v[88:91], v62 offset:256
    v_mfma_f32_16x16x32_bf16 v[144:147], v[124:127], a[28:31], v[144:147]
    s_add_u32 m0, s81, 105472
    s_nop 0
    buffer_load_dwordx4 v23, s[92:95], s78 offen lds
    v_mfma_f32_16x16x32_bf16 v[148:151], v[124:127], a[60:63], v[148:151]
    ds_read_b128 v[92:95], v63 offset:256
    v_mfma_f32_16x16x32_bf16 v[152:155], v[124:127], a[92:95], v[152:155]
    v_mfma_f32_16x16x32_bf16 v[156:159], v[124:127], a[124:127], v[156:159]
    s_waitcnt vmcnt(9)
    s_barrier
    v_mov_b32 v15, 1
    v_and_b32 v13, 0xffffff7f, v11
    buffer_atomic_add v15, v13, s[20:23], 0 offen offset:4
    s_cmp_ge_u32 s60, 2
    s_cbranch_scc0 L_w1_last
    s_mul_i32 s68, s98, s83
    v_mul_f32 v128, s76, v128
    v_mul_f32 v129, s76, v129
    v_mul_f32 v130, s76, v130
    v_mul_f32 v131, s76, v131
    v_cvt_pk_bf16_f32 v224, v128, v129
    v_cvt_pk_bf16_f32 v225, v130, v131
    v_mul_f32 v144, s76, v144
    v_mul_f32 v145, s76, v145
    v_mul_f32 v146, s76, v146
    v_mul_f32 v147, s76, v147
    v_cvt_pk_bf16_f32 v226, v144, v145
    v_cvt_pk_bf16_f32 v227, v146, v147
    buffer_store_dwordx4 v[224:227], v28, s[8:11], s68 offen sc1
    v_mul_f32 v132, s76, v132
    v_mul_f32 v133, s76, v133
    v_mul_f32 v134, s76, v134
    v_mul_f32 v135, s76, v135
    v_cvt_pk_bf16_f32 v228, v132, v133
    v_cvt_pk_bf16_f32 v229, v134, v135
    v_mul_f32 v148, s76, v148
    v_mul_f32 v149, s76, v149
    v_mul_f32 v150, s76, v150
    v_mul_f32 v151, s76, v151
    v_cvt_pk_bf16_f32 v230, v148, v149
    v_cvt_pk_bf16_f32 v231, v150, v151
    buffer_store_dwordx4 v[228:231], v29, s[8:11], s68 offen sc1
    v_mul_f32 v136, s76, v136
    v_mul_f32 v137, s76, v137
    v_mul_f32 v138, s76, v138
    v_mul_f32 v139, s76, v139
    v_cvt_pk_bf16_f32 v232, v136, v137
    v_cvt_pk_bf16_f32 v233, v138, v139
    v_mul_f32 v152, s76, v152
    v_mul_f32 v153, s76, v153
    v_mul_f32 v154, s76, v154
    v_mul_f32 v155, s76, v155
    v_cvt_pk_bf16_f32 v234, v152, v153
    v_cvt_pk_bf16_f32 v235, v154, v155
    buffer_store_dwordx4 v[232:235], v30, s[8:11], s68 offen sc1
    v_mul_f32 v140, s76, v140
    v_mul_f32 v141, s76, v141
    v_mul_f32 v142, s76, v142
    v_mul_f32 v143, s76, v143
    v_cvt_pk_bf16_f32 v236, v140, v141
    v_cvt_pk_bf16_f32 v237, v142, v143
    v_mul_f32 v156, s76, v156
    v_mul_f32 v157, s76, v157
    v_mul_f32 v158, s76, v158
    v_mul_f32 v159, s76, v159
    v_cvt_pk_bf16_f32 v238, v156, v157
    v_cvt_pk_bf16_f32 v239, v158, v159
    buffer_store_dwordx4 v[236:239], v31, s[8:11], s68 offen sc1
    s_branch L_w1_done
L_w1_last:
    s_waitcnt lgkmcnt(0)
    v_mfma_f32_16x16x32_bf16 v[160:163], v[64:67], a[0:3], 0
    v_mfma_f32_16x16x32_bf16 v[164:167], v[64:67], a[32:35], 0
    v_mfma_f32_16x16x32_bf16 v[168:171], v[64:67], a[64:67], 0
    s_mul_i32 s68, s98, s83
    v_mul_f32 v128, s76, v128
    v_mul_f32 v129, s76, v129
    v_mfma_f32_16x16x32_bf16 v[172:175], v[64:67], a[96:99], 0
    v_mul_f32 v130, s76, v130
    v_mul_f32 v131, s76, v131
    v_mfma_f32_16x16x32_bf16 v[160:163], v[68:71], a[4:7], v[160:163]
    v_cvt_pk_bf16_f32 v224, v128, v129
    v_cvt_pk_bf16_f32 v225, v130, v131
    v_mfma_f32_16x16x32_bf16 v[164:167], v[68:71], a[36:39], v[164:167]
    v_mul_f32 v144, s76, v144
    v_mul_f32 v145, s76, v145
    v_mfma_f32_16x16x32_bf16 v[168:171], v[68:71], a[68:71], v[168:171]
    v_mul_f32 v146, s76, v146
    v_mul_f32 v147, s76, v147
    v_mfma_f32_16x16x32_bf16 v[172:175], v[68:71], a[100:103], v[172:175]
    v_cvt_pk_bf16_f32 v226, v144, v145
    v_cvt_pk_bf16_f32 v227, v146, v147
    v_mfma_f32_16x16x32_bf16 v[160:163], v[72:75], a[8:11], v[160:163]
    buffer_store_dwordx4 v[224:227], v28, s[8:11], s68 offen sc1
    v_mul_f32 v132, s76, v132
    v_mfma_f32_16x16x32_bf16 v[164:167], v[72:75], a[40:43], v[164:167]
    v_mul_f32 v133, s76, v133
    v_mul_f32 v134, s76, v134
    v_mfma_f32_16x16x32_bf16 v[168:171], v[72:75], a[72:75], v[168:171]
    v_mul_f32 v135, s76, v135
    v_cvt_pk_bf16_f32 v228, v132, v133
    v_mfma_f32_16x16x32_bf16 v[172:175], v[72:75], a[104:107], v[172:175]
    v_cvt_pk_bf16_f32 v229, v134, v135
    v_mul_f32 v148, s76, v148
    v_mfma_f32_16x16x32_bf16 v[160:163], v[76:79], a[12:15], v[160:163]
    v_mul_f32 v149, s76, v149
    v_mul_f32 v150, s76, v150
    v_mfma_f32_16x16x32_bf16 v[164:167], v[76:79], a[44:47], v[164:167]
    v_mul_f32 v151, s76, v151
    v_cvt_pk_bf16_f32 v230, v148, v149
    v_mfma_f32_16x16x32_bf16 v[168:171], v[76:79], a[76:79], v[168:171]
    v_cvt_pk_bf16_f32 v231, v150, v151
    buffer_store_dwordx4 v[228:231], v29, s[8:11], s68 offen sc1
    v_mfma_f32_16x16x32_bf16 v[172:175], v[76:79], a[108:111], v[172:175]
    v_mul_f32 v136, s76, v136
    v_mul_f32 v137, s76, v137
    s_waitcnt vmcnt(3)
    ds_read_b128 v[96:99], v60 offset:32768
    v_mfma_f32_16x16x32_bf16 v[160:163], v[80:83], a[16:19], v[160:163]
    v_mul_f32 v138, s76, v138
    v_mul_f32 v139, s76, v139
    v_mfma_f32_16x16x32_bf16 v[164:167], v[80:83], a[48:51], v[164:167]
    v_cvt_pk_bf16_f32 v232, v136, v137
    v_cvt_pk_bf16_f32 v233, v138, v139
    ds_read_b128 v[100:103], v61 offset:32768
    v_mfma_f32_16x16x32_bf16 v[168:171], v[80:83], a[80:83], v[168:171]
    v_mul_f32 v152, s76, v152
    v_mul_f32 v153, s76, v153
    v_mfma_f32_16x16x32_bf16 v[172:175], v[80:83], a[112:115], v[172:175]
    v_mul_f32 v154, s76, v154
    v_mul_f32 v155, s76, v155
    ds_read_b128 v[104:107], v62 offset:32768
    v_mfma_f32_16x16x32_bf16 v[160:163], v[84:87], a[20:23], v[160:163]
    v_cvt_pk_bf16_f32 v234, v152, v153
    v_cvt_pk_bf16_f32 v235, v154, v155
    v_mfma_f32_16x16x32_bf16 v[164:167], v[84:87], a[52:55], v[164:167]
    buffer_store_dwordx4 v[232:235], v30, s[8:11], s68 offen sc1
    v_mul_f32 v140, s76, v140
    ds_read_b128 v[108:111], v63 offset:32768
    v_mfma_f32_16x16x32_bf16 v[168:171], v[84:87], a[84:87], v[168:171]
    v_mul_f32 v141, s76, v141
    v_mul_f32 v142, s76, v142
    v_mfma_f32_16x16x32_bf16 v[172:175], v[84:87], a[116:119], v[172:175]
    v_mul_f32 v143, s76, v143
    v_cvt_pk_bf16_f32 v236, v140, v141
    ds_read_b128 v[112:115], v60 offset:33024
    v_mfma_f32_16x16x32_bf16 v[160:163], v[88:91], a[24:27], v[160:163]
    v_cvt_pk_bf16_f32 v237, v142, v143
    v_mul_f32 v156, s76, v156
    v_mfma_f32_16x16x32_bf16 v[164:167], v[88:91], a[56:59], v[164:167]
    v_mul_f32 v157, s76, v157
    v_mul_f32 v158, s76, v158
    ds_read_b128 v[116:119], v61 offset:33024
    v_mfma_f32_16x16x32_bf16 v[168:171], v[88:91], a[88:91], v[168:171]
    v_mul_f32 v159, s76, v159
    v_cvt_pk_bf16_f32 v238, v156, v157
    v_mfma_f32_16x16x32_bf16 v[172:175], v[88:91], a[120:123], v[172:175]
    v_cvt_pk_bf16_f32 v239, v158, v159
    buffer_store_dwordx4 v[236:239], v31, s[8:11], s68 offen sc1
    ds_read_b128 v[120:123], v62 offset:33024
    v_mfma_f32_16x16x32_bf16 v[160:163], v[92:95], a[28:31], v[160:163]
    v_mfma_f32_16x16x32_bf16 v[164:167], v[92:95], a[60:63], v[164:167]
    ds_read_b128 v[124:127], v63 offset:33024
    v_mfma_f32_16x16x32_bf16 v[168:171], v[92:95], a[92:95], v[168:171]
    v_mfma_f32_16x16x32_bf16 v[172:175], v[92:95], a[124:127], v[172:175]
    s_waitcnt lgkmcnt(0)
    v_mfma_f32_16x16x32_bf16 v[176:179], v[96:99], a[0:3], 0
    v_mfma_f32_16x16x32_bf16 v[180:183], v[96:99], a[32:35], 0
    v_mfma_f32_16x16x32_bf16 v[184:187], v[96:99], a[64:67], 0
    v_mfma_f32_16x16x32_bf16 v[188:191], v[96:99], a[96:99], 0
    v_mfma_f32_16x16x32_bf16 v[176:179], v[100:103], a[4:7], v[176:179]
    v_mfma_f32_16x16x32_bf16 v[180:183], v[100:103], a[36:39], v[180:183]
    v_mfma_f32_16x16x32_bf16 v[184:187], v[100:103], a[68:71], v[184:187]
    v_mfma_f32_16x16x32_bf16 v[188:191], v[100:103], a[100:103], v[188:191]
    v_mfma_f32_16x16x32_bf16 v[176:179], v[104:107], a[8:11], v[176:179]
    v_mfma_f32_16x16x32_bf16 v[180:183], v[104:107], a[40:43], v[180:183]
    v_mfma_f32_16x16x32_bf16 v[184:187], v[104:107], a[72:75], v[184:187]
    v_mfma_f32_16x16x32_bf16 v[188:191], v[104:107], a[104:107], v[188:191]
    v_mfma_f32_16x16x32_bf16 v[176:179], v[108:111], a[12:15], v[176:179]
    v_mfma_f32_16x16x32_bf16 v[180:183], v[108:111], a[44:47], v[180:183]
    s_waitcnt vmcnt(0)
    v_mov_b32 v12, 3
    buffer_store_dword v12, v14, s[8:11], 0 offen sc1
    v_mfma_f32_16x16x32_bf16 v[184:187], v[108:111], a[76:79], v[184:187]
    v_mfma_f32_16x16x32_bf16 v[188:191], v[108:111], a[108:111], v[188:191]
    v_mfma_f32_16x16x32_bf16 v[176:179], v[112:115], a[16:19], v[176:179]
    v_mfma_f32_16x16x32_bf16 v[180:183], v[112:115], a[48:51], v[180:183]
    v_mfma_f32_16x16x32_bf16 v[184:187], v[112:115], a[80:83], v[184:187]
    v_mfma_f32_16x16x32_bf16 v[188:191], v[112:115], a[112:115], v[188:191]
    v_mfma_f32_16x16x32_bf16 v[176:179], v[116:119], a[20:23], v[176:179]
    v_mfma_f32_16x16x32_bf16 v[180:183], v[116:119], a[52:55], v[180:183]
    v_mfma_f32_16x16x32_bf16 v[184:187], v[116:119], a[84:87], v[184:187]
    v_mfma_f32_16x16x32_bf16 v[188:191], v[116:119], a[116:119], v[188:191]
    v_mfma_f32_16x16x32_bf16 v[176:179], v[120:123], a[24:27], v[176:179]
    v_mfma_f32_16x16x32_bf16 v[180:183], v[120:123], a[56:59], v[180:183]
    v_mfma_f32_16x16x32_bf16 v[184:187], v[120:123], a[88:91], v[184:187]
    v_mfma_f32_16x16x32_bf16 v[188:191], v[120:123], a[120:123], v[188:191]
    v_mfma_f32_16x16x32_bf16 v[176:179], v[124:127], a[28:31], v[176:179]
    v_mfma_f32_16x16x32_bf16 v[180:183], v[124:127], a[60:63], v[180:183]
    v_mfma_f32_16x16x32_bf16 v[184:187], v[124:127], a[92:95], v[184:187]
    v_mfma_f32_16x16x32_bf16 v[188:191], v[124:127], a[124:127], v[188:191]
    s_mul_i32 s68, s99, s83
    v_mul_f32 v160, s76, v160
    v_mul_f32 v161, s76, v161
    v_mul_f32 v162, s76, v162
    v_mul_f32 v163, s76, v163
    v_cvt_pk_bf16_f32 v240, v160, v161
    v_cvt_pk_bf16_f32 v241, v162, v163
    v_mul_f32 v176, s76, v176
    v_mul_f32 v177, s76, v177
    v_mul_f32 v178, s76, v178
    v_mul_f32 v179, s76, v179
    v_cvt_pk_bf16_f32 v242, v176, v177
    v_cvt_pk_bf16_f32 v243, v178, v179
    buffer_store_dwordx4 v[240:243], v28, s[8:11], s68 offen sc1
    v_mul_f32 v164, s76, v164
    v_mul_f32 v165, s76, v165
    v_mul_f32 v166, s76, v166
    v_mul_f32 v167, s76, v167
    v_cvt_pk_bf16_f32 v244, v164, v165
    v_cvt_pk_bf16_f32 v245, v166, v167
    v_mul_f32 v180, s76, v180
    v_mul_f32 v181, s76, v181
    v_mul_f32 v182, s76, v182
    v_mul_f32 v183, s76, v183
    v_cvt_pk_bf16_f32 v246, v180, v181
    v_cvt_pk_bf16_f32 v247, v182, v183
    buffer_store_dwordx4 v[244:247], v29, s[8:11], s68 offen sc1
    v_mul_f32 v168, s76, v168
    v_mul_f32 v169, s76, v169
    v_mul_f32 v170, s76, v170
    v_mul_f32 v171, s76, v171
    v_cvt_pk_bf16_f32 v248, v168, v169
    v_cvt_pk_bf16_f32 v249, v170, v171
    v_mul_f32 v184, s76, v184
    v_mul_f32 v185, s76, v185
    v_mul_f32 v186, s76, v186
    v_mul_f32 v187, s76, v187
    v_cvt_pk_bf16_f32 v250, v184, v185
    v_cvt_pk_bf16_f32 v251, v186, v187
    buffer_store_dwordx4 v[248:251], v30, s[8:11], s68 offen sc1
    v_mul_f32 v172, s76, v172
    v_mul_f32 v173, s76, v173
    v_mul_f32 v174, s76, v174
    v_mul_f32 v175, s76, v175
    v_cvt_pk_bf16_f32 v252, v172, v173
    v_cvt_pk_bf16_f32 v253, v174, v175
    v_mul_f32 v188, s76, v188
    v_mul_f32 v189, s76, v189
    v_mul_f32 v190, s76, v190
    v_mul_f32 v191, s76, v191
    v_cvt_pk_bf16_f32 v254, v188, v189
    v_cvt_pk_bf16_f32 v255, v190, v191
    buffer_store_dwordx4 v[252:255], v31, s[8:11], s68 offen sc1
L_w1_done:
    v_mov_b32 v9, 4
    s_waitcnt vmcnt(0)
    buffer_store_dword v9, v14, s[8:11], 0 offen sc1
    s_waitcnt lgkmcnt(0)
    s_barrier
    v_mov_b32 v8, 105344
    v_bfe_u32 v1, v0, 0, 4
    v_mul_u32_u24 v1, 912, v1
    v_add_u32 v8, v8, v1
    v_bfe_u32 v1, v0, 5, 1
    v_lshl_add_u32 v8, v1, 5, v8
    v_bfe_u32 v1, v0, 4, 1
    v_lshl_add_u32 v8, v1, 3, v8
    s_lshl_b32 s65, s96, 6
    s_add_u32 s66, s65, 0
    v_add_u32 v9, s66, v8
    ds_write2_b32 v9, v192, v194 offset0:0 offset1:1
    ds_write2_b32 v9, v193, v195 offset0:4 offset1:5
    s_add_u32 s66, s65, 14592
    v_add_u32 v9, s66, v8
    ds_write2_b32 v9, v196, v198 offset0:0 offset1:1
    ds_write2_b32 v9, v197, v199 offset0:4 offset1:5
    s_add_u32 s66, s65, 29184
    v_add_u32 v9, s66, v8
    ds_write2_b32 v9, v200, v202 offset0:0 offset1:1
    ds_write2_b32 v9, v201, v203 offset0:4 offset1:5
    s_add_u32 s66, s65, 43776
    v_add_u32 v9, s66, v8
    ds_write2_b32 v9, v204, v206 offset0:0 offset1:1
    ds_write2_b32 v9, v205, v207 offset0:4 offset1:5
    s_waitcnt lgkmcnt(4)
    s_lshl_b32 s65, s97, 6
    s_add_u32 s66, s65, 0
    v_add_u32 v9, s66, v8
    ds_write2_b32 v9, v208, v210 offset0:0 offset1:1
    ds_write2_b32 v9, v209, v211 offset0:4 offset1:5
    s_add_u32 s66, s65, 14592
    v_add_u32 v9, s66, v8
    ds_write2_b32 v9, v212, v214 offset0:0 offset1:1
    ds_write2_b32 v9, v213, v215 offset0:4 offset1:5
    s_add_u32 s66, s65, 29184
    v_add_u32 v9, s66, v8
    ds_write2_b32 v9, v216, v218 offset0:0 offset1:1
    ds_write2_b32 v9, v217, v219 offset0:4 offset1:5
    s_add_u32 s66, s65, 43776
    v_add_u32 v9, s66, v8
    ds_write2_b32 v9, v220, v222 offset0:0 offset1:1
    ds_write2_b32 v9, v221, v223 offset0:4 offset1:5
    s_waitcnt lgkmcnt(4)
    s_lshl_b32 s65, s98, 6
    s_add_u32 s66, s65, 0
    v_add_u32 v9, s66, v8
    ds_write2_b32 v9, v224, v226 offset0:0 offset1:1
    ds_write2_b32 v9, v225, v227 offset0:4 offset1:5
    s_add_u32 s66, s65, 14592
    v_add_u32 v9, s66, v8
    ds_write2_b32 v9, v228, v230 offset0:0 offset1:1
    ds_write2_b32 v9, v229, v231 offset0:4 offset1:5
    s_add_u32 s66, s65, 29184
    v_add_u32 v9, s66, v8
    ds_write2_b32 v9, v232, v234 offset0:0 offset1:1
    ds_write2_b32 v9, v233, v235 offset0:4 offset1:5
    s_add_u32 s66, s65, 43776
    v_add_u32 v9, s66, v8
    ds_write2_b32 v9, v236, v238 offset0:0 offset1:1
    ds_write2_b32 v9, v237, v239 offset0:4 offset1:5
    s_waitcnt lgkmcnt(4)
    s_cmp_ge_u32 s60, 2
    s_cbranch_scc1 L_w1b_s
    s_lshl_b32 s65, s99, 6
    s_add_u32 s66, s65, 0
    v_add_u32 v9, s66, v8
    ds_write2_b32 v9, v240, v242 offset0:0 offset1:1
    ds_write2_b32 v9, v241, v243 offset0:4 offset1:5
    s_add_u32 s66, s65, 14592
    v_add_u32 v9, s66, v8
    ds_write2_b32 v9, v244, v246 offset0:0 offset1:1
    ds_write2_b32 v9, v245, v247 offset0:4 offset1:5
    s_add_u32 s66, s65, 29184
    v_add_u32 v9, s66, v8
    ds_write2_b32 v9, v248, v250 offset0:0 offset1:1
    ds_write2_b32 v9, v249, v251 offset0:4 offset1:5
    s_add_u32 s66, s65, 43776
    v_add_u32 v9, s66, v8
    ds_write2_b32 v9, v252, v254 offset0:0 offset1:1
    ds_write2_b32 v9, v253, v255 offset0:4 offset1:5
    s_waitcnt lgkmcnt(4)
L_w1b_s:
    s_cmp_lg_u32 s74, 0
    s_cbranch_scc1 L_w1b_b
    s_waitcnt lgkmcnt(0)
    s_cmp_lg_u32 s60, 0
    s_cbranch_scc1 L_wd_done_312
    v_mov_b32 v2, 208
L_wd_311:
    buffer_load_dword v3, v2, s[20:23], 0 offen sc1
    s_waitcnt vmcnt(0)
    v_cmp_gt_u32 vcc, 1, v3
    s_cbranch_vccnz L_retry_313
L_wd_done_312:
    s_barrier
    s_barrier
    v_mov_b32 v4, 0
    v_bfe_u32 v1, v0, 2, 4
    v_mul_u32_u24 v1, 2688, v1
    v_add_u32 v4, v4, v1
    v_bfe_u32 v1, v0, 0, 2
    v_lshl_add_u32 v4, v1, 4, v4
    s_mul_i32 s77, s60, 301056
    s_mul_i32 s65, s72, 56
    s_add_u32 s77, s77, s65
    buffer_load_dwordx4 v[16:19], v4, s[48:51], s77 offen offset:0
    buffer_load_dwordx4 v[20:23], v4, s[48:51], s77 offen offset:896
    buffer_load_dwordx4 v[24:27], v4, s[48:51], s77 offen offset:1792
    s_add_u32 s77, s77, 43008
    buffer_load_dwordx4 v[28:31], v4, s[48:51], s77 offen offset:0
    buffer_load_dwordx4 v[32:35], v4, s[48:51], s77 offen offset:896
    buffer_load_dwordx4 v[36:39], v4, s[48:51], s77 offen offset:1792
    s_add_u32 s77, s77, 43008
    buffer_load_dwordx4 v[40:43], v4, s[48:51], s77 offen offset:0
    buffer_load_dwordx4 v[44:47], v4, s[48:51], s77 offen offset:896
    buffer_load_dwordx4 v[48:51], v4, s[48:51], s77 offen offset:1792
    s_add_u32 s77, s77, 43008
    buffer_load_dwordx4 v[52:55], v4, s[48:51], s77 offen offset:0
    buffer_load_dwordx4 v[56:59], v4, s[48:51], s77 offen offset:896
    buffer_load_dwordx4 v[60:63], v4, s[48:51], s77 offen offset:1792
    s_add_u32 s77, s77, 43008
    buffer_load_dwordx4 v[64:67], v4, s[48:51], s77 offen offset:0
    buffer_load_dwordx4 v[68:71], v4, s[48:51], s77 offen offset:896
    buffer_load_dwordx4 v[72:75], v4, s[48:51], s77 offen offset:1792
    s_add_u32 s77, s77, 43008
    buffer_load_dwordx4 v[76:79], v4, s[48:51], s77 offen offset:0
    buffer_load_dwordx4 v[80:83], v4, s[48:51], s77 offen offset:896
    buffer_load_dwordx4 v[84:87], v4, s[48:51], s77 offen offset:1792
    s_add_u32 s77, s77, 43008
    buffer_load_dwordx4 v[88:91], v4, s[48:51], s77 offen offset:0
    buffer_load_dwordx4 v[92:95], v4, s[48:51], s77 offen offset:896
    buffer_load_dwordx4 v[96:99], v4, s[48:51], s77 offen offset:1792
    s_add_u32 s77, s77, 43008
    s_mul_i32 s65, s60, 23296
    v_mov_b32 v5, s65
    v_bfe_u32 v1, v0, 2, 4
    v_mul_u32_u24 v1, 208, v1
    v_add_u32 v5, v5, v1
    v_bfe_u32 v1, v0, 0, 2
    v_lshl_add_u32 v5, v1, 4, v5
    s_waitcnt vmcnt(20)
    ds_write_b128 v5, v[16:19] offset:0
    s_waitcnt vmcnt(19)
    ds_write_b128 v5, v[20:23] offset:64
    s_waitcnt vmcnt(18)
    ds_write_b128 v5, v[24:27] offset:128
    s_waitcnt vmcnt(17)
    ds_write_b128 v5, v[28:31] offset:3328
    s_waitcnt vmcnt(16)
    ds_write_b128 v5, v[32:35] offset:3392
    s_waitcnt vmcnt(15)
    ds_write_b128 v5, v[36:39] offset:3456
    s_waitcnt lgkmcnt(6)
    s_waitcnt vmcnt(14)
    ds_write_b128 v5, v[40:43] offset:6656
    s_waitcnt vmcnt(13)
    ds_write_b128 v5, v[44:47] offset:6720
    s_waitcnt vmcnt(12)
    ds_write_b128 v5, v[48:51] offset:6784
    s_waitcnt vmcnt(11)
    ds_write_b128 v5, v[52:55] offset:9984
    s_waitcnt vmcnt(10)
    ds_write_b128 v5, v[56:59] offset:10048
    s_waitcnt vmcnt(9)
    ds_write_b128 v5, v[60:63] offset:10112
    s_waitcnt lgkmcnt(6)
    s_waitcnt vmcnt(8)
    ds_write_b128 v5, v[64:67] offset:13312
    s_waitcnt vmcnt(7)
    ds_write_b128 v5, v[68:71] offset:13376
    s_waitcnt vmcnt(6)
    ds_write_b128 v5, v[72:75] offset:13440
    s_waitcnt vmcnt(5)
    ds_write_b128 v5, v[76:79] offset:16640
    s_waitcnt vmcnt(4)
    ds_write_b128 v5, v[80:83] offset:16704
    s_waitcnt vmcnt(3)
    ds_write_b128 v5, v[84:87] offset:16768
    s_waitcnt lgkmcnt(6)
    s_waitcnt vmcnt(2)
    ds_write_b128 v5, v[88:91] offset:19968
    s_waitcnt vmcnt(1)
    ds_write_b128 v5, v[92:95] offset:20032
    s_waitcnt vmcnt(0)
    ds_write_b128 v5, v[96:99] offset:20096
    v_mov_b32 v6, 0
    v_bfe_u32 v1, v0, 4, 2
    v_mul_u32_u24 v1, 1664, v1
    v_add_u32 v6, v6, v1
    v_bfe_u32 v1, v0, 2, 2
    v_mul_u32_u24 v1, 208, v1
    v_add_u32 v6, v6, v1
    v_bfe_u32 v1, v0, 0, 2
    v_lshl_add_u32 v6, v1, 4, v6
    v_add_u32 v7, 46592, v6
    s_waitcnt lgkmcnt(0)
    s_barrier
    ds_read_b64_tr_b16 a[0:1], v6 offset:0
    ds_read_b64_tr_b16 a[2:3], v6 offset:832
    ds_read_b64_tr_b16 a[4:5], v6 offset:6656
    ds_read_b64_tr_b16 a[6:7], v6 offset:7488
    ds_read_b64_tr_b16 a[8:9], v6 offset:13312
    ds_read_b64_tr_b16 a[10:11], v6 offset:14144
    s_waitcnt lgkmcnt(6)
    ds_read_b64_tr_b16 a[12:13], v6 offset:19968
    ds_read_b64_tr_b16 a[14:15], v6 offset:20800
    ds_read_b64_tr_b16 a[16:17], v6 offset:26624
    ds_read_b64_tr_b16 a[18:19], v6 offset:27456
    ds_read_b64_tr_b16 a[20:21], v6 offset:33280
    ds_read_b64_tr_b16 a[22:23], v6 offset:34112
    s_waitcnt lgkmcnt(6)
    ds_read_b64_tr_b16 a[24:25], v6 offset:39936
    ds_read_b64_tr_b16 a[26:27], v6 offset:40768
    ds_read_b64_tr_b16 a[28:29], v7 offset:0
    ds_read_b64_tr_b16 a[30:31], v7 offset:832
    ds_read_b64_tr_b16 a[32:33], v7 offset:6656
    ds_read_b64_tr_b16 a[34:35], v7 offset:7488
    s_waitcnt lgkmcnt(6)
    ds_read_b64_tr_b16 a[36:37], v7 offset:13312
    ds_read_b64_tr_b16 a[38:39], v7 offset:14144
    ds_read_b64_tr_b16 a[40:41], v7 offset:19968
    ds_read_b64_tr_b16 a[42:43], v7 offset:20800
    ds_read_b64_tr_b16 a[44:45], v7 offset:26624
    ds_read_b64_tr_b16 a[46:47], v7 offset:27456
    s_waitcnt lgkmcnt(6)
    ds_read_b64_tr_b16 a[48:49], v7 offset:33280
    ds_read_b64_tr_b16 a[50:51], v7 offset:34112
    ds_read_b64_tr_b16 a[52:53], v7 offset:39936
    ds_read_b64_tr_b16 a[54:55], v7 offset:40768
    ds_read_b64_tr_b16 a[56:57], v6 offset:8
    ds_read_b64_tr_b16 a[58:59], v6 offset:840
    s_waitcnt lgkmcnt(6)
    ds_read_b64_tr_b16 a[60:61], v6 offset:6664
    ds_read_b64_tr_b16 a[62:63], v6 offset:7496
    ds_read_b64_tr_b16 a[64:65], v6 offset:13320
    ds_read_b64_tr_b16 a[66:67], v6 offset:14152
    ds_read_b64_tr_b16 a[68:69], v6 offset:19976
    ds_read_b64_tr_b16 a[70:71], v6 offset:20808
    s_waitcnt lgkmcnt(6)
    ds_read_b64_tr_b16 a[72:73], v6 offset:26632
    ds_read_b64_tr_b16 a[74:75], v6 offset:27464
    ds_read_b64_tr_b16 a[76:77], v6 offset:33288
    ds_read_b64_tr_b16 a[78:79], v6 offset:34120
    ds_read_b64_tr_b16 a[80:81], v6 offset:39944
    ds_read_b64_tr_b16 a[82:83], v6 offset:40776
    s_waitcnt lgkmcnt(6)
    ds_read_b64_tr_b16 a[84:85], v7 offset:8
    ds_read_b64_tr_b16 a[86:87], v7 offset:840
    ds_read_b64_tr_b16 a[88:89], v7 offset:6664
    ds_read_b64_tr_b16 a[90:91], v7 offset:7496
    ds_read_b64_tr_b16 a[92:93], v7 offset:13320
    ds_read_b64_tr_b16 a[94:95], v7 offset:14152
    s_waitcnt lgkmcnt(6)
    ds_read_b64_tr_b16 a[96:97], v7 offset:19976
    ds_read_b64_tr_b16 a[98:99], v7 offset:20808
    ds_read_b64_tr_b16 a[100:101], v7 offset:26632
    ds_read_b64_tr_b16 a[102:103], v7 offset:27464
    ds_read_b64_tr_b16 a[104:105], v7 offset:33288
    ds_read_b64_tr_b16 a[106:107], v7 offset:34120
    s_waitcnt lgkmcnt(6)
    ds_read_b64_tr_b16 a[108:109], v7 offset:39944
    ds_read_b64_tr_b16 a[110:111], v7 offset:40776
    ds_read_b64_tr_b16 a[112:113], v6 offset:64
    ds_read_b64_tr_b16 a[114:115], v6 offset:896
    ds_read_b64_tr_b16 a[116:117], v6 offset:6720
    ds_read_b64_tr_b16 a[118:119], v6 offset:7552
    s_waitcnt lgkmcnt(6)
    ds_read_b64_tr_b16 a[120:121], v6 offset:13376
    ds_read_b64_tr_b16 a[122:123], v6 offset:14208
    ds_read_b64_tr_b16 a[124:125], v6 offset:20032
    ds_read_b64_tr_b16 a[126:127], v6 offset:20864
    ds_read_b64_tr_b16 a[128:129], v6 offset:26688
    ds_read_b64_tr_b16 a[130:131], v6 offset:27520
    s_waitcnt lgkmcnt(6)
    ds_read_b64_tr_b16 a[132:133], v6 offset:33344
    ds_read_b64_tr_b16 a[134:135], v6 offset:34176
    ds_read_b64_tr_b16 a[136:137], v6 offset:40000
    ds_read_b64_tr_b16 a[138:139], v6 offset:40832
    ds_read_b64_tr_b16 a[140:141], v7 offset:64
    ds_read_b64_tr_b16 a[142:143], v7 offset:896
    s_waitcnt lgkmcnt(6)
    ds_read_b64_tr_b16 a[144:145], v7 offset:6720
    ds_read_b64_tr_b16 a[146:147], v7 offset:7552
    ds_read_b64_tr_b16 a[148:149], v7 offset:13376
    ds_read_b64_tr_b16 a[150:151], v7 offset:14208
    ds_read_b64_tr_b16 a[152:153], v7 offset:20032
    ds_read_b64_tr_b16 a[154:155], v7 offset:20864
    s_waitcnt lgkmcnt(6)
    ds_read_b64_tr_b16 a[156:157], v7 offset:26688
    ds_read_b64_tr_b16 a[158:159], v7 offset:27520
    ds_read_b64_tr_b16 a[160:161], v7 offset:33344
    ds_read_b64_tr_b16 a[162:163], v7 offset:34176
    ds_read_b64_tr_b16 a[164:165], v7 offset:40000
    ds_read_b64_tr_b16 a[166:167], v7 offset:40832
    s_waitcnt lgkmcnt(6)
    ds_read_b64_tr_b16 a[168:169], v6 offset:72
    ds_read_b64_tr_b16 a[170:171], v6 offset:904
    ds_read_b64_tr_b16 a[172:173], v6 offset:6728
    ds_read_b64_tr_b16 a[174:175], v6 offset:7560
    ds_read_b64_tr_b16 a[176:177], v6 offset:13384
    ds_read_b64_tr_b16 a[178:179], v6 offset:14216
    s_waitcnt lgkmcnt(6)
    ds_read_b64_tr_b16 a[180:181], v6 offset:20040
    ds_read_b64_tr_b16 a[182:183], v6 offset:20872
    ds_read_b64_tr_b16 a[184:185], v6 offset:26696
    ds_read_b64_tr_b16 a[186:187], v6 offset:27528
    ds_read_b64_tr_b16 a[188:189], v6 offset:33352
    ds_read_b64_tr_b16 a[190:191], v6 offset:34184
    s_waitcnt lgkmcnt(6)
    ds_read_b64_tr_b16 a[192:193], v6 offset:40008
    ds_read_b64_tr_b16 a[194:195], v6 offset:40840
    ds_read_b64_tr_b16 a[196:197], v7 offset:72
    ds_read_b64_tr_b16 a[198:199], v7 offset:904
    ds_read_b64_tr_b16 a[200:201], v7 offset:6728
    ds_read_b64_tr_b16 a[202:203], v7 offset:7560
    s_waitcnt lgkmcnt(6)
    ds_read_b64_tr_b16 a[204:205], v7 offset:13384
    ds_read_b64_tr_b16 a[206:207], v7 offset:14216
    ds_read_b64_tr_b16 a[208:209], v7 offset:20040
    ds_read_b64_tr_b16 a[210:211], v7 offset:20872
    ds_read_b64_tr_b16 a[212:213], v7 offset:26696
    ds_read_b64_tr_b16 a[214:215], v7 offset:27528
    s_waitcnt lgkmcnt(6)
    ds_read_b64_tr_b16 a[216:217], v7 offset:33352
    ds_read_b64_tr_b16 a[218:219], v7 offset:34184
    ds_read_b64_tr_b16 a[220:221], v7 offset:40008
    ds_read_b64_tr_b16 a[222:223], v7 offset:40840
    ds_read_b64_tr_b16 a[224:225], v6 offset:128
    ds_read_b64_tr_b16 a[226:227], v6 offset:960
    s_waitcnt lgkmcnt(6)
    ds_read_b64_tr_b16 a[228:229], v6 offset:6784
    ds_read_b64_tr_b16 a[230:231], v6 offset:7616
    ds_read_b64_tr_b16 a[232:233], v6 offset:13440
    ds_read_b64_tr_b16 a[234:235], v6 offset:14272
    ds_read_b64_tr_b16 a[236:237], v6 offset:20096
    ds_read_b64_tr_b16 a[238:239], v6 offset:20928
    s_waitcnt lgkmcnt(6)
    ds_read_b64_tr_b16 a[240:241], v6 offset:26752
    ds_read_b64_tr_b16 a[242:243], v6 offset:27584
    ds_read_b64_tr_b16 a[244:245], v6 offset:33408
    ds_read_b64_tr_b16 a[246:247], v6 offset:34240
    ds_read_b64_tr_b16 a[248:249], v6 offset:40064
    ds_read_b64_tr_b16 a[250:251], v6 offset:40896
    s_waitcnt lgkmcnt(6)
    ds_read_b64_tr_b16 a[252:253], v7 offset:128
    ds_read_b64_tr_b16 a[254:255], v7 offset:960
    ds_read_b64_tr_b16 v[176:177], v7 offset:6784
    ds_read_b64_tr_b16 v[178:179], v7 offset:7616
    ds_read_b64_tr_b16 v[180:181], v7 offset:13440
    ds_read_b64_tr_b16 v[182:183], v7 offset:14272
    s_waitcnt lgkmcnt(6)
    ds_read_b64_tr_b16 v[184:185], v7 offset:20096
    ds_read_b64_tr_b16 v[186:187], v7 offset:20928
    ds_read_b64_tr_b16 v[188:189], v7 offset:26752
    ds_read_b64_tr_b16 v[190:191], v7 offset:27584
    ds_read_b64_tr_b16 v[192:193], v7 offset:33408
    ds_read_b64_tr_b16 v[194:195], v7 offset:34240
    s_waitcnt lgkmcnt(6)
    ds_read_b64_tr_b16 v[196:197], v7 offset:40064
    ds_read_b64_tr_b16 v[198:199], v7 offset:40896
    ds_read_b64_tr_b16 v[200:201], v6 offset:136
    ds_read_b64_tr_b16 v[202:203], v6 offset:968
    ds_read_b64_tr_b16 v[204:205], v6 offset:6792
    ds_read_b64_tr_b16 v[206:207], v6 offset:7624
    s_waitcnt lgkmcnt(6)
    ds_read_b64_tr_b16 v[208:209], v6 offset:13448
    ds_read_b64_tr_b16 v[210:211], v6 offset:14280
    ds_read_b64_tr_b16 v[212:213], v6 offset:20104
    ds_read_b64_tr_b16 v[214:215], v6 offset:20936
    ds_read_b64_tr_b16 v[216:217], v6 offset:26760
    ds_read_b64_tr_b16 v[218:219], v6 offset:27592
    s_waitcnt lgkmcnt(6)
    ds_read_b64_tr_b16 v[220:221], v6 offset:33416
    ds_read_b64_tr_b16 v[222:223], v6 offset:34248
    ds_read_b64_tr_b16 v[224:225], v6 offset:40072
    ds_read_b64_tr_b16 v[226:227], v6 offset:40904
    ds_read_b64_tr_b16 v[228:229], v7 offset:136
    ds_read_b64_tr_b16 v[230:231], v7 offset:968
    s_waitcnt lgkmcnt(6)
    ds_read_b64_tr_b16 v[232:233], v7 offset:6792
    ds_read_b64_tr_b16 v[234:235], v7 offset:7624
    ds_read_b64_tr_b16 v[236:237], v7 offset:13448
    ds_read_b64_tr_b16 v[238:239], v7 offset:14280
    ds_read_b64_tr_b16 v[240:241], v7 offset:20104
    ds_read_b64_tr_b16 v[242:243], v7 offset:20936
    s_waitcnt lgkmcnt(6)
    ds_read_b64_tr_b16 v[244:245], v7 offset:26760
    ds_read_b64_tr_b16 v[246:247], v7 offset:27592
    ds_read_b64_tr_b16 v[248:249], v7 offset:33416
    ds_read_b64_tr_b16 v[250:251], v7 offset:34248
    ds_read_b64_tr_b16 v[252:253], v7 offset:40072
    ds_read_b64_tr_b16 v[254:255], v7 offset:40904
    s_waitcnt lgkmcnt(6)
    v_lshrrev_b32 v1, 4, v0
    v_xor_b32 v1, v1, v0
    v_and_b32 v1, 3, v1
    v_lshrrev_b32 v2, 2, v0
    v_mul_u32_u24 v2, 896, v2
    v_lshl_add_u32 v8, v1, 4, v2
    v_lshrrev_b32 v1, 4, v0
    v_bfe_u32 v2, v0, 2, 2
    v_xor_b32 v1, v1, v2
    v_and_b32 v2, 15, v0
    v_lshlrev_b32 v2, 6, v2
    v_lshl_add_u32 v11, v1, 4, v2
    s_mul_i32 s83, s60, 14336
    v_add_u32 v11, s83, v11
    v_add_u32 v9, 14336, v8
    v_mov_b32 v64, 0
    v_mov_b32 v65, 0
    v_mov_b32 v66, 0
    v_mov_b32 v67, 0
    v_mov_b32 v68, 0
    v_mov_b32 v69, 0
    v_mov_b32 v70, 0
    v_mov_b32 v71, 0
    v_mov_b32 v72, 0
    v_mov_b32 v73, 0
    v_mov_b32 v74, 0
    v_mov_b32 v75, 0
    v_mov_b32 v76, 0
    v_mov_b32 v77, 0
    v_mov_b32 v78, 0
    v_mov_b32 v79, 0
    s_mov_b32 s76, 0x3fb8aa3b
    s_mov_b32 s79, 0x358637bd
    v_and_b32 v1, 15, v0
    v_cmp_le_u32 s[96:97], 12, v1
    v_cmp_eq_u32 s[98:99], 12, v1
    v_cmp_le_u32 s[100:101], 48, v0
    s_lshl_b32 s80, s73, 2
    s_add_u32 s80, s80, s60
    s_waitcnt lgkmcnt(0)
    s_mov_b32 s81, 0
    s_barrier
    s_mul_i32 s77, s80, 28672
    s_add_u32 m0, s83, 1024
    s_nop 0
    buffer_load_dwordx4 v8, s[44:47], s77 offen offset:0 lds
    s_add_u32 m0, s83, 2048
    s_nop 0
    buffer_load_dwordx4 v9, s[44:47], s77 offen offset:0 lds
    s_add_u32 m0, s83, 3008
    s_nop 0
    buffer_load_dwordx4 v8, s[44:47], s77 offen offset:64 lds
    s_add_u32 m0, s83, 4032
    s_nop 0
    buffer_load_dwordx4 v9, s[44:47], s77 offen offset:64 lds
    s_add_u32 m0, s83, 4992
    s_nop 0
    buffer_load_dwordx4 v8, s[44:47], s77 offen offset:128 lds
    s_add_u32 m0, s83, 6016
    s_nop 0
    buffer_load_dwordx4 v9, s[44:47], s77 offen offset:128 lds
    s_add_u32 m0, s83, 6976
    s_nop 0
    buffer_load_dwordx4 v8, s[44:47], s77 offen offset:192 lds
    s_add_u32 m0, s83, 8000
    s_nop 0
    buffer_load_dwordx4 v9, s[44:47], s77 offen offset:192 lds
    s_add_u32 m0, s83, 8960
    s_nop 0
    buffer_load_dwordx4 v8, s[44:47], s77 offen offset:256 lds
    s_add_u32 m0, s83, 9984
    s_nop 0
    buffer_load_dwordx4 v9, s[44:47], s77 offen offset:256 lds
    s_add_u32 m0, s83, 10944
    s_nop 0
    buffer_load_dwordx4 v8, s[44:47], s77 offen offset:320 lds
    s_add_u32 m0, s83, 11968
    s_nop 0
    buffer_load_dwordx4 v9, s[44:47], s77 offen offset:320 lds
    s_add_u32 m0, s83, 12928
    s_nop 0
    buffer_load_dwordx4 v8, s[44:47], s77 offen offset:384 lds
    s_add_u32 m0, s83, 13952
    s_nop 0
    buffer_load_dwordx4 v9, s[44:47], s77 offen offset:384 lds
L_a1loop:
    s_waitcnt vmcnt(0)
    ds_read_b128 v[120:123], v11 offset:1024
    ds_read_b128 v[124:127], v11 offset:2048
    ds_read_b128 v[128:131], v11 offset:3072
    ds_read_b128 v[132:135], v11 offset:4096
    ds_read_b128 v[136:139], v11 offset:5120
    ds_read_b128 v[140:143], v11 offset:6144
    ds_read_b128 v[144:147], v11 offset:7168
    ds_read_b128 v[148:151], v11 offset:8192
    ds_read_b128 v[152:155], v11 offset:9216
    ds_read_b128 v[156:159], v11 offset:10240
    ds_read_b128 v[160:163], v11 offset:11264
    ds_read_b128 v[164:167], v11 offset:12288
    ds_read_b128 v[168:171], v11 offset:13312
    ds_read_b128 v[172:175], v11 offset:14336
    s_waitcnt lgkmcnt(0)
    s_add_u32 m0, s83, 576
    s_nop 0
    buffer_load_dwordx4 v8, s[44:47], s77 offen offset:448 lds
    s_add_u32 m0, s83, 1600
    s_nop 0
    buffer_load_dwordx4 v9, s[44:47], s77 offen offset:448 lds
    s_add_u32 m0, s83, 2560
    s_nop 0
    buffer_load_dwordx4 v8, s[44:47], s77 offen offset:512 lds
    s_add_u32 m0, s83, 3584
    s_nop 0
    buffer_load_dwordx4 v9, s[44:47], s77 offen offset:512 lds
    s_add_u32 m0, s83, 4544
    s_nop 0
    buffer_load_dwordx4 v8, s[44:47], s77 offen offset:576 lds
    s_add_u32 m0, s83, 5568
    s_nop 0
    buffer_load_dwordx4 v9, s[44:47], s77 offen offset:576 lds
    s_add_u32 m0, s83, 6528
    s_nop 0
    buffer_load_dwordx4 v8, s[44:47], s77 offen offset:640 lds
    s_add_u32 m0, s83, 7552
    s_nop 0
    buffer_load_dwordx4 v9, s[44:47], s77 offen offset:640 lds
    s_add_u32 m0, s83, 8512
    s_nop 0
    buffer_load_dwordx4 v8, s[44:47], s77 offen offset:704 lds
    s_add_u32 m0, s83, 9536
    s_nop 0
    buffer_load_dwordx4 v9, s[44:47], s77 offen offset:704 lds
    s_add_u32 m0, s83, 10496
    s_nop 0
    buffer_load_dwordx4 v8, s[44:47], s77 offen offset:768 lds
    s_add_u32 m0, s83, 11520
    s_nop 0
    buffer_load_dwordx4 v9, s[44:47], s77 offen offset:768 lds
    s_add_u32 m0, s83, 12480
    s_nop 0
    buffer_load_dwordx4 v8, s[44:47], s77 offen offset:832 lds
    s_add_u32 m0, s83, 13504
    s_nop 0
    buffer_load_dwordx4 v9, s[44:47], s77 offen offset:832 lds
    v_mfma_f32_16x16x32_bf16 v[16:19], v[120:123], a[112:115], 0
    v_mfma_f32_16x16x32_bf16 v[32:35], v[120:123], a[224:227], 0
    v_mfma_f32_16x16x32_bf16 v[48:51], a[0:3], v[120:123], 0
    v_mfma_f32_16x16x32_bf16 v[24:27], v[120:123], a[168:171], 0
    v_mfma_f32_16x16x32_bf16 v[40:43], v[120:123], v[200:203], 0
    v_mfma_f32_16x16x32_bf16 v[52:55], a[56:59], v[120:123], 0
    v_mfma_f32_16x16x32_bf16 v[20:23], v[124:127], a[112:115], 0
    v_mfma_f32_16x16x32_bf16 v[36:39], v[124:127], a[224:227], 0
    v_mfma_f32_16x16x32_bf16 v[56:59], a[0:3], v[124:127], 0
    v_mfma_f32_16x16x32_bf16 v[28:31], v[124:127], a[168:171], 0
    v_mfma_f32_16x16x32_bf16 v[44:47], v[124:127], v[200:203], 0
    v_mfma_f32_16x16x32_bf16 v[60:63], a[56:59], v[124:127], 0
    v_mfma_f32_16x16x32_bf16 v[16:19], v[128:131], a[116:119], v[16:19]
    v_mfma_f32_16x16x32_bf16 v[32:35], v[128:131], a[228:231], v[32:35]
    v_mfma_f32_16x16x32_bf16 v[48:51], a[4:7], v[128:131], v[48:51]
    v_mfma_f32_16x16x32_bf16 v[24:27], v[128:131], a[172:175], v[24:27]
    v_mfma_f32_16x16x32_bf16 v[40:43], v[128:131], v[204:207], v[40:43]
    v_mfma_f32_16x16x32_bf16 v[52:55], a[60:63], v[128:131], v[52:55]
    v_mfma_f32_16x16x32_bf16 v[20:23], v[132:135], a[116:119], v[20:23]
    v_mfma_f32_16x16x32_bf16 v[36:39], v[132:135], a[228:231], v[36:39]
    v_mfma_f32_16x16x32_bf16 v[56:59], a[4:7], v[132:135], v[56:59]
    v_mfma_f32_16x16x32_bf16 v[28:31], v[132:135], a[172:175], v[28:31]
    v_mfma_f32_16x16x32_bf16 v[44:47], v[132:135], v[204:207], v[44:47]
    v_mfma_f32_16x16x32_bf16 v[60:63], a[60:63], v[132:135], v[60:63]
    v_mfma_f32_16x16x32_bf16 v[16:19], v[136:139], a[120:123], v[16:19]
    v_mfma_f32_16x16x32_bf16 v[32:35], v[136:139], a[232:235], v[32:35]
    v_mfma_f32_16x16x32_bf16 v[48:51], a[8:11], v[136:139], v[48:51]
    v_mfma_f32_16x16x32_bf16 v[24:27], v[136:139], a[176:179], v[24:27]
    v_mfma_f32_16x16x32_bf16 v[40:43], v[136:139], v[208:211], v[40:43]
    v_mfma_f32_16x16x32_bf16 v[52:55], a[64:67], v[136:139], v[52:55]
    v_mfma_f32_16x16x32_bf16 v[20:23], v[140:143], a[120:123], v[20:23]
    v_mfma_f32_16x16x32_bf16 v[36:39], v[140:143], a[232:235], v[36:39]
    v_mfma_f32_16x16x32_bf16 v[56:59], a[8:11], v[140:143], v[56:59]
    v_mfma_f32_16x16x32_bf16 v[28:31], v[140:143], a[176:179], v[28:31]
    v_mfma_f32_16x16x32_bf16 v[44:47], v[140:143], v[208:211], v[44:47]
    v_mfma_f32_16x16x32_bf16 v[60:63], a[64:67], v[140:143], v[60:63]
    v_mfma_f32_16x16x32_bf16 v[16:19], v[144:147], a[124:127], v[16:19]
    v_mfma_f32_16x16x32_bf16 v[32:35], v[144:147], a[236:239], v[32:35]
    v_mfma_f32_16x16x32_bf16 v[48:51], a[12:15], v[144:147], v[48:51]
    v_mfma_f32_16x16x32_bf16 v[24:27], v[144:147], a[180:183], v[24:27]
    v_mfma_f32_16x16x32_bf16 v[40:43], v[144:147], v[212:215], v[40:43]
    v_mfma_f32_16x16x32_bf16 v[52:55], a[68:71], v[144:147], v[52:55]
    v_mfma_f32_16x16x32_bf16 v[20:23], v[148:151], a[124:127], v[20:23]
    v_mfma_f32_16x16x32_bf16 v[36:39], v[148:151], a[236:239], v[36:39]
    v_mfma_f32_16x16x32_bf16 v[56:59], a[12:15], v[148:151], v[56:59]
    v_mfma_f32_16x16x32_bf16 v[28:31], v[148:151], a[180:183], v[28:31]
    v_mfma_f32_16x16x32_bf16 v[44:47], v[148:151], v[212:215], v[44:47]
    v_mfma_f32_16x16x32_bf16 v[60:63], a[68:71], v[148:151], v[60:63]
    v_mfma_f32_16x16x32_bf16 v[16:19], v[152:155], a[128:131], v[16:19]
    v_mfma_f32_16x16x32_bf16 v[32:35], v[152:155], a[240:243], v[32:35]
    v_mfma_f32_16x16x32_bf16 v[48:51], a[16:19], v[152:155], v[48:51]
    v_mfma_f32_16x16x32_bf16 v[24:27], v[152:155], a[184:187], v[24:27]
    v_mfma_f32_16x16x32_bf16 v[40:43], v[152:155], v[216:219], v[40:43]
    v_mfma_f32_16x16x32_bf16 v[52:55], a[72:75], v[152:155], v[52:55]
    v_mfma_f32_16x16x32_bf16 v[20:23], v[156:159], a[128:131], v[20:23]
    v_mfma_f32_16x16x32_bf16 v[36:39], v[156:159], a[240:243], v[36:39]
    v_mfma_f32_16x16x32_bf16 v[56:59], a[16:19], v[156:159], v[56:59]
    v_mfma_f32_16x16x32_bf16 v[28:31], v[156:159], a[184:187], v[28:31]
    v_mfma_f32_16x16x32_bf16 v[44:47], v[156:159], v[216:219], v[44:47]
    v_mfma_f32_16x16x32_bf16 v[60:63], a[72:75], v[156:159], v[60:63]
    v_mfma_f32_16x16x32_bf16 v[16:19], v[160:163], a[132:135], v[16:19]
    v_mfma_f32_16x16x32_bf16 v[32:35], v[160:163], a[244:247], v[32:35]
    v_mfma_f32_16x16x32_bf16 v[48:51], a[20:23], v[160:163], v[48:51]
    v_mfma_f32_16x16x32_bf16 v[24:27], v[160:163], a[188:191], v[24:27]
    v_mfma_f32_16x16x32_bf16 v[40:43], v[160:163], v[220:223], v[40:43]
    v_mfma_f32_16x16x32_bf16 v[52:55], a[76:79], v[160:163], v[52:55]
    v_mfma_f32_16x16x32_bf16 v[20:23], v[164:167], a[132:135], v[20:23]
    v_mfma_f32_16x16x32_bf16 v[36:39], v[164:167], a[244:247], v[36:39]
    v_mfma_f32_16x16x32_bf16 v[56:59], a[20:23], v[164:167], v[56:59]
    v_mfma_f32_16x16x32_bf16 v[28:31], v[164:167], a[188:191], v[28:31]
    v_mfma_f32_16x16x32_bf16 v[44:47], v[164:167], v[220:223], v[44:47]
    v_mfma_f32_16x16x32_bf16 v[60:63], a[76:79], v[164:167], v[60:63]
    v_mfma_f32_16x16x32_bf16 v[16:19], v[168:171], a[136:139], v[16:19]
    v_mfma_f32_16x16x32_bf16 v[32:35], v[168:171], a[248:251], v[32:35]
    v_mfma_f32_16x16x32_bf16 v[48:51], a[24:27], v[168:171], v[48:51]
    v_mfma_f32_16x16x32_bf16 v[24:27], v[168:171], a[192:195], v[24:27]
    v_mfma_f32_16x16x32_bf16 v[40:43], v[168:171], v[224:227], v[40:43]
    v_mfma_f32_16x16x32_bf16 v[52:55], a[80:83], v[168:171], v[52:55]
    v_mfma_f32_16x16x32_bf16 v[20:23], v[172:175], a[136:139], v[20:23]
    v_mfma_f32_16x16x32_bf16 v[36:39], v[172:175], a[248:251], v[36:39]
    v_mfma_f32_16x16x32_bf16 v[56:59], a[24:27], v[172:175], v[56:59]
    v_mfma_f32_16x16x32_bf16 v[28:31], v[172:175], a[192:195], v[28:31]
    v_mfma_f32_16x16x32_bf16 v[44:47], v[172:175], v[224:227], v[44:47]
    v_mfma_f32_16x16x32_bf16 v[60:63], a[80:83], v[172:175], v[60:63]
    s_nop 7
    s_waitcnt vmcnt(0)
    ds_read_b128 v[120:123], v11 offset:1024
    ds_read_b128 v[124:127], v11 offset:2048
    ds_read_b128 v[128:131], v11 offset:3072
    ds_read_b128 v[132:135], v11 offset:4096
    ds_read_b128 v[136:139], v11 offset:5120
    ds_read_b128 v[140:143], v11 offset:6144
    ds_read_b128 v[144:147], v11 offset:7168
    ds_read_b128 v[148:151], v11 offset:8192
    ds_read_b128 v[152:155], v11 offset:9216
    ds_read_b128 v[156:159], v11 offset:10240
    ds_read_b128 v[160:163], v11 offset:11264
    ds_read_b128 v[164:167], v11 offset:12288
    ds_read_b128 v[168:171], v11 offset:13312
    ds_read_b128 v[172:175], v11 offset:14336
    s_waitcnt lgkmcnt(0)
    s_add_u32 s77, s77, 802816
    s_add_u32 m0, s83, 1024
    s_nop 0
    buffer_load_dwordx4 v8, s[44:47], s77 offen offset:0 lds
    s_add_u32 m0, s83, 2048
    s_nop 0
    buffer_load_dwordx4 v9, s[44:47], s77 offen offset:0 lds
    s_add_u32 m0, s83, 3008
    s_nop 0
    buffer_load_dwordx4 v8, s[44:47], s77 offen offset:64 lds
    s_add_u32 m0, s83, 4032
    s_nop 0
    buffer_load_dwordx4 v9, s[44:47], s77 offen offset:64 lds
    s_add_u32 m0, s83, 4992
    s_nop 0
    buffer_load_dwordx4 v8, s[44:47], s77 offen offset:128 lds
    s_add_u32 m0, s83, 6016
    s_nop 0
    buffer_load_dwordx4 v9, s[44:47], s77 offen offset:128 lds
    s_add_u32 m0, s83, 6976
    s_nop 0
    buffer_load_dwordx4 v8, s[44:47], s77 offen offset:192 lds
    s_add_u32 m0, s83, 8000
    s_nop 0
    buffer_load_dwordx4 v9, s[44:47], s77 offen offset:192 lds
    s_add_u32 m0, s83, 8960
    s_nop 0
    buffer_load_dwordx4 v8, s[44:47], s77 offen offset:256 lds
    s_add_u32 m0, s83, 9984
    s_nop 0
    buffer_load_dwordx4 v9, s[44:47], s77 offen offset:256 lds
    s_add_u32 m0, s83, 10944
    s_nop 0
    buffer_load_dwordx4 v8, s[44:47], s77 offen offset:320 lds
    s_add_u32 m0, s83, 11968
    s_nop 0
    buffer_load_dwordx4 v9, s[44:47], s77 offen offset:320 lds
    s_add_u32 m0, s83, 12928
    s_nop 0
    buffer_load_dwordx4 v8, s[44:47], s77 offen offset:384 lds
    s_add_u32 m0, s83, 13952
    s_nop 0
    buffer_load_dwordx4 v9, s[44:47], s77 offen offset:384 lds
    v_mfma_f32_16x16x32_bf16 v[16:19], v[120:123], a[140:143], v[16:19]
    v_mfma_f32_16x16x32_bf16 v[32:35], v[120:123], a[252:255], v[32:35]
    v_mfma_f32_16x16x32_bf16 v[48:51], a[28:31], v[120:123], v[48:51]
    v_mfma_f32_16x16x32_bf16 v[24:27], v[120:123], a[196:199], v[24:27]
    v_mfma_f32_16x16x32_bf16 v[40:43], v[120:123], v[228:231], v[40:43]
    v_mfma_f32_16x16x32_bf16 v[52:55], a[84:87], v[120:123], v[52:55]
    v_mfma_f32_16x16x32_bf16 v[20:23], v[124:127], a[140:143], v[20:23]
    v_mfma_f32_16x16x32_bf16 v[36:39], v[124:127], a[252:255], v[36:39]
    v_mfma_f32_16x16x32_bf16 v[56:59], a[28:31], v[124:127], v[56:59]
    v_mfma_f32_16x16x32_bf16 v[28:31], v[124:127], a[196:199], v[28:31]
    v_mfma_f32_16x16x32_bf16 v[44:47], v[124:127], v[228:231], v[44:47]
    v_mfma_f32_16x16x32_bf16 v[60:63], a[84:87], v[124:127], v[60:63]
    v_mfma_f32_16x16x32_bf16 v[16:19], v[128:131], a[144:147], v[16:19]
    v_mfma_f32_16x16x32_bf16 v[32:35], v[128:131], v[176:179], v[32:35]
    v_mfma_f32_16x16x32_bf16 v[48:51], a[32:35], v[128:131], v[48:51]
    v_mfma_f32_16x16x32_bf16 v[24:27], v[128:131], a[200:203], v[24:27]
    v_mfma_f32_16x16x32_bf16 v[40:43], v[128:131], v[232:235], v[40:43]
    v_mfma_f32_16x16x32_bf16 v[52:55], a[88:91], v[128:131], v[52:55]
    v_mfma_f32_16x16x32_bf16 v[20:23], v[132:135], a[144:147], v[20:23]
    v_mfma_f32_16x16x32_bf16 v[36:39], v[132:135], v[176:179], v[36:39]
    v_mfma_f32_16x16x32_bf16 v[56:59], a[32:35], v[132:135], v[56:59]
    v_mfma_f32_16x16x32_bf16 v[28:31], v[132:135], a[200:203], v[28:31]
    v_mfma_f32_16x16x32_bf16 v[44:47], v[132:135], v[232:235], v[44:47]
    v_mfma_f32_16x16x32_bf16 v[60:63], a[88:91], v[132:135], v[60:63]
    v_mfma_f32_16x16x32_bf16 v[16:19], v[136:139], a[148:151], v[16:19]
    v_mfma_f32_16x16x32_bf16 v[32:35], v[136:139], v[180:183], v[32:35]
    v_mfma_f32_16x16x32_bf16 v[48:51], a[36:39], v[136:139], v[48:51]
    v_mfma_f32_16x16x32_bf16 v[24:27], v[136:139], a[204:207], v[24:27]
    v_mfma_f32_16x16x32_bf16 v[40:43], v[136:139], v[236:239], v[40:43]
    v_mfma_f32_16x16x32_bf16 v[52:55], a[92:95], v[136:139], v[52:55]
    v_mfma_f32_16x16x32_bf16 v[20:23], v[140:143], a[148:151], v[20:23]
    v_mfma_f32_16x16x32_bf16 v[36:39], v[140:143], v[180:183], v[36:39]
    v_mfma_f32_16x16x32_bf16 v[56:59], a[36:39], v[140:143], v[56:59]
    v_mfma_f32_16x16x32_bf16 v[28:31], v[140:143], a[204:207], v[28:31]
    v_mfma_f32_16x16x32_bf16 v[44:47], v[140:143], v[236:239], v[44:47]
    v_mfma_f32_16x16x32_bf16 v[60:63], a[92:95], v[140:143], v[60:63]
    v_mfma_f32_16x16x32_bf16 v[16:19], v[144:147], a[152:155], v[16:19]
    v_mfma_f32_16x16x32_bf16 v[32:35], v[144:147], v[184:187], v[32:35]
    v_mfma_f32_16x16x32_bf16 v[48:51], a[40:43], v[144:147], v[48:51]
    v_mfma_f32_16x16x32_bf16 v[24:27], v[144:147], a[208:211], v[24:27]
    v_mfma_f32_16x16x32_bf16 v[40:43], v[144:147], v[240:243], v[40:43]
    v_mfma_f32_16x16x32_bf16 v[52:55], a[96:99], v[144:147], v[52:55]
    v_mfma_f32_16x16x32_bf16 v[20:23], v[148:151], a[152:155], v[20:23]
    v_mfma_f32_16x16x32_bf16 v[36:39], v[148:151], v[184:187], v[36:39]
    v_mfma_f32_16x16x32_bf16 v[56:59], a[40:43], v[148:151], v[56:59]
    v_mfma_f32_16x16x32_bf16 v[28:31], v[148:151], a[208:211], v[28:31]
    v_mfma_f32_16x16x32_bf16 v[44:47], v[148:151], v[240:243], v[44:47]
    v_mfma_f32_16x16x32_bf16 v[60:63], a[96:99], v[148:151], v[60:63]
    v_mfma_f32_16x16x32_bf16 v[16:19], v[152:155], a[156:159], v[16:19]
    v_mfma_f32_16x16x32_bf16 v[32:35], v[152:155], v[188:191], v[32:35]
    v_mfma_f32_16x16x32_bf16 v[48:51], a[44:47], v[152:155], v[48:51]
    v_mfma_f32_16x16x32_bf16 v[24:27], v[152:155], a[212:215], v[24:27]
    v_mfma_f32_16x16x32_bf16 v[40:43], v[152:155], v[244:247], v[40:43]
    v_mfma_f32_16x16x32_bf16 v[52:55], a[100:103], v[152:155], v[52:55]
    v_mfma_f32_16x16x32_bf16 v[20:23], v[156:159], a[156:159], v[20:23]
    v_mfma_f32_16x16x32_bf16 v[36:39], v[156:159], v[188:191], v[36:39]
    v_mfma_f32_16x16x32_bf16 v[56:59], a[44:47], v[156:159], v[56:59]
    v_mfma_f32_16x16x32_bf16 v[28:31], v[156:159], a[212:215], v[28:31]
    v_mfma_f32_16x16x32_bf16 v[44:47], v[156:159], v[244:247], v[44:47]
    v_mfma_f32_16x16x32_bf16 v[60:63], a[100:103], v[156:159], v[60:63]
    v_mfma_f32_16x16x32_bf16 v[16:19], v[160:163], a[160:163], v[16:19]
    v_mfma_f32_16x16x32_bf16 v[32:35], v[160:163], v[192:195], v[32:35]
    v_mfma_f32_16x16x32_bf16 v[48:51], a[48:51], v[160:163], v[48:51]
    v_mfma_f32_16x16x32_bf16 v[24:27], v[160:163], a[216:219], v[24:27]
    v_mfma_f32_16x16x32_bf16 v[40:43], v[160:163], v[248:251], v[40:43]
    v_mfma_f32_16x16x32_bf16 v[52:55], a[104:107], v[160:163], v[52:55]
    v_mfma_f32_16x16x32_bf16 v[20:23], v[164:167], a[160:163], v[20:23]
    v_mfma_f32_16x16x32_bf16 v[36:39], v[164:167], v[192:195], v[36:39]
    v_mfma_f32_16x16x32_bf16 v[56:59], a[48:51], v[164:167], v[56:59]
    v_mfma_f32_16x16x32_bf16 v[28:31], v[164:167], a[216:219], v[28:31]
    v_mfma_f32_16x16x32_bf16 v[44:47], v[164:167], v[248:251], v[44:47]
    v_mfma_f32_16x16x32_bf16 v[60:63], a[104:107], v[164:167], v[60:63]
    v_mfma_f32_16x16x32_bf16 v[16:19], v[168:171], a[164:167], v[16:19]
    v_mfma_f32_16x16x32_bf16 v[32:35], v[168:171], v[196:199], v[32:35]
    v_mfma_f32_16x16x32_bf16 v[48:51], a[52:55], v[168:171], v[48:51]
    v_mfma_f32_16x16x32_bf16 v[24:27], v[168:171], a[220:223], v[24:27]
    v_mfma_f32_16x16x32_bf16 v[40:43], v[168:171], v[252:255], v[40:43]
    v_mfma_f32_16x16x32_bf16 v[52:55], a[108:111], v[168:171], v[52:55]
    v_mfma_f32_16x16x32_bf16 v[20:23], v[172:175], a[164:167], v[20:23]
    v_mfma_f32_16x16x32_bf16 v[36:39], v[172:175], v[196:199], v[36:39]
    v_mfma_f32_16x16x32_bf16 v[56:59], a[52:55], v[172:175], v[56:59]
    v_mfma_f32_16x16x32_bf16 v[28:31], v[172:175], a[220:223], v[28:31]
    v_mfma_f32_16x16x32_bf16 v[44:47], v[172:175], v[252:255], v[44:47]
    v_mfma_f32_16x16x32_bf16 v[60:63], a[108:111], v[172:175], v[60:63]
    s_nop 7
    v_mul_f32 v104, s76, v16
    v_exp_f32 v104, v104
    v_cmp_lt_f32 vcc, 0, v16
    v_add_f32 v16, 1.0, v16
    s_nop 0
    v_cndmask_b32 v16, v104, v16, vcc
    v_add_f32 v16, s79, v16
    v_mul_f32 v104, s76, v17
    v_exp_f32 v104, v104
    v_cmp_lt_f32 vcc, 0, v17
    v_add_f32 v17, 1.0, v17
    s_nop 0
    v_cndmask_b32 v17, v104, v17, vcc
    v_add_f32 v17, s79, v17
    v_mul_f32 v104, s76, v18
    v_exp_f32 v104, v104
    v_cmp_lt_f32 vcc, 0, v18
    v_add_f32 v18, 1.0, v18
    s_nop 0
    v_cndmask_b32 v18, v104, v18, vcc
    v_add_f32 v18, s79, v18
    v_mul_f32 v104, s76, v19
    v_exp_f32 v104, v104
    v_cmp_lt_f32 vcc, 0, v19
    v_add_f32 v19, 1.0, v19
    s_nop 0
    v_cndmask_b32 v19, v104, v19, vcc
    v_add_f32 v19, s79, v19
    v_mul_f32 v104, s76, v20
    v_exp_f32 v104, v104
    v_cmp_lt_f32 vcc, 0, v20
    v_add_f32 v20, 1.0, v20
    s_nop 0
    v_cndmask_b32 v20, v104, v20, vcc
    v_add_f32 v20, s79, v20
    v_mul_f32 v104, s76, v21
    v_exp_f32 v104, v104
    v_cmp_lt_f32 vcc, 0, v21
    v_add_f32 v21, 1.0, v21
    s_nop 0
    v_cndmask_b32 v21, v104, v21, vcc
    v_add_f32 v21, s79, v21
    v_mul_f32 v104, s76, v22
    v_exp_f32 v104, v104
    v_cmp_lt_f32 vcc, 0, v22
    v_add_f32 v22, 1.0, v22
    s_nop 0
    v_cndmask_b32 v22, v104, v22, vcc
    v_add_f32 v22, s79, v22
    v_mul_f32 v104, s76, v23
    v_exp_f32 v104, v104
    v_cmp_lt_f32 vcc, 0, v23
    v_add_f32 v23, 1.0, v23
    s_nop 0
    v_cndmask_b32 v23, v104, v23, vcc
    v_add_f32 v23, s79, v23
    v_cvt_pk_bf16_f32 v16, v16, v17
    v_cvt_pk_bf16_f32 v17, v18, v19
    v_cvt_pk_bf16_f32 v18, v20, v21
    v_cvt_pk_bf16_f32 v19, v22, v23
    v_cvt_pk_bf16_f32 v32, v32, v33
    v_cvt_pk_bf16_f32 v33, v34, v35
    v_cvt_pk_bf16_f32 v34, v36, v37
    v_cvt_pk_bf16_f32 v35, v38, v39
    v_mul_f32 v104, s76, v24
    v_exp_f32 v104, v104
    v_cmp_lt_f32 vcc, 0, v24
    v_add_f32 v24, 1.0, v24
    s_nop 0
    v_cndmask_b32 v24, v104, v24, vcc
    v_add_f32 v24, s79, v24
    v_cndmask_b32 v24, v24, 0, s[96:97]
    v_mul_f32 v104, s76, v25
    v_exp_f32 v104, v104
    v_cmp_lt_f32 vcc, 0, v25
    v_add_f32 v25, 1.0, v25
    s_nop 0
    v_cndmask_b32 v25, v104, v25, vcc
    v_add_f32 v25, s79, v25
    v_cndmask_b32 v25, v25, 0, s[96:97]
    v_mul_f32 v104, s76, v26
    v_exp_f32 v104, v104
    v_cmp_lt_f32 vcc, 0, v26
    v_add_f32 v26, 1.0, v26
    s_nop 0
    v_cndmask_b32 v26, v104, v26, vcc
    v_add_f32 v26, s79, v26
    v_cndmask_b32 v26, v26, 0, s[96:97]
    v_mul_f32 v104, s76, v27
    v_exp_f32 v104, v104
    v_cmp_lt_f32 vcc, 0, v27
    v_add_f32 v27, 1.0, v27
    s_nop 0
    v_cndmask_b32 v27, v104, v27, vcc
    v_add_f32 v27, s79, v27
    v_cndmask_b32 v27, v27, 0, s[96:97]
    v_mul_f32 v104, s76, v28
    v_exp_f32 v104, v104
    v_cmp_lt_f32 vcc, 0, v28
    v_add_f32 v28, 1.0, v28
    s_nop 0
    v_cndmask_b32 v28, v104, v28, vcc
    v_add_f32 v28, s79, v28
    v_cndmask_b32 v28, v28, 0, s[96:97]
    v_mul_f32 v104, s76, v29
    v_exp_f32 v104, v104
    v_cmp_lt_f32 vcc, 0, v29
    v_add_f32 v29, 1.0, v29
    s_nop 0
    v_cndmask_b32 v29, v104, v29, vcc
    v_add_f32 v29, s79, v29
    v_cndmask_b32 v29, v29, 0, s[96:97]
    v_mul_f32 v104, s76, v30
    v_exp_f32 v104, v104
    v_cmp_lt_f32 vcc, 0, v30
    v_add_f32 v30, 1.0, v30
    s_nop 0
    v_cndmask_b32 v30, v104, v30, vcc
    v_add_f32 v30, s79, v30
    v_cndmask_b32 v30, v30, 0, s[96:97]
    v_mul_f32 v104, s76, v31
    v_exp_f32 v104, v104
    v_cmp_lt_f32 vcc, 0, v31
    v_add_f32 v31, 1.0, v31
    s_nop 0
    v_cndmask_b32 v31, v104, v31, vcc
    v_add_f32 v31, s79, v31
    v_cndmask_b32 v31, v31, 0, s[96:97]
    v_cvt_pk_bf16_f32 v24, v24, v25
    v_cvt_pk_bf16_f32 v25, v26, v27
    v_cvt_pk_bf16_f32 v26, v28, v29
    v_cvt_pk_bf16_f32 v27, v30, v31
    v_cndmask_b32 v40, v40, 0, s[96:97]
    v_cndmask_b32 v40, v40, 1.0, s[98:99]
    v_cndmask_b32 v41, v41, 0, s[96:97]
    v_cndmask_b32 v41, v41, 1.0, s[98:99]
    v_cndmask_b32 v42, v42, 0, s[96:97]
    v_cndmask_b32 v42, v42, 1.0, s[98:99]
    v_cndmask_b32 v43, v43, 0, s[96:97]
    v_cndmask_b32 v43, v43, 1.0, s[98:99]
    v_cndmask_b32 v44, v44, 0, s[96:97]
    v_cndmask_b32 v44, v44, 1.0, s[98:99]
    v_cndmask_b32 v45, v45, 0, s[96:97]
    v_cndmask_b32 v45, v45, 1.0, s[98:99]
    v_cndmask_b32 v46, v46, 0, s[96:97]
    v_cndmask_b32 v46, v46, 1.0, s[98:99]
    v_cndmask_b32 v47, v47, 0, s[96:97]
    v_cndmask_b32 v47, v47, 1.0, s[98:99]
    v_cvt_pk_bf16_f32 v40, v40, v41
    v_cvt_pk_bf16_f32 v41, v42, v43
    v_cvt_pk_bf16_f32 v42, v44, v45
    v_cvt_pk_bf16_f32 v43, v46, v47
    v_mfma_f32_16x16x32_bf16 v[64:67], v[16:19], v[32:35], v[64:67]
    s_nop 0
    v_mfma_f32_16x16x32_bf16 v[68:71], v[16:19], v[40:43], v[68:71]
    v_mfma_f32_16x16x32_bf16 v[72:75], v[24:27], v[32:35], v[72:75]
    v_mfma_f32_16x16x32_bf16 v[76:79], v[24:27], v[40:43], v[76:79]
    v_mov_b32 v103, v95
    v_mov_b32 v102, v94
    v_mov_b32 v101, v93
    v_mov_b32 v100, v92
    v_mov_b32 v99, v91
    v_mov_b32 v98, v90
    v_mov_b32 v97, v89
    v_mov_b32 v96, v88
    v_mov_b32 v95, v87
    v_mov_b32 v94, v86
    v_mov_b32 v93, v85
    v_mov_b32 v92, v84
    v_mov_b32 v91, v83
    v_mov_b32 v90, v82
    v_mov_b32 v89, v81
    v_mov_b32 v88, v80
    v_mul_f32 v104, s76, v48
    v_exp_f32 v104, v104
    v_cmp_lt_f32 vcc, 0, v48
    v_add_f32 v48, 1.0, v48
    s_nop 0
    v_cndmask_b32 v48, v104, v48, vcc
    v_add_f32 v48, s79, v48
    v_mul_f32 v104, s76, v49
    v_exp_f32 v104, v104
    v_cmp_lt_f32 vcc, 0, v49
    v_add_f32 v49, 1.0, v49
    s_nop 0
    v_cndmask_b32 v49, v104, v49, vcc
    v_add_f32 v49, s79, v49
    v_mul_f32 v104, s76, v50
    v_exp_f32 v104, v104
    v_cmp_lt_f32 vcc, 0, v50
    v_add_f32 v50, 1.0, v50
    s_nop 0
    v_cndmask_b32 v50, v104, v50, vcc
    v_add_f32 v50, s79, v50
    v_mul_f32 v104, s76, v51
    v_exp_f32 v104, v104
    v_cmp_lt_f32 vcc, 0, v51
    v_add_f32 v51, 1.0, v51
    s_nop 0
    v_cndmask_b32 v51, v104, v51, vcc
    v_add_f32 v51, s79, v51
    v_mul_f32 v104, s76, v52
    v_exp_f32 v104, v104
    v_cmp_lt_f32 vcc, 0, v52
    v_add_f32 v52, 1.0, v52
    s_nop 0
    v_cndmask_b32 v52, v104, v52, vcc
    v_add_f32 v52, s79, v52
    v_cndmask_b32 v52, v52, 0, s[100:101]
    v_mul_f32 v104, s76, v53
    v_exp_f32 v104, v104
    v_cmp_lt_f32 vcc, 0, v53
    v_add_f32 v53, 1.0, v53
    s_nop 0
    v_cndmask_b32 v53, v104, v53, vcc
    v_add_f32 v53, s79, v53
    v_cndmask_b32 v53, v53, 0, s[100:101]
    v_mul_f32 v104, s76, v54
    v_exp_f32 v104, v104
    v_cmp_lt_f32 vcc, 0, v54
    v_add_f32 v54, 1.0, v54
    s_nop 0
    v_cndmask_b32 v54, v104, v54, vcc
    v_add_f32 v54, s79, v54
    v_cndmask_b32 v54, v54, 0, s[100:101]
    v_mul_f32 v104, s76, v55
    v_exp_f32 v104, v104
    v_cmp_lt_f32 vcc, 0, v55
    v_add_f32 v55, 1.0, v55
    s_nop 0
    v_cndmask_b32 v55, v104, v55, vcc
    v_add_f32 v55, s79, v55
    v_cndmask_b32 v55, v55, 0, s[100:101]
    v_cvt_pk_bf16_f32 v80, v48, v49
    v_cvt_pk_bf16_f32 v81, v50, v51
    v_cvt_pk_bf16_f32 v82, v52, v53
    v_cvt_pk_bf16_f32 v83, v54, v55
    v_mul_f32 v104, s76, v56
    v_exp_f32 v104, v104
    v_cmp_lt_f32 vcc, 0, v56
    v_add_f32 v56, 1.0, v56
    s_nop 0
    v_cndmask_b32 v56, v104, v56, vcc
    v_add_f32 v56, s79, v56
    v_mul_f32 v104, s76, v57
    v_exp_f32 v104, v104
    v_cmp_lt_f32 vcc, 0, v57
    v_add_f32 v57, 1.0, v57
    s_nop 0
    v_cndmask_b32 v57, v104, v57, vcc
    v_add_f32 v57, s79, v57
    v_mul_f32 v104, s76, v58
    v_exp_f32 v104, v104
    v_cmp_lt_f32 vcc, 0, v58
    v_add_f32 v58, 1.0, v58
    s_nop 0
    v_cndmask_b32 v58, v104, v58, vcc
    v_add_f32 v58, s79, v58
    v_mul_f32 v104, s76, v59
    v_exp_f32 v104, v104
    v_cmp_lt_f32 vcc, 0, v59
    v_add_f32 v59, 1.0, v59
    s_nop 0
    v_cndmask_b32 v59, v104, v59, vcc
    v_add_f32 v59, s79, v59
    v_mul_f32 v104, s76, v60
    v_exp_f32 v104, v104
    v_cmp_lt_f32 vcc, 0, v60
    v_add_f32 v60, 1.0, v60
    s_nop 0
    v_cndmask_b32 v60, v104, v60, vcc
    v_add_f32 v60, s79, v60
    v_cndmask_b32 v60, v60, 0, s[100:101]
    v_mul_f32 v104, s76, v61
    v_exp_f32 v104, v104
    v_cmp_lt_f32 vcc, 0, v61
    v_add_f32 v61, 1.0, v61
    s_nop 0
    v_cndmask_b32 v61, v104, v61, vcc
    v_add_f32 v61, s79, v61
    v_cndmask_b32 v61, v61, 0, s[100:101]
    v_mul_f32 v104, s76, v62
    v_exp_f32 v104, v104
    v_cmp_lt_f32 vcc, 0, v62
    v_add_f32 v62, 1.0, v62
    s_nop 0
    v_cndmask_b32 v62, v104, v62, vcc
    v_add_f32 v62, s79, v62
    v_cndmask_b32 v62, v62, 0, s[100:101]
    v_mul_f32 v104, s76, v63
    v_exp_f32 v104, v104
    v_cmp_lt_f32 vcc, 0, v63
    v_add_f32 v63, 1.0, v63
    s_nop 0
    v_cndmask_b32 v63, v104, v63, vcc
    v_add_f32 v63, s79, v63
    v_cndmask_b32 v63, v63, 0, s[100:101]
    v_cvt_pk_bf16_f32 v84, v56, v57
    v_cvt_pk_bf16_f32 v85, v58, v59
    v_cvt_pk_bf16_f32 v86, v60, v61
    v_cvt_pk_bf16_f32 v87, v62, v63
    s_add_u32 s81, s81, 1
    s_add_u32 s80, s80, 28
    s_cmp_lt_u32 s80, 64
    s_cbranch_scc1 L_a1loop
    s_waitcnt vmcnt(0)
    s_barrier
    s_lshl_b32 s65, s60, 12
    s_add_u32 s65, s65, 65536
    v_mov_b32 v5, s65
    v_bfe_u32 v1, v0, 0, 6
    v_lshl_add_u32 v5, v1, 4, v5
    ds_write_b128 v5, v[64:67] offset:0
    ds_write_b128 v5, v[68:71] offset:1024
    ds_write_b128 v5, v[72:75] offset:2048
    ds_write_b128 v5, v[76:79] offset:3072
    s_lshl_b32 s65, s60, 10
    v_mov_b32 v6, s65
    v_bfe_u32 v1, v0, 0, 6
    v_lshl_add_u32 v6, v1, 4, v6
    v_add_u32 v7, 65536, v6
    s_waitcnt lgkmcnt(0)
    s_barrier
    ds_read_b128 v[16:19], v7 offset:0
    ds_read_b128 v[20:23], v7 offset:4096
    ds_read_b128 v[24:27], v7 offset:8192
    ds_read_b128 v[28:31], v7 offset:12288
    s_waitcnt lgkmcnt(0)
    v_add_f32 v16, v16, v20
    v_add_f32 v24, v24, v28
    v_add_f32 v16, v16, v24
    v_add_f32 v17, v17, v21
    v_add_f32 v25, v25, v29
    v_add_f32 v17, v17, v25
    v_add_f32 v18, v18, v22
    v_add_f32 v26, v26, v30
    v_add_f32 v18, v18, v26
    v_add_f32 v19, v19, v23
    v_add_f32 v27, v27, v31
    v_add_f32 v19, v19, v27
    s_lshl_b32 s65, s75, 12
    s_add_u32 s65, s65, 94371840
    buffer_store_dwordx4 v[16:19], v6, s[8:11], s65 offen sc1
    s_lshl_b32 s65, s75, 6
    s_lshl_b32 s66, s60, 2
    s_add_u32 s65, s65, s66
    s_add_u32 s65, s65, 88297472
    v_mov_b32 v1, s65
    v_mov_b32 v2, 2147483632
    v_cmp_eq_u32 vcc, 0, v0
    s_nop 1
    v_cndmask_b32 v10, v2, v1, vcc
    v_mov_b32 v3, 1
    s_waitcnt vmcnt(0)
    buffer_store_dword v3, v10, s[8:11], 0 offen sc1
    v_lshrrev_b32 v1, 2, v0
    v_min_u32 v1, 6, v1
    v_lshlrev_b32 v1, 6, v1
    v_and_b32 v2, 3, v0
    v_lshl_add_u32 v10, v2, 2, v1
    s_mul_i32 s65, s72, 448
    s_add_u32 s65, s65, 88297472
L_wf_314:
    buffer_load_dword v3, v10, s[8:11], s65 offen sc1
    s_waitcnt vmcnt(0)
    v_cmp_gt_u32 vcc, 1, v3
    s_cbranch_vccnz L_retry_315
    v_mov_b32 v4, 0
    v_bfe_u32 v1, v0, 0, 6
    v_lshl_add_u32 v4, v1, 4, v4
    v_mov_b32 v5, 192
    v_bfe_u32 v1, v0, 4, 2
    v_lshl_add_u32 v5, v1, 8, v5
    s_mul_i32 s77, s72, 28672
    s_add_u32 s77, s77, 94371840
    buffer_load_dwordx4 v[104:107], v4, s[8:11], s77 offen offset:0 sc1
    buffer_load_dwordx4 v[108:111], v4, s[8:11], s77 offen offset:1024 sc1
    buffer_load_dwordx4 v[112:115], v4, s[8:11], s77 offen offset:2048 sc1
    buffer_load_dwordx4 v[116:119], v4, s[8:11], s77 offen offset:3072 sc1
    buffer_load_dwordx4 v[120:123], v5, s[8:11], s77 offen offset:1024 sc1
    buffer_load_dwordx4 v[124:127], v5, s[8:11], s77 offen offset:3072 sc1
    s_add_u32 s77, s77, 4096
    buffer_load_dwordx4 v[128:131], v4, s[8:11], s77 offen offset:0 sc1
    buffer_load_dwordx4 v[132:135], v4, s[8:11], s77 offen offset:1024 sc1
    buffer_load_dwordx4 v[136:139], v4, s[8:11], s77 offen offset:2048 sc1
    buffer_load_dwordx4 v[140:143], v4, s[8:11], s77 offen offset:3072 sc1
    buffer_load_dwordx4 v[144:147], v5, s[8:11], s77 offen offset:1024 sc1
    buffer_load_dwordx4 v[148:151], v5, s[8:11], s77 offen offset:3072 sc1
    s_add_u32 s77, s77, 4096
    buffer_load_dwordx4 v[152:155], v4, s[8:11], s77 offen offset:0 sc1
    buffer_load_dwordx4 v[156:159], v4, s[8:11], s77 offen offset:1024 sc1
    buffer_load_dwordx4 v[160:163], v4, s[8:11], s77 offen offset:2048 sc1
    buffer_load_dwordx4 v[164:167], v4, s[8:11], s77 offen offset:3072 sc1
    buffer_load_dwordx4 v[168:171], v5, s[8:11], s77 offen offset:1024 sc1
    buffer_load_dwordx4 v[172:175], v5, s[8:11], s77 offen offset:3072 sc1
    s_add_u32 s77, s77, 4096
    buffer_load_dwordx4 v[176:179], v4, s[8:11], s77 offen offset:0 sc1
    buffer_load_dwordx4 v[180:183], v4, s[8:11], s77 offen offset:1024 sc1
    buffer_load_dwordx4 v[184:187], v4, s[8:11], s77 offen offset:2048 sc1
    buffer_load_dwordx4 v[188:191], v4, s[8:11], s77 offen offset:3072 sc1
    buffer_load_dwordx4 v[192:195], v5, s[8:11], s77 offen offset:1024 sc1
    buffer_load_dwordx4 v[196:199], v5, s[8:11], s77 offen offset:3072 sc1
    s_add_u32 s77, s77, 4096
    buffer_load_dwordx4 v[200:203], v4, s[8:11], s77 offen offset:0 sc1
    buffer_load_dwordx4 v[204:207], v4, s[8:11], s77 offen offset:1024 sc1
    buffer_load_dwordx4 v[208:211], v4, s[8:11], s77 offen offset:2048 sc1
    buffer_load_dwordx4 v[212:215], v4, s[8:11], s77 offen offset:3072 sc1
    buffer_load_dwordx4 v[216:219], v5, s[8:11], s77 offen offset:1024 sc1
    buffer_load_dwordx4 v[220:223], v5, s[8:11], s77 offen offset:3072 sc1
    s_add_u32 s77, s77, 4096
    buffer_load_dwordx4 v[224:227], v4, s[8:11], s77 offen offset:0 sc1
    buffer_load_dwordx4 v[228:231], v4, s[8:11], s77 offen offset:1024 sc1
    buffer_load_dwordx4 v[232:235], v4, s[8:11], s77 offen offset:2048 sc1
    buffer_load_dwordx4 v[236:239], v4, s[8:11], s77 offen offset:3072 sc1
    buffer_load_dwordx4 v[240:243], v5, s[8:11], s77 offen offset:1024 sc1
    buffer_load_dwordx4 v[244:247], v5, s[8:11], s77 offen offset:3072 sc1
    s_add_u32 s77, s77, 4096
    buffer_load_dwordx4 v[16:19], v4, s[8:11], s77 offen offset:0 sc1
    buffer_load_dwordx4 v[20:23], v4, s[8:11], s77 offen offset:1024 sc1
    buffer_load_dwordx4 v[24:27], v4, s[8:11], s77 offen offset:2048 sc1
    buffer_load_dwordx4 v[28:31], v4, s[8:11], s77 offen offset:3072 sc1
    buffer_load_dwordx4 v[32:35], v5, s[8:11], s77 offen offset:1024 sc1
    buffer_load_dwordx4 v[36:39], v5, s[8:11], s77 offen offset:3072 sc1
    s_add_u32 s77, s77, 4096
    s_waitcnt vmcnt(0)
    v_add_f32 v16, v16, v104
    v_add_f32 v17, v17, v105
    v_add_f32 v18, v18, v106
    v_add_f32 v19, v19, v107
    v_add_f32 v20, v20, v108
    v_add_f32 v21, v21, v109
    v_add_f32 v22, v22, v110
    v_add_f32 v23, v23, v111
    v_add_f32 v24, v24, v112
    v_add_f32 v25, v25, v113
    v_add_f32 v26, v26, v114
    v_add_f32 v27, v27, v115
    v_add_f32 v28, v28, v116
    v_add_f32 v29, v29, v117
    v_add_f32 v30, v30, v118
    v_add_f32 v31, v31, v119
    v_add_f32 v32, v32, v120
    v_add_f32 v33, v33, v121
    v_add_f32 v34, v34, v122
    v_add_f32 v35, v35, v123
    v_add_f32 v36, v36, v124
    v_add_f32 v37, v37, v125
    v_add_f32 v38, v38, v126
    v_add_f32 v39, v39, v127
    v_add_f32 v16, v16, v128
    v_add_f32 v17, v17, v129
    v_add_f32 v18, v18, v130
    v_add_f32 v19, v19, v131
    v_add_f32 v20, v20, v132
    v_add_f32 v21, v21, v133
    v_add_f32 v22, v22, v134
    v_add_f32 v23, v23, v135
    v_add_f32 v24, v24, v136
    v_add_f32 v25, v25, v137
    v_add_f32 v26, v26, v138
    v_add_f32 v27, v27, v139
    v_add_f32 v28, v28, v140
    v_add_f32 v29, v29, v141
    v_add_f32 v30, v30, v142
    v_add_f32 v31, v31, v143
    v_add_f32 v32, v32, v144
    v_add_f32 v33, v33, v145
    v_add_f32 v34, v34, v146
    v_add_f32 v35, v35, v147
    v_add_f32 v36, v36, v148
    v_add_f32 v37, v37, v149
    v_add_f32 v38, v38, v150
    v_add_f32 v39, v39, v151
    v_add_f32 v16, v16, v152
    v_add_f32 v17, v17, v153
    v_add_f32 v18, v18, v154
    v_add_f32 v19, v19, v155
    v_add_f32 v20, v20, v156
    v_add_f32 v21, v21, v157
    v_add_f32 v22, v22, v158
    v_add_f32 v23, v23, v159
    v_add_f32 v24, v24, v160
    v_add_f32 v25, v25, v161
    v_add_f32 v26, v26, v162
    v_add_f32 v27, v27, v163
    v_add_f32 v28, v28, v164
    v_add_f32 v29, v29, v165
    v_add_f32 v30, v30, v166
    v_add_f32 v31, v31, v167
    v_add_f32 v32, v32, v168
    v_add_f32 v33, v33, v169
    v_add_f32 v34, v34, v170
    v_add_f32 v35, v35, v171
    v_add_f32 v36, v36, v172
    v_add_f32 v37, v37, v173
    v_add_f32 v38, v38, v174
    v_add_f32 v39, v39, v175
    v_add_f32 v16, v16, v176
    v_add_f32 v17, v17, v177
    v_add_f32 v18, v18, v178
    v_add_f32 v19, v19, v179
    v_add_f32 v20, v20, v180
    v_add_f32 v21, v21, v181
    v_add_f32 v22, v22, v182
    v_add_f32 v23, v23, v183
    v_add_f32 v24, v24, v184
    v_add_f32 v25, v25, v185
    v_add_f32 v26, v26, v186
    v_add_f32 v27, v27, v187
    v_add_f32 v28, v28, v188
    v_add_f32 v29, v29, v189
    v_add_f32 v30, v30, v190
    v_add_f32 v31, v31, v191
    v_add_f32 v32, v32, v192
    v_add_f32 v33, v33, v193
    v_add_f32 v34, v34, v194
    v_add_f32 v35, v35, v195
    v_add_f32 v36, v36, v196
    v_add_f32 v37, v37, v197
    v_add_f32 v38, v38, v198
    v_add_f32 v39, v39, v199
    v_add_f32 v16, v16, v200
    v_add_f32 v17, v17, v201
    v_add_f32 v18, v18, v202
    v_add_f32 v19, v19, v203
    v_add_f32 v20, v20, v204
    v_add_f32 v21, v21, v205
    v_add_f32 v22, v22, v206
    v_add_f32 v23, v23, v207
    v_add_f32 v24, v24, v208
    v_add_f32 v25, v25, v209
    v_add_f32 v26, v26, v210
    v_add_f32 v27, v27, v211
    v_add_f32 v28, v28, v212
    v_add_f32 v29, v29, v213
    v_add_f32 v30, v30, v214
    v_add_f32 v31, v31, v215
    v_add_f32 v32, v32, v216
    v_add_f32 v33, v33, v217
    v_add_f32 v34, v34, v218
    v_add_f32 v35, v35, v219
    v_add_f32 v36, v36, v220
    v_add_f32 v37, v37, v221
    v_add_f32 v38, v38, v222
    v_add_f32 v39, v39, v223
    v_add_f32 v16, v16, v224
    v_add_f32 v17, v17, v225
    v_add_f32 v18, v18, v226
    v_add_f32 v19, v19, v227
    v_add_f32 v20, v20, v228
    v_add_f32 v21, v21, v229
    v_add_f32 v22, v22, v230
    v_add_f32 v23, v23, v231
    v_add_f32 v24, v24, v232
    v_add_f32 v25, v25, v233
    v_add_f32 v26, v26, v234
    v_add_f32 v27, v27, v235
    v_add_f32 v28, v28, v236
    v_add_f32 v29, v29, v237
    v_add_f32 v30, v30, v238
    v_add_f32 v31, v31, v239
    v_add_f32 v32, v32, v240
    v_add_f32 v33, v33, v241
    v_add_f32 v34, v34, v242
    v_add_f32 v35, v35, v243
    v_add_f32 v36, v36, v244
    v_add_f32 v37, v37, v245
    v_add_f32 v38, v38, v246
    v_add_f32 v39, v39, v247
    v_cvt_pk_bf16_f32 v64, v16, v17
    v_cvt_pk_bf16_f32 v65, v18, v19
    v_cvt_pk_bf16_f32 v66, v24, v25
    v_cvt_pk_bf16_f32 v67, v26, v27
    v_cvt_pk_bf16_f32 v68, v20, v21
    v_cvt_pk_bf16_f32 v69, v22, v23
    v_cvt_pk_bf16_f32 v70, v28, v29
    v_cvt_pk_bf16_f32 v71, v30, v31
    v_cvt_pk_bf16_f32 v72, v32, v33
    v_cvt_pk_bf16_f32 v73, v34, v35
    v_cvt_pk_bf16_f32 v74, v36, v37
    v_cvt_pk_bf16_f32 v75, v38, v39
    s_lshl_b32 s65, s72, 10
    v_mov_b32 v6, s65
    v_bfe_u32 v1, v0, 0, 6
    v_lshl_add_u32 v6, v1, 4, v6
L_a1o:
    s_sub_u32 s80, s80, 28
    s_lshl_b32 s77, s80, 15
    s_add_u32 s77, s77, 95420416
    s_add_u32 s78, s77, 16384
    v_mfma_f32_16x16x32_bf16 v[16:19], v[64:67], v[80:83], 0
    v_mfma_f32_16x16x32_bf16 v[20:23], v[68:71], v[80:83], 0
    v_mfma_f32_16x16x32_bf16 v[24:27], v[72:75], v[80:83], 0
    v_mfma_f32_16x16x32_bf16 v[28:31], v[64:67], v[84:87], 0
    v_mfma_f32_16x16x32_bf16 v[32:35], v[68:71], v[84:87], 0
    v_mfma_f32_16x16x32_bf16 v[36:39], v[72:75], v[84:87], 0
    v_add_f32 v24, s79, v24
    v_rcp_f32 v24, v24
    s_nop 0
    v_mul_f32 v16, v16, v24
    v_mul_f32 v17, v17, v24
    v_mul_f32 v18, v18, v24
    v_mul_f32 v19, v19, v24
    v_mul_f32 v20, v20, v24
    v_cndmask_b32 v20, v20, 0, s[100:101]
    v_mul_f32 v21, v21, v24
    v_cndmask_b32 v21, v21, 0, s[100:101]
    v_mul_f32 v22, v22, v24
    v_cndmask_b32 v22, v22, 0, s[100:101]
    v_mul_f32 v23, v23, v24
    v_cndmask_b32 v23, v23, 0, s[100:101]
    v_cvt_pk_bf16_f32 v40, v16, v17
    v_cvt_pk_bf16_f32 v41, v18, v19
    v_cvt_pk_bf16_f32 v42, v20, v21
    v_cvt_pk_bf16_f32 v43, v22, v23
    buffer_store_dwordx4 v[40:43], v6, s[8:11], s77 offen sc1
    v_add_f32 v36, s79, v36
    v_rcp_f32 v36, v36
    s_nop 0
    v_mul_f32 v28, v28, v36
    v_mul_f32 v29, v29, v36
    v_mul_f32 v30, v30, v36
    v_mul_f32 v31, v31, v36
    v_mul_f32 v32, v32, v36
    v_cndmask_b32 v32, v32, 0, s[100:101]
    v_mul_f32 v33, v33, v36
    v_cndmask_b32 v33, v33, 0, s[100:101]
    v_mul_f32 v34, v34, v36
    v_cndmask_b32 v34, v34, 0, s[100:101]
    v_mul_f32 v35, v35, v36
    v_cndmask_b32 v35, v35, 0, s[100:101]
    v_cvt_pk_bf16_f32 v44, v28, v29
    v_cvt_pk_bf16_f32 v45, v30, v31
    v_cvt_pk_bf16_f32 v46, v32, v33
    v_cvt_pk_bf16_f32 v47, v34, v35
    buffer_store_dwordx4 v[44:47], v6, s[8:11], s78 offen sc1
    v_mov_b32 v80, v88
    v_mov_b32 v81, v89
    v_mov_b32 v82, v90
    v_mov_b32 v83, v91
    v_mov_b32 v84, v92
    v_mov_b32 v85, v93
    v_mov_b32 v86, v94
    v_mov_b32 v87, v95
    v_mov_b32 v88, v96
    v_mov_b32 v89, v97
    v_mov_b32 v90, v98
    v_mov_b32 v91, v99
    v_mov_b32 v92, v100
    v_mov_b32 v93, v101
    v_mov_b32 v94, v102
    v_mov_b32 v95, v103
    s_sub_u32 s81, s81, 1
    s_cmp_lg_u32 s81, 0
    s_cbranch_scc1 L_a1o
    s_lshl_b32 s65, s75, 2
    s_add_u32 s65, s65, s60
    s_lshl_b32 s65, s65, 2
    s_add_u32 s65, s65, 88305664
    v_mov_b32 v1, s65
    v_mov_b32 v2, 2147483632
    v_cmp_eq_u32 vcc, 0, v0
    s_nop 1
    v_cndmask_b32 v10, v2, v1, vcc
    v_mov_b32 v3, 1
    s_waitcnt vmcnt(0)
    buffer_store_dword v3, v10, s[8:11], 0 offen sc1
    s_barrier
    v_mov_b32 v4, 0
    v_bfe_u32 v1, v0, 3, 3
    v_mul_u32_u24 v1, 896, v1
    v_add_u32 v4, v4, v1
    v_bfe_u32 v1, v0, 0, 3
    v_lshl_add_u32 v4, v1, 4, v4
    s_mul_i32 s77, s60, 100352
    s_lshl_b32 s65, s73, 7
    s_add_u32 s77, s77, s65
    buffer_load_dwordx4 v[64:67], v4, s[52:55], s77 offen
    s_add_u32 s77, s77, 7168
    buffer_load_dwordx4 v[68:71], v4, s[52:55], s77 offen
    s_add_u32 s77, s77, 7168
    buffer_load_dwordx4 v[72:75], v4, s[52:55], s77 offen
    s_add_u32 s77, s77, 7168
    buffer_load_dwordx4 v[76:79], v4, s[52:55], s77 offen
    s_add_u32 s77, s77, 7168
    buffer_load_dwordx4 v[80:83], v4, s[52:55], s77 offen
    s_add_u32 s77, s77, 7168
    buffer_load_dwordx4 v[84:87], v4, s[52:55], s77 offen
    s_add_u32 s77, s77, 7168
    buffer_load_dwordx4 v[88:91], v4, s[52:55], s77 offen
    s_add_u32 s77, s77, 7168
    buffer_load_dwordx4 v[92:95], v4, s[52:55], s77 offen
    s_add_u32 s77, s77, 7168
    buffer_load_dwordx4 v[96:99], v4, s[52:55], s77 offen
    s_add_u32 s77, s77, 7168
    buffer_load_dwordx4 v[100:103], v4, s[52:55], s77 offen
    s_add_u32 s77, s77, 7168
    buffer_load_dwordx4 v[104:107], v4, s[52:55], s77 offen
    s_add_u32 s77, s77, 7168
    buffer_load_dwordx4 v[108:111], v4, s[52:55], s77 offen
    s_add_u32 s77, s77, 7168
    buffer_load_dwordx4 v[112:115], v4, s[52:55], s77 offen
    s_add_u32 s77, s77, 7168
    buffer_load_dwordx4 v[116:119], v4, s[52:55], s77 offen
    s_add_u32 s77, s77, 7168
    buffer_load_dwordx4 v[120:123], v4, s[52:55], s77 offen
    s_add_u32 s77, s77, 7168
    s_mul_i32 s65, s60, 16128
    v_mov_b32 v5, s65
    v_bfe_u32 v1, v0, 3, 3
    v_mul_u32_u24 v1, 144, v1
    v_add_u32 v5, v5, v1
    v_bfe_u32 v1, v0, 0, 3
    v_lshl_add_u32 v5, v1, 4, v5
    s_waitcnt vmcnt(14)
    ds_write_b128 v5, v[64:67] offset:0
    s_waitcnt vmcnt(13)
    ds_write_b128 v5, v[68:71] offset:1152
    s_waitcnt vmcnt(12)
    ds_write_b128 v5, v[72:75] offset:2304
    s_waitcnt vmcnt(11)
    ds_write_b128 v5, v[76:79] offset:3456
    s_waitcnt vmcnt(10)
    ds_write_b128 v5, v[80:83] offset:4608
    s_waitcnt vmcnt(9)
    ds_write_b128 v5, v[84:87] offset:5760
    s_waitcnt lgkmcnt(6)
    s_waitcnt vmcnt(8)
    ds_write_b128 v5, v[88:91] offset:6912
    s_waitcnt vmcnt(7)
    ds_write_b128 v5, v[92:95] offset:8064
    s_waitcnt vmcnt(6)
    ds_write_b128 v5, v[96:99] offset:9216
    s_waitcnt vmcnt(5)
    ds_write_b128 v5, v[100:103] offset:10368
    s_waitcnt vmcnt(4)
    ds_write_b128 v5, v[104:107] offset:11520
    s_waitcnt vmcnt(3)
    ds_write_b128 v5, v[108:111] offset:12672
    s_waitcnt lgkmcnt(6)
    s_waitcnt vmcnt(2)
    ds_write_b128 v5, v[112:115] offset:13824
    s_waitcnt vmcnt(1)
    ds_write_b128 v5, v[116:119] offset:14976
    s_waitcnt vmcnt(0)
    ds_write_b128 v5, v[120:123] offset:16128
    v_mov_b32 v6, 0
    v_bfe_u32 v1, v0, 4, 2
    v_mul_u32_u24 v1, 1152, v1
    v_add_u32 v6, v6, v1
    v_bfe_u32 v1, v0, 2, 2
    v_mul_u32_u24 v1, 144, v1
    v_add_u32 v6, v6, v1
    v_bfe_u32 v1, v0, 0, 2
    v_lshl_add_u32 v6, v1, 4, v6
    s_waitcnt lgkmcnt(0)
    s_barrier
    ds_read_b64_tr_b16 a[0:1], v6 offset:0
    ds_read_b64_tr_b16 a[2:3], v6 offset:576
    ds_read_b64_tr_b16 a[4:5], v6 offset:4032
    ds_read_b64_tr_b16 a[6:7], v6 offset:4608
    ds_read_b64_tr_b16 a[8:9], v6 offset:8064
    ds_read_b64_tr_b16 a[10:11], v6 offset:8640
    s_waitcnt lgkmcnt(6)
    ds_read_b64_tr_b16 a[12:13], v6 offset:12096
    ds_read_b64_tr_b16 a[14:15], v6 offset:12672
    ds_read_b64_tr_b16 a[16:17], v6 offset:16128
    ds_read_b64_tr_b16 a[18:19], v6 offset:16704
    ds_read_b64_tr_b16 a[20:21], v6 offset:20160
    ds_read_b64_tr_b16 a[22:23], v6 offset:20736
    s_waitcnt lgkmcnt(6)
    ds_read_b64_tr_b16 a[24:25], v6 offset:24192
    ds_read_b64_tr_b16 a[26:27], v6 offset:24768
    ds_read_b64_tr_b16 a[28:29], v6 offset:28224
    ds_read_b64_tr_b16 a[30:31], v6 offset:28800
    ds_read_b64_tr_b16 a[32:33], v6 offset:32256
    ds_read_b64_tr_b16 a[34:35], v6 offset:32832
    s_waitcnt lgkmcnt(6)
    ds_read_b64_tr_b16 a[36:37], v6 offset:36288
    ds_read_b64_tr_b16 a[38:39], v6 offset:36864
    ds_read_b64_tr_b16 a[40:41], v6 offset:40320
    ds_read_b64_tr_b16 a[42:43], v6 offset:40896
    ds_read_b64_tr_b16 a[44:45], v6 offset:44352
    ds_read_b64_tr_b16 a[46:47], v6 offset:44928
    s_waitcnt lgkmcnt(6)
    ds_read_b64_tr_b16 a[48:49], v6 offset:48384
    ds_read_b64_tr_b16 a[50:51], v6 offset:48960
    ds_read_b64_tr_b16 a[52:53], v6 offset:52416
    ds_read_b64_tr_b16 a[54:55], v6 offset:52992
    ds_read_b64_tr_b16 a[56:57], v6 offset:56448
    ds_read_b64_tr_b16 a[58:59], v6 offset:57024
    s_waitcnt lgkmcnt(6)
    ds_read_b64_tr_b16 a[60:61], v6 offset:60480
    ds_read_b64_tr_b16 a[62:63], v6 offset:61056
    ds_read_b64_tr_b16 a[64:65], v6 offset:8
    ds_read_b64_tr_b16 a[66:67], v6 offset:584
    ds_read_b64_tr_b16 a[68:69], v6 offset:4040
    ds_read_b64_tr_b16 a[70:71], v6 offset:4616
    s_waitcnt lgkmcnt(6)
    ds_read_b64_tr_b16 a[72:73], v6 offset:8072
    ds_read_b64_tr_b16 a[74:75], v6 offset:8648
    ds_read_b64_tr_b16 a[76:77], v6 offset:12104
    ds_read_b64_tr_b16 a[78:79], v6 offset:12680
    ds_read_b64_tr_b16 a[80:81], v6 offset:16136
    ds_read_b64_tr_b16 a[82:83], v6 offset:16712
    s_waitcnt lgkmcnt(6)
    ds_read_b64_tr_b16 a[84:85], v6 offset:20168
    ds_read_b64_tr_b16 a[86:87], v6 offset:20744
    ds_read_b64_tr_b16 a[88:89], v6 offset:24200
    ds_read_b64_tr_b16 a[90:91], v6 offset:24776
    ds_read_b64_tr_b16 a[92:93], v6 offset:28232
    ds_read_b64_tr_b16 a[94:95], v6 offset:28808
    s_waitcnt lgkmcnt(6)
    ds_read_b64_tr_b16 a[96:97], v6 offset:32264
    ds_read_b64_tr_b16 a[98:99], v6 offset:32840
    ds_read_b64_tr_b16 a[100:101], v6 offset:36296
    ds_read_b64_tr_b16 a[102:103], v6 offset:36872
    ds_read_b64_tr_b16 a[104:105], v6 offset:40328
    ds_read_b64_tr_b16 a[106:107], v6 offset:40904
    s_waitcnt lgkmcnt(6)
    ds_read_b64_tr_b16 a[108:109], v6 offset:44360
    ds_read_b64_tr_b16 a[110:111], v6 offset:44936
    ds_read_b64_tr_b16 a[112:113], v6 offset:48392
    ds_read_b64_tr_b16 a[114:115], v6 offset:48968
    ds_read_b64_tr_b16 a[116:117], v6 offset:52424
    ds_read_b64_tr_b16 a[118:119], v6 offset:53000
    s_waitcnt lgkmcnt(6)
    ds_read_b64_tr_b16 a[120:121], v6 offset:56456
    ds_read_b64_tr_b16 a[122:123], v6 offset:57032
    ds_read_b64_tr_b16 a[124:125], v6 offset:60488
    ds_read_b64_tr_b16 a[126:127], v6 offset:61064
    ds_read_b64_tr_b16 a[128:129], v6 offset:64
    ds_read_b64_tr_b16 a[130:131], v6 offset:640
    s_waitcnt lgkmcnt(6)
    ds_read_b64_tr_b16 a[132:133], v6 offset:4096
    ds_read_b64_tr_b16 a[134:135], v6 offset:4672
    ds_read_b64_tr_b16 a[136:137], v6 offset:8128
    ds_read_b64_tr_b16 a[138:139], v6 offset:8704
    ds_read_b64_tr_b16 a[140:141], v6 offset:12160
    ds_read_b64_tr_b16 a[142:143], v6 offset:12736
    s_waitcnt lgkmcnt(6)
    ds_read_b64_tr_b16 a[144:145], v6 offset:16192
    ds_read_b64_tr_b16 a[146:147], v6 offset:16768
    ds_read_b64_tr_b16 a[148:149], v6 offset:20224
    ds_read_b64_tr_b16 a[150:151], v6 offset:20800
    ds_read_b64_tr_b16 a[152:153], v6 offset:24256
    ds_read_b64_tr_b16 a[154:155], v6 offset:24832
    s_waitcnt lgkmcnt(6)
    ds_read_b64_tr_b16 a[156:157], v6 offset:28288
    ds_read_b64_tr_b16 a[158:159], v6 offset:28864
    ds_read_b64_tr_b16 a[160:161], v6 offset:32320
    ds_read_b64_tr_b16 a[162:163], v6 offset:32896
    ds_read_b64_tr_b16 a[164:165], v6 offset:36352
    ds_read_b64_tr_b16 a[166:167], v6 offset:36928
    s_waitcnt lgkmcnt(6)
    ds_read_b64_tr_b16 a[168:169], v6 offset:40384
    ds_read_b64_tr_b16 a[170:171], v6 offset:40960
    ds_read_b64_tr_b16 a[172:173], v6 offset:44416
    ds_read_b64_tr_b16 a[174:175], v6 offset:44992
    ds_read_b64_tr_b16 a[176:177], v6 offset:48448
    ds_read_b64_tr_b16 a[178:179], v6 offset:49024
    s_waitcnt lgkmcnt(6)
    ds_read_b64_tr_b16 a[180:181], v6 offset:52480
    ds_read_b64_tr_b16 a[182:183], v6 offset:53056
    ds_read_b64_tr_b16 a[184:185], v6 offset:56512
    ds_read_b64_tr_b16 a[186:187], v6 offset:57088
    ds_read_b64_tr_b16 a[188:189], v6 offset:60544
    ds_read_b64_tr_b16 a[190:191], v6 offset:61120
    s_waitcnt lgkmcnt(6)
    ds_read_b64_tr_b16 a[192:193], v6 offset:72
    ds_read_b64_tr_b16 a[194:195], v6 offset:648
    ds_read_b64_tr_b16 a[196:197], v6 offset:4104
    ds_read_b64_tr_b16 a[198:199], v6 offset:4680
    ds_read_b64_tr_b16 a[200:201], v6 offset:8136
    ds_read_b64_tr_b16 a[202:203], v6 offset:8712
    s_waitcnt lgkmcnt(6)
    ds_read_b64_tr_b16 a[204:205], v6 offset:12168
    ds_read_b64_tr_b16 a[206:207], v6 offset:12744
    ds_read_b64_tr_b16 a[208:209], v6 offset:16200
    ds_read_b64_tr_b16 a[210:211], v6 offset:16776
    ds_read_b64_tr_b16 a[212:213], v6 offset:20232
    ds_read_b64_tr_b16 a[214:215], v6 offset:20808
    s_waitcnt lgkmcnt(6)
    ds_read_b64_tr_b16 a[216:217], v6 offset:24264
    ds_read_b64_tr_b16 a[218:219], v6 offset:24840
    ds_read_b64_tr_b16 a[220:221], v6 offset:28296
    ds_read_b64_tr_b16 a[222:223], v6 offset:28872
    ds_read_b64_tr_b16 a[224:225], v6 offset:32328
    ds_read_b64_tr_b16 a[226:227], v6 offset:32904
    s_waitcnt lgkmcnt(6)
    ds_read_b64_tr_b16 a[228:229], v6 offset:36360
    ds_read_b64_tr_b16 a[230:231], v6 offset:36936
    ds_read_b64_tr_b16 a[232:233], v6 offset:40392
    ds_read_b64_tr_b16 a[234:235], v6 offset:40968
    ds_read_b64_tr_b16 a[236:237], v6 offset:44424
    ds_read_b64_tr_b16 a[238:239], v6 offset:45000
    s_waitcnt lgkmcnt(6)
    ds_read_b64_tr_b16 a[240:241], v6 offset:48456
    ds_read_b64_tr_b16 a[242:243], v6 offset:49032
    ds_read_b64_tr_b16 a[244:245], v6 offset:52488
    ds_read_b64_tr_b16 a[246:247], v6 offset:53064
    ds_read_b64_tr_b16 a[248:249], v6 offset:56520
    ds_read_b64_tr_b16 a[250:251], v6 offset:57096
    s_waitcnt lgkmcnt(6)
    ds_read_b64_tr_b16 a[252:253], v6 offset:60552
    ds_read_b64_tr_b16 a[254:255], v6 offset:61128
    s_lshl_b32 s80, s72, 2
    s_add_u32 s80, s80, s60
    s_mov_b32 s65, s80
    s_sub_u32 s66, s65, 28
    s_cmp_ge_u32 s65, 28
    s_cselect_b32 s65, s66, s65
    s_sub_u32 s66, s65, 28
    s_cmp_ge_u32 s65, 28
    s_cselect_b32 s65, s66, s65
    s_lshl_b32 s65, s65, 2
    s_add_u32 s65, s65, 88305664
    v_mov_b32 v10, 0
    v_bfe_u32 v1, v0, 0, 4
    v_mul_u32_u24 v1, 112, v1
    v_add_u32 v10, v10, v1
L_wf_316:
    buffer_load_dword v3, v10, s[8:11], s65 offen sc1
    s_waitcnt vmcnt(0)
    v_cmp_gt_u32 vcc, 1, v3
    s_cbranch_vccnz L_retry_317
    v_mov_b32 v4, 0
    v_bfe_u32 v1, v0, 0, 6
    v_lshl_add_u32 v4, v1, 4, v4
    s_lshl_b32 s77, s80, 15
    s_add_u32 s77, s77, 95420416
    buffer_load_dwordx4 v[64:67], v4, s[8:11], s77 offen offset:0 sc1
    buffer_load_dwordx4 v[68:71], v4, s[8:11], s77 offen offset:1024 sc1
    buffer_load_dwordx4 v[72:75], v4, s[8:11], s77 offen offset:2048 sc1
    buffer_load_dwordx4 v[76:79], v4, s[8:11], s77 offen offset:3072 sc1
    s_add_u32 s77, s77, 4096
    buffer_load_dwordx4 v[80:83], v4, s[8:11], s77 offen offset:0 sc1
    buffer_load_dwordx4 v[84:87], v4, s[8:11], s77 offen offset:1024 sc1
    buffer_load_dwordx4 v[88:91], v4, s[8:11], s77 offen offset:2048 sc1
    buffer_load_dwordx4 v[92:95], v4, s[8:11], s77 offen offset:3072 sc1
    s_add_u32 s77, s77, 4096
    buffer_load_dwordx4 v[96:99], v4, s[8:11], s77 offen offset:0 sc1
    buffer_load_dwordx4 v[100:103], v4, s[8:11], s77 offen offset:1024 sc1
    buffer_load_dwordx4 v[104:107], v4, s[8:11], s77 offen offset:2048 sc1
    buffer_load_dwordx4 v[108:111], v4, s[8:11], s77 offen offset:3072 sc1
    s_add_u32 s77, s77, 4096
    buffer_load_dwordx4 v[112:115], v4, s[8:11], s77 offen offset:0 sc1
    buffer_load_dwordx4 v[116:119], v4, s[8:11], s77 offen offset:1024 sc1
    buffer_load_dwordx4 v[120:123], v4, s[8:11], s77 offen offset:2048 sc1
    buffer_load_dwordx4 v[124:127], v4, s[8:11], s77 offen offset:3072 sc1
    s_add_u32 s77, s77, 4096
    buffer_load_dwordx4 v[128:131], v4, s[8:11], s77 offen offset:0 sc1
    buffer_load_dwordx4 v[132:135], v4, s[8:11], s77 offen offset:1024 sc1
    buffer_load_dwordx4 v[136:139], v4, s[8:11], s77 offen offset:2048 sc1
    buffer_load_dwordx4 v[140:143], v4, s[8:11], s77 offen offset:3072 sc1
    s_add_u32 s77, s77, 4096
    buffer_load_dwordx4 v[144:147], v4, s[8:11], s77 offen offset:0 sc1
    buffer_load_dwordx4 v[148:151], v4, s[8:11], s77 offen offset:1024 sc1
    buffer_load_dwordx4 v[152:155], v4, s[8:11], s77 offen offset:2048 sc1
    buffer_load_dwordx4 v[156:159], v4, s[8:11], s77 offen offset:3072 sc1
    s_add_u32 s77, s77, 4096
    buffer_load_dwordx4 v[160:163], v4, s[8:11], s77 offen offset:0 sc1
    buffer_load_dwordx4 v[164:167], v4, s[8:11], s77 offen offset:1024 sc1
    buffer_load_dwordx4 v[168:171], v4, s[8:11], s77 offen offset:2048 sc1
    buffer_load_dwordx4 v[172:175], v4, s[8:11], s77 offen offset:3072 sc1
    s_add_u32 s77, s77, 4096
    buffer_load_dwordx4 v[176:179], v4, s[8:11], s77 offen offset:0 sc1
    buffer_load_dwordx4 v[180:183], v4, s[8:11], s77 offen offset:1024 sc1
    buffer_load_dwordx4 v[184:187], v4, s[8:11], s77 offen offset:2048 sc1
    buffer_load_dwordx4 v[188:191], v4, s[8:11], s77 offen offset:3072 sc1
    s_add_u32 s77, s77, 4096
    s_lshl_b32 s65, s73, 7
    v_mov_b32 v8, s65
    v_bfe_u32 v1, v0, 0, 4
    v_mul_u32_u24 v1, 1792, v1
    v_add_u32 v8, v8, v1
    v_bfe_u32 v1, v0, 4, 2
    v_lshl_add_u32 v8, v1, 4, v8
    s_mul_i32 s77, s80, 57344
    s_add_u32 s78, s77, 28672
    s_waitcnt lgkmcnt(0)
    s_waitcnt vmcnt(31)
    v_mfma_f32_16x16x32_bf16 v[16:19], a[0:3], v[64:67], 0
    v_mfma_f32_16x16x32_bf16 v[20:23], a[64:67], v[64:67], 0
    v_mfma_f32_16x16x32_bf16 v[24:27], a[128:131], v[64:67], 0
    v_mfma_f32_16x16x32_bf16 v[28:31], a[192:195], v[64:67], 0
    s_waitcnt vmcnt(30)
    v_mfma_f32_16x16x32_bf16 v[16:19], a[4:7], v[68:71], v[16:19]
    v_mfma_f32_16x16x32_bf16 v[20:23], a[68:71], v[68:71], v[20:23]
    v_mfma_f32_16x16x32_bf16 v[24:27], a[132:135], v[68:71], v[24:27]
    v_mfma_f32_16x16x32_bf16 v[28:31], a[196:199], v[68:71], v[28:31]
    s_waitcnt vmcnt(29)
    v_mfma_f32_16x16x32_bf16 v[16:19], a[8:11], v[72:75], v[16:19]
    v_mfma_f32_16x16x32_bf16 v[20:23], a[72:75], v[72:75], v[20:23]
    v_mfma_f32_16x16x32_bf16 v[24:27], a[136:139], v[72:75], v[24:27]
    v_mfma_f32_16x16x32_bf16 v[28:31], a[200:203], v[72:75], v[28:31]
    s_waitcnt vmcnt(28)
    v_mfma_f32_16x16x32_bf16 v[16:19], a[12:15], v[76:79], v[16:19]
    v_mfma_f32_16x16x32_bf16 v[20:23], a[76:79], v[76:79], v[20:23]
    v_mfma_f32_16x16x32_bf16 v[24:27], a[140:143], v[76:79], v[24:27]
    v_mfma_f32_16x16x32_bf16 v[28:31], a[204:207], v[76:79], v[28:31]
    s_waitcnt vmcnt(27)
    v_mfma_f32_16x16x32_bf16 v[16:19], a[16:19], v[80:83], v[16:19]
    v_mfma_f32_16x16x32_bf16 v[20:23], a[80:83], v[80:83], v[20:23]
    v_mfma_f32_16x16x32_bf16 v[24:27], a[144:147], v[80:83], v[24:27]
    v_mfma_f32_16x16x32_bf16 v[28:31], a[208:211], v[80:83], v[28:31]
    s_waitcnt vmcnt(26)
    v_mfma_f32_16x16x32_bf16 v[16:19], a[20:23], v[84:87], v[16:19]
    v_mfma_f32_16x16x32_bf16 v[20:23], a[84:87], v[84:87], v[20:23]
    v_mfma_f32_16x16x32_bf16 v[24:27], a[148:151], v[84:87], v[24:27]
    v_mfma_f32_16x16x32_bf16 v[28:31], a[212:215], v[84:87], v[28:31]
    s_waitcnt vmcnt(25)
    v_mfma_f32_16x16x32_bf16 v[16:19], a[24:27], v[88:91], v[16:19]
    v_mfma_f32_16x16x32_bf16 v[20:23], a[88:91], v[88:91], v[20:23]
    v_mfma_f32_16x16x32_bf16 v[24:27], a[152:155], v[88:91], v[24:27]
    v_mfma_f32_16x16x32_bf16 v[28:31], a[216:219], v[88:91], v[28:31]
    s_waitcnt vmcnt(24)
    v_mfma_f32_16x16x32_bf16 v[16:19], a[28:31], v[92:95], v[16:19]
    v_mfma_f32_16x16x32_bf16 v[20:23], a[92:95], v[92:95], v[20:23]
    v_mfma_f32_16x16x32_bf16 v[24:27], a[156:159], v[92:95], v[24:27]
    v_mfma_f32_16x16x32_bf16 v[28:31], a[220:223], v[92:95], v[28:31]
    s_waitcnt vmcnt(23)
    v_mfma_f32_16x16x32_bf16 v[16:19], a[32:35], v[96:99], v[16:19]
    v_mfma_f32_16x16x32_bf16 v[20:23], a[96:99], v[96:99], v[20:23]
    v_mfma_f32_16x16x32_bf16 v[24:27], a[160:163], v[96:99], v[24:27]
    v_mfma_f32_16x16x32_bf16 v[28:31], a[224:227], v[96:99], v[28:31]
    s_waitcnt vmcnt(22)
    v_mfma_f32_16x16x32_bf16 v[16:19], a[36:39], v[100:103], v[16:19]
    v_mfma_f32_16x16x32_bf16 v[20:23], a[100:103], v[100:103], v[20:23]
    v_mfma_f32_16x16x32_bf16 v[24:27], a[164:167], v[100:103], v[24:27]
    v_mfma_f32_16x16x32_bf16 v[28:31], a[228:231], v[100:103], v[28:31]
    s_waitcnt vmcnt(21)
    v_mfma_f32_16x16x32_bf16 v[16:19], a[40:43], v[104:107], v[16:19]
    v_mfma_f32_16x16x32_bf16 v[20:23], a[104:107], v[104:107], v[20:23]
    v_mfma_f32_16x16x32_bf16 v[24:27], a[168:171], v[104:107], v[24:27]
    v_mfma_f32_16x16x32_bf16 v[28:31], a[232:235], v[104:107], v[28:31]
    s_waitcnt vmcnt(20)
    v_mfma_f32_16x16x32_bf16 v[16:19], a[44:47], v[108:111], v[16:19]
    v_mfma_f32_16x16x32_bf16 v[20:23], a[108:111], v[108:111], v[20:23]
    v_mfma_f32_16x16x32_bf16 v[24:27], a[172:175], v[108:111], v[24:27]
    v_mfma_f32_16x16x32_bf16 v[28:31], a[236:239], v[108:111], v[28:31]
    s_waitcnt vmcnt(19)
    v_mfma_f32_16x16x32_bf16 v[16:19], a[48:51], v[112:115], v[16:19]
    v_mfma_f32_16x16x32_bf16 v[20:23], a[112:115], v[112:115], v[20:23]
    v_mfma_f32_16x16x32_bf16 v[24:27], a[176:179], v[112:115], v[24:27]
    v_mfma_f32_16x16x32_bf16 v[28:31], a[240:243], v[112:115], v[28:31]
    s_waitcnt vmcnt(18)
    v_mfma_f32_16x16x32_bf16 v[16:19], a[52:55], v[116:119], v[16:19]
    v_mfma_f32_16x16x32_bf16 v[20:23], a[116:119], v[116:119], v[20:23]
    v_mfma_f32_16x16x32_bf16 v[24:27], a[180:183], v[116:119], v[24:27]
    v_mfma_f32_16x16x32_bf16 v[28:31], a[244:247], v[116:119], v[28:31]
    s_waitcnt vmcnt(17)
    v_mfma_f32_16x16x32_bf16 v[16:19], a[56:59], v[120:123], v[16:19]
    v_mfma_f32_16x16x32_bf16 v[20:23], a[120:123], v[120:123], v[20:23]
    v_mfma_f32_16x16x32_bf16 v[24:27], a[184:187], v[120:123], v[24:27]
    v_mfma_f32_16x16x32_bf16 v[28:31], a[248:251], v[120:123], v[28:31]
    s_waitcnt vmcnt(16)
    v_mfma_f32_16x16x32_bf16 v[16:19], a[60:63], v[124:127], v[16:19]
    v_mfma_f32_16x16x32_bf16 v[20:23], a[124:127], v[124:127], v[20:23]
    v_mfma_f32_16x16x32_bf16 v[24:27], a[188:191], v[124:127], v[24:27]
    v_mfma_f32_16x16x32_bf16 v[28:31], a[252:255], v[124:127], v[28:31]
    s_waitcnt vmcnt(15)
    v_mfma_f32_16x16x32_bf16 v[32:35], a[0:3], v[128:131], 0
    v_mfma_f32_16x16x32_bf16 v[36:39], a[64:67], v[128:131], 0
    v_mfma_f32_16x16x32_bf16 v[40:43], a[128:131], v[128:131], 0
    v_mfma_f32_16x16x32_bf16 v[44:47], a[192:195], v[128:131], 0
    s_waitcnt vmcnt(14)
    v_mfma_f32_16x16x32_bf16 v[32:35], a[4:7], v[132:135], v[32:35]
    v_mfma_f32_16x16x32_bf16 v[36:39], a[68:71], v[132:135], v[36:39]
    v_mfma_f32_16x16x32_bf16 v[40:43], a[132:135], v[132:135], v[40:43]
    v_mfma_f32_16x16x32_bf16 v[44:47], a[196:199], v[132:135], v[44:47]
    s_waitcnt vmcnt(13)
    v_mfma_f32_16x16x32_bf16 v[32:35], a[8:11], v[136:139], v[32:35]
    v_mfma_f32_16x16x32_bf16 v[36:39], a[72:75], v[136:139], v[36:39]
    v_mfma_f32_16x16x32_bf16 v[40:43], a[136:139], v[136:139], v[40:43]
    v_mfma_f32_16x16x32_bf16 v[44:47], a[200:203], v[136:139], v[44:47]
    s_waitcnt vmcnt(12)
    v_mfma_f32_16x16x32_bf16 v[32:35], a[12:15], v[140:143], v[32:35]
    v_mfma_f32_16x16x32_bf16 v[36:39], a[76:79], v[140:143], v[36:39]
    v_mfma_f32_16x16x32_bf16 v[40:43], a[140:143], v[140:143], v[40:43]
    v_mfma_f32_16x16x32_bf16 v[44:47], a[204:207], v[140:143], v[44:47]
    s_waitcnt vmcnt(11)
    v_mfma_f32_16x16x32_bf16 v[32:35], a[16:19], v[144:147], v[32:35]
    v_mfma_f32_16x16x32_bf16 v[36:39], a[80:83], v[144:147], v[36:39]
    v_mfma_f32_16x16x32_bf16 v[40:43], a[144:147], v[144:147], v[40:43]
    v_mfma_f32_16x16x32_bf16 v[44:47], a[208:211], v[144:147], v[44:47]
    s_waitcnt vmcnt(10)
    v_mfma_f32_16x16x32_bf16 v[32:35], a[20:23], v[148:151], v[32:35]
    v_mfma_f32_16x16x32_bf16 v[36:39], a[84:87], v[148:151], v[36:39]
    v_mfma_f32_16x16x32_bf16 v[40:43], a[148:151], v[148:151], v[40:43]
    v_mfma_f32_16x16x32_bf16 v[44:47], a[212:215], v[148:151], v[44:47]
    s_waitcnt vmcnt(9)
    v_mfma_f32_16x16x32_bf16 v[32:35], a[24:27], v[152:155], v[32:35]
    v_mfma_f32_16x16x32_bf16 v[36:39], a[88:91], v[152:155], v[36:39]
    v_mfma_f32_16x16x32_bf16 v[40:43], a[152:155], v[152:155], v[40:43]
    v_mfma_f32_16x16x32_bf16 v[44:47], a[216:219], v[152:155], v[44:47]
    s_waitcnt vmcnt(8)
    v_mfma_f32_16x16x32_bf16 v[32:35], a[28:31], v[156:159], v[32:35]
    v_mfma_f32_16x16x32_bf16 v[36:39], a[92:95], v[156:159], v[36:39]
    v_mfma_f32_16x16x32_bf16 v[40:43], a[156:159], v[156:159], v[40:43]
    v_mfma_f32_16x16x32_bf16 v[44:47], a[220:223], v[156:159], v[44:47]
    s_waitcnt vmcnt(7)
    v_mfma_f32_16x16x32_bf16 v[32:35], a[32:35], v[160:163], v[32:35]
    v_mfma_f32_16x16x32_bf16 v[36:39], a[96:99], v[160:163], v[36:39]
    v_mfma_f32_16x16x32_bf16 v[40:43], a[160:163], v[160:163], v[40:43]
    v_mfma_f32_16x16x32_bf16 v[44:47], a[224:227], v[160:163], v[44:47]
    s_waitcnt vmcnt(6)
    v_mfma_f32_16x16x32_bf16 v[32:35], a[36:39], v[164:167], v[32:35]
    v_mfma_f32_16x16x32_bf16 v[36:39], a[100:103], v[164:167], v[36:39]
    v_mfma_f32_16x16x32_bf16 v[40:43], a[164:167], v[164:167], v[40:43]
    v_mfma_f32_16x16x32_bf16 v[44:47], a[228:231], v[164:167], v[44:47]
    s_waitcnt vmcnt(5)
    v_mfma_f32_16x16x32_bf16 v[32:35], a[40:43], v[168:171], v[32:35]
    v_mfma_f32_16x16x32_bf16 v[36:39], a[104:107], v[168:171], v[36:39]
    v_mfma_f32_16x16x32_bf16 v[40:43], a[168:171], v[168:171], v[40:43]
    v_mfma_f32_16x16x32_bf16 v[44:47], a[232:235], v[168:171], v[44:47]
    s_waitcnt vmcnt(4)
    v_mfma_f32_16x16x32_bf16 v[32:35], a[44:47], v[172:175], v[32:35]
    v_mfma_f32_16x16x32_bf16 v[36:39], a[108:111], v[172:175], v[36:39]
    v_mfma_f32_16x16x32_bf16 v[40:43], a[172:175], v[172:175], v[40:43]
    v_mfma_f32_16x16x32_bf16 v[44:47], a[236:239], v[172:175], v[44:47]
    s_waitcnt vmcnt(3)
    v_mfma_f32_16x16x32_bf16 v[32:35], a[48:51], v[176:179], v[32:35]
    v_mfma_f32_16x16x32_bf16 v[36:39], a[112:115], v[176:179], v[36:39]
    v_mfma_f32_16x16x32_bf16 v[40:43], a[176:179], v[176:179], v[40:43]
    v_mfma_f32_16x16x32_bf16 v[44:47], a[240:243], v[176:179], v[44:47]
    s_waitcnt vmcnt(2)
    v_mfma_f32_16x16x32_bf16 v[32:35], a[52:55], v[180:183], v[32:35]
    v_mfma_f32_16x16x32_bf16 v[36:39], a[116:119], v[180:183], v[36:39]
    v_mfma_f32_16x16x32_bf16 v[40:43], a[180:183], v[180:183], v[40:43]
    v_mfma_f32_16x16x32_bf16 v[44:47], a[244:247], v[180:183], v[44:47]
    s_waitcnt vmcnt(1)
    v_mfma_f32_16x16x32_bf16 v[32:35], a[56:59], v[184:187], v[32:35]
    v_mfma_f32_16x16x32_bf16 v[36:39], a[120:123], v[184:187], v[36:39]
    v_mfma_f32_16x16x32_bf16 v[40:43], a[184:187], v[184:187], v[40:43]
    v_mfma_f32_16x16x32_bf16 v[44:47], a[248:251], v[184:187], v[44:47]
    s_waitcnt vmcnt(0)
    v_mfma_f32_16x16x32_bf16 v[32:35], a[60:63], v[188:191], v[32:35]
    v_mfma_f32_16x16x32_bf16 v[36:39], a[124:127], v[188:191], v[36:39]
    v_mfma_f32_16x16x32_bf16 v[40:43], a[188:191], v[188:191], v[40:43]
    v_mfma_f32_16x16x32_bf16 v[44:47], a[252:255], v[188:191], v[44:47]
    v_cvt_pk_bf16_f32 v48, v16, v17
    v_cvt_pk_bf16_f32 v49, v18, v19
    v_cvt_pk_bf16_f32 v50, v20, v21
    v_cvt_pk_bf16_f32 v51, v22, v23
    buffer_store_dwordx4 v[48:51], v8, s[24:27], s77 offen offset:0
    v_cvt_pk_bf16_f32 v52, v24, v25
    v_cvt_pk_bf16_f32 v53, v26, v27
    v_cvt_pk_bf16_f32 v54, v28, v29
    v_cvt_pk_bf16_f32 v55, v30, v31
    buffer_store_dwordx4 v[52:55], v8, s[24:27], s77 offen offset:64
    v_cvt_pk_bf16_f32 v56, v32, v33
    v_cvt_pk_bf16_f32 v57, v34, v35
    v_cvt_pk_bf16_f32 v58, v36, v37
    v_cvt_pk_bf16_f32 v59, v38, v39
    buffer_store_dwordx4 v[56:59], v8, s[24:27], s78 offen offset:0
    v_cvt_pk_bf16_f32 v60, v40, v41
    v_cvt_pk_bf16_f32 v61, v42, v43
    v_cvt_pk_bf16_f32 v62, v44, v45
    v_cvt_pk_bf16_f32 v63, v46, v47
    buffer_store_dwordx4 v[60:63], v8, s[24:27], s78 offen offset:64
    v_mov_b32 v12, 105344
    v_bfe_u32 v1, v0, 2, 2
    v_mul_u32_u24 v1, 7296, v1
    v_add_u32 v12, v12, v1
    v_bfe_u32 v1, v0, 0, 2
    v_mul_u32_u24 v1, 912, v1
    v_add_u32 v12, v12, v1
    v_bfe_u32 v1, v0, 4, 2
    v_lshl_add_u32 v12, v1, 4, v12
    v_mov_b32 v13, 108992
    v_bfe_u32 v1, v0, 2, 2
    v_mul_u32_u24 v1, 7296, v1
    v_add_u32 v13, v13, v1
    v_bfe_u32 v1, v0, 0, 2
    v_mul_u32_u24 v1, 912, v1
    v_add_u32 v13, v13, v1
    v_bfe_u32 v1, v0, 4, 2
    v_lshl_add_u32 v13, v1, 4, v13
    v_mov_b32 v14, 134528
    v_bfe_u32 v1, v0, 2, 2
    v_mul_u32_u24 v1, 7296, v1
    v_add_u32 v14, v14, v1
    v_bfe_u32 v1, v0, 0, 2
    v_mul_u32_u24 v1, 912, v1
    v_add_u32 v14, v14, v1
    v_bfe_u32 v1, v0, 4, 2
    v_lshl_add_u32 v14, v1, 4, v14
    v_mov_b32 v15, 138176
    v_bfe_u32 v1, v0, 2, 2
    v_mul_u32_u24 v1, 7296, v1
    v_add_u32 v15, v15, v1
    v_bfe_u32 v1, v0, 0, 2
    v_mul_u32_u24 v1, 912, v1
    v_add_u32 v15, v15, v1
    v_bfe_u32 v1, v0, 4, 2
    v_lshl_add_u32 v15, v1, 4, v15
    s_mul_i32 s65, s72, 28672
    s_lshl_b32 s66, s73, 11
    s_add_u32 s65, s65, s66
    v_mov_b32 v4, s65
    v_bfe_u32 v1, v0, 0, 6
    v_lshl_add_u32 v4, v1, 4, v4
    v_add_u32 v5, 1024, v4
    v_add_u32 v6, 14336, v4
    v_add_u32 v7, 15360, v4
    s_mov_b32 s79, 46137344
    s_branch L_w1b_c
L_w1b_b:
    v_mov_b32 v12, 105344
    v_bfe_u32 v1, v0, 0, 4
    v_mul_u32_u24 v1, 912, v1
    v_add_u32 v12, v12, v1
    v_bfe_u32 v1, v0, 4, 2
    v_lshl_add_u32 v12, v1, 4, v12
    v_mov_b32 v13, 119936
    v_bfe_u32 v1, v0, 0, 4
    v_mul_u32_u24 v1, 912, v1
    v_add_u32 v13, v13, v1
    v_bfe_u32 v1, v0, 4, 2
    v_lshl_add_u32 v13, v1, 4, v13
    v_mov_b32 v14, 134528
    v_bfe_u32 v1, v0, 0, 4
    v_mul_u32_u24 v1, 912, v1
    v_add_u32 v14, v14, v1
    v_bfe_u32 v1, v0, 4, 2
    v_lshl_add_u32 v14, v1, 4, v14
    v_mov_b32 v15, 149120
    v_bfe_u32 v1, v0, 0, 4
    v_mul_u32_u24 v1, 912, v1
    v_add_u32 v15, v15, v1
    v_bfe_u32 v1, v0, 4, 2
    v_lshl_add_u32 v15, v1, 4, v15
    s_mul_i32 s65, s72, 28672
    s_lshl_b32 s66, s73, 12
    s_add_u32 s65, s65, s66
    v_mov_b32 v4, s65
    v_bfe_u32 v1, v0, 0, 6
    v_lshl_add_u32 v4, v1, 4, v4
    v_add_u32 v5, 2048, v4
    v_add_u32 v6, 1024, v4
    v_add_u32 v7, 3072, v4
    s_mov_b32 s79, 16777216
L_w1b_c:
    s_waitcnt lgkmcnt(0)
    s_cmp_lg_u32 s60, 0
    s_cbranch_scc1 L_wd_done_319
    v_mov_b32 v2, 208
L_wd_318:
    buffer_load_dword v3, v2, s[20:23], 0 offen sc1
    s_waitcnt vmcnt(0)
    v_cmp_gt_u32 vcc, 1, v3
    s_cbranch_vccnz L_retry_320
L_wd_done_319:
    s_barrier
    s_cmp_lg_u32 s74, 0
    s_cbranch_scc1 L_w2B
L_w2A:
    v_mov_b32 v8, 0
    v_bfe_u32 v1, v0, 0, 6
    v_lshl_add_u32 v8, v1, 4, v8
    s_lshl_b32 s65, s75, 2
    s_add_u32 s65, s65, s60
    s_lshl_b32 s65, s65, 2
    s_add_u32 s65, s65, 88293376
    v_mov_b32 v1, s65
    v_mov_b32 v2, 2147483632
    v_cmp_eq_u32 vcc, 0, v0
    s_nop 1
    v_cndmask_b32 v9, v2, v1, vcc
    s_mul_i32 s77, s60, 28672
    s_add_u32 s77, s77, 92274688
    s_mul_i32 s65, s60, 458752
    s_add_u32 s79, s79, s65
    s_mov_b32 s81, 0
    s_add_u32 s67, s77, 0
    buffer_load_dwordx4 v[64:67], v8, s[8:11], s67 offen offset:0 sc1
    ds_read_b128 a[0:3], v12 offset:0
    ds_read_b128 a[56:59], v13 offset:0
    s_add_u32 s67, s77, 12288
    buffer_load_dwordx4 v[120:123], v8, s[8:11], s67 offen offset:2048 sc1
    ds_read_b128 a[112:115], v14 offset:0
    ds_read_b128 a[168:171], v15 offset:0
    s_add_u32 s67, s77, 0
    buffer_load_dwordx4 v[68:71], v8, s[8:11], s67 offen offset:1024 sc1
    ds_read_b128 a[4:7], v12 offset:64
    ds_read_b128 a[60:63], v13 offset:64
    s_add_u32 s67, s77, 12288
    buffer_load_dwordx4 v[124:127], v8, s[8:11], s67 offen offset:3072 sc1
    ds_read_b128 a[116:119], v14 offset:64
    ds_read_b128 a[172:175], v15 offset:64
    s_waitcnt lgkmcnt(6)
    buffer_store_dword v1, v2, s[8:11], 0 offen
    s_add_u32 s67, s77, 0
    buffer_load_dwordx4 v[72:75], v8, s[8:11], s67 offen offset:2048 sc1
    ds_read_b128 a[8:11], v12 offset:128
    ds_read_b128 a[64:67], v13 offset:128
    s_add_u32 s67, s77, 16384
    buffer_load_dwordx4 v[128:131], v8, s[8:11], s67 offen offset:0 sc1
    ds_read_b128 a[120:123], v14 offset:128
    ds_read_b128 a[176:179], v15 offset:128
    s_add_u32 s67, s77, 0
    buffer_load_dwordx4 v[76:79], v8, s[8:11], s67 offen offset:3072 sc1
    ds_read_b128 a[12:15], v12 offset:192
    ds_read_b128 a[68:71], v13 offset:192
    s_add_u32 s67, s77, 16384
    buffer_load_dwordx4 v[132:135], v8, s[8:11], s67 offen offset:1024 sc1
    ds_read_b128 a[124:127], v14 offset:192
    ds_read_b128 a[180:183], v15 offset:192
    s_waitcnt lgkmcnt(6)
    s_add_u32 s67, s77, 4096
    buffer_load_dwordx4 v[80:83], v8, s[8:11], s67 offen offset:0 sc1
    ds_read_b128 a[16:19], v12 offset:256
    ds_read_b128 a[72:75], v13 offset:256
    s_add_u32 s67, s77, 16384
    buffer_load_dwordx4 v[136:139], v8, s[8:11], s67 offen offset:2048 sc1
    ds_read_b128 a[128:131], v14 offset:256
    ds_read_b128 a[184:187], v15 offset:256
    s_add_u32 s67, s77, 4096
    buffer_load_dwordx4 v[84:87], v8, s[8:11], s67 offen offset:1024 sc1
    ds_read_b128 a[20:23], v12 offset:320
    ds_read_b128 a[76:79], v13 offset:320
    s_add_u32 s67, s77, 16384
    buffer_load_dwordx4 v[140:143], v8, s[8:11], s67 offen offset:3072 sc1
    ds_read_b128 a[132:135], v14 offset:320
    ds_read_b128 a[188:191], v15 offset:320
    s_waitcnt lgkmcnt(6)
    s_add_u32 s67, s77, 4096
    buffer_load_dwordx4 v[88:91], v8, s[8:11], s67 offen offset:2048 sc1
    ds_read_b128 a[24:27], v12 offset:384
    ds_read_b128 a[80:83], v13 offset:384
    s_add_u32 s67, s77, 20480
    buffer_load_dwordx4 v[144:147], v8, s[8:11], s67 offen offset:0 sc1
    ds_read_b128 a[136:139], v14 offset:384
    ds_read_b128 a[192:195], v15 offset:384
    s_add_u32 s67, s77, 4096
    buffer_load_dwordx4 v[92:95], v8, s[8:11], s67 offen offset:3072 sc1
    ds_read_b128 a[28:31], v12 offset:448
    ds_read_b128 a[84:87], v13 offset:448
    s_add_u32 s67, s77, 20480
    buffer_load_dwordx4 v[148:151], v8, s[8:11], s67 offen offset:1024 sc1
    ds_read_b128 a[140:143], v14 offset:448
    ds_read_b128 a[196:199], v15 offset:448
    s_waitcnt lgkmcnt(6)
    s_add_u32 s67, s77, 8192
    buffer_load_dwordx4 v[96:99], v8, s[8:11], s67 offen offset:0 sc1
    ds_read_b128 a[32:35], v12 offset:512
    ds_read_b128 a[88:91], v13 offset:512
    s_add_u32 s67, s77, 20480
    buffer_load_dwordx4 v[152:155], v8, s[8:11], s67 offen offset:2048 sc1
    ds_read_b128 a[144:147], v14 offset:512
    ds_read_b128 a[200:203], v15 offset:512
    s_add_u32 s67, s77, 8192
    buffer_load_dwordx4 v[100:103], v8, s[8:11], s67 offen offset:1024 sc1
    ds_read_b128 a[36:39], v12 offset:576
    ds_read_b128 a[92:95], v13 offset:576
    s_add_u32 s67, s77, 20480
    buffer_load_dwordx4 v[156:159], v8, s[8:11], s67 offen offset:3072 sc1
    ds_read_b128 a[148:151], v14 offset:576
    ds_read_b128 a[204:207], v15 offset:576
    s_waitcnt lgkmcnt(6)
    s_add_u32 s67, s77, 8192
    buffer_load_dwordx4 v[104:107], v8, s[8:11], s67 offen offset:2048 sc1
    ds_read_b128 a[40:43], v12 offset:640
    ds_read_b128 a[96:99], v13 offset:640
    s_add_u32 s67, s77, 24576
    buffer_load_dwordx4 v[160:163], v8, s[8:11], s67 offen offset:0 sc1
    ds_read_b128 a[152:155], v14 offset:640
    ds_read_b128 a[208:211], v15 offset:640
    s_add_u32 s67, s77, 8192
    buffer_load_dwordx4 v[108:111], v8, s[8:11], s67 offen offset:3072 sc1
    ds_read_b128 a[44:47], v12 offset:704
    ds_read_b128 a[100:103], v13 offset:704
    s_add_u32 s67, s77, 24576
    buffer_load_dwordx4 v[164:167], v8, s[8:11], s67 offen offset:1024 sc1
    ds_read_b128 a[156:159], v14 offset:704
    ds_read_b128 a[212:215], v15 offset:704
    s_waitcnt lgkmcnt(6)
    s_add_u32 s67, s77, 12288
    buffer_load_dwordx4 v[112:115], v8, s[8:11], s67 offen offset:0 sc1
    ds_read_b128 a[48:51], v12 offset:768
    ds_read_b128 a[104:107], v13 offset:768
    s_add_u32 s67, s77, 24576
    buffer_load_dwordx4 v[168:171], v8, s[8:11], s67 offen offset:2048 sc1
    ds_read_b128 a[160:163], v14 offset:768
    ds_read_b128 a[216:219], v15 offset:768
    s_add_u32 s67, s77, 12288
    buffer_load_dwordx4 v[116:119], v8, s[8:11], s67 offen offset:1024 sc1
    ds_read_b128 a[52:55], v12 offset:832
    ds_read_b128 a[108:111], v13 offset:832
    s_add_u32 s67, s77, 24576
    buffer_load_dwordx4 v[172:175], v8, s[8:11], s67 offen offset:3072 sc1
    ds_read_b128 a[164:167], v14 offset:832
    ds_read_b128 a[220:223], v15 offset:832
    s_waitcnt lgkmcnt(6)
    s_waitcnt lgkmcnt(0)
    s_add_u32 s77, s77, 114688
    buffer_store_dword v1, v2, s[8:11], 0 offen
    buffer_store_dword v1, v2, s[8:11], 0 offen
    buffer_store_dword v1, v2, s[8:11], 0 offen
    buffer_store_dword v1, v2, s[8:11], 0 offen
L_w2loopA:
    s_waitcnt vmcnt(31)
    v_mfma_f32_16x16x32_bf16 v[16:19], a[0:3], v[64:67], 0
    v_mfma_f32_16x16x32_bf16 v[20:23], a[56:59], v[64:67], 0
    s_add_u32 s67, s77, 0
    buffer_load_dwordx4 v[176:179], v8, s[8:11], s67 offen offset:0 sc1
    v_mfma_f32_16x16x32_bf16 v[24:27], a[112:115], v[64:67], 0
    v_mfma_f32_16x16x32_bf16 v[28:31], a[168:171], v[64:67], 0
    v_mfma_f32_16x16x32_bf16 v[32:35], a[0:3], v[120:123], 0
    v_mfma_f32_16x16x32_bf16 v[36:39], a[56:59], v[120:123], 0
    s_add_u32 s67, s77, 12288
    buffer_load_dwordx4 v[232:235], v8, s[8:11], s67 offen offset:2048 sc1
    v_mfma_f32_16x16x32_bf16 v[40:43], a[112:115], v[120:123], 0
    v_mfma_f32_16x16x32_bf16 v[44:47], a[168:171], v[120:123], 0
    s_waitcnt vmcnt(31)
    v_mfma_f32_16x16x32_bf16 v[16:19], a[4:7], v[68:71], v[16:19]
    v_mfma_f32_16x16x32_bf16 v[20:23], a[60:63], v[68:71], v[20:23]
    s_add_u32 s67, s77, 0
    buffer_load_dwordx4 v[180:183], v8, s[8:11], s67 offen offset:1024 sc1
    v_mfma_f32_16x16x32_bf16 v[24:27], a[116:119], v[68:71], v[24:27]
    v_mfma_f32_16x16x32_bf16 v[28:31], a[172:175], v[68:71], v[28:31]
    v_mfma_f32_16x16x32_bf16 v[32:35], a[4:7], v[124:127], v[32:35]
    v_mfma_f32_16x16x32_bf16 v[36:39], a[60:63], v[124:127], v[36:39]
    s_add_u32 s67, s77, 12288
    buffer_load_dwordx4 v[236:239], v8, s[8:11], s67 offen offset:3072 sc1
    v_mfma_f32_16x16x32_bf16 v[40:43], a[116:119], v[124:127], v[40:43]
    v_mfma_f32_16x16x32_bf16 v[44:47], a[172:175], v[124:127], v[44:47]
    s_waitcnt vmcnt(4)
    v_mov_b32 v10, s81
    buffer_store_dword v10, v9, s[8:11], 0 offen sc1
    v_mfma_f32_16x16x32_bf16 v[16:19], a[8:11], v[72:75], v[16:19]
    v_mfma_f32_16x16x32_bf16 v[20:23], a[64:67], v[72:75], v[20:23]
    s_add_u32 s67, s77, 0
    buffer_load_dwordx4 v[184:187], v8, s[8:11], s67 offen offset:2048 sc1
    v_mfma_f32_16x16x32_bf16 v[24:27], a[120:123], v[72:75], v[24:27]
    v_mfma_f32_16x16x32_bf16 v[28:31], a[176:179], v[72:75], v[28:31]
    v_mfma_f32_16x16x32_bf16 v[32:35], a[8:11], v[128:131], v[32:35]
    v_mfma_f32_16x16x32_bf16 v[36:39], a[64:67], v[128:131], v[36:39]
    s_add_u32 s67, s77, 16384
    buffer_load_dwordx4 v[240:243], v8, s[8:11], s67 offen offset:0 sc1
    v_mfma_f32_16x16x32_bf16 v[40:43], a[120:123], v[128:131], v[40:43]
    v_mfma_f32_16x16x32_bf16 v[44:47], a[176:179], v[128:131], v[44:47]
    v_mfma_f32_16x16x32_bf16 v[16:19], a[12:15], v[76:79], v[16:19]
    v_mfma_f32_16x16x32_bf16 v[20:23], a[68:71], v[76:79], v[20:23]
    s_add_u32 s67, s77, 0
    buffer_load_dwordx4 v[188:191], v8, s[8:11], s67 offen offset:3072 sc1
    v_mfma_f32_16x16x32_bf16 v[24:27], a[124:127], v[76:79], v[24:27]
    v_mfma_f32_16x16x32_bf16 v[28:31], a[180:183], v[76:79], v[28:31]
    v_mfma_f32_16x16x32_bf16 v[32:35], a[12:15], v[132:135], v[32:35]
    v_mfma_f32_16x16x32_bf16 v[36:39], a[68:71], v[132:135], v[36:39]
    s_add_u32 s67, s77, 16384
    buffer_load_dwordx4 v[244:247], v8, s[8:11], s67 offen offset:1024 sc1
    v_mfma_f32_16x16x32_bf16 v[40:43], a[124:127], v[132:135], v[40:43]
    v_mfma_f32_16x16x32_bf16 v[44:47], a[180:183], v[132:135], v[44:47]
    v_mfma_f32_16x16x32_bf16 v[16:19], a[16:19], v[80:83], v[16:19]
    v_mfma_f32_16x16x32_bf16 v[20:23], a[72:75], v[80:83], v[20:23]
    s_add_u32 s67, s77, 4096
    buffer_load_dwordx4 v[192:195], v8, s[8:11], s67 offen offset:0 sc1
    v_mfma_f32_16x16x32_bf16 v[24:27], a[128:131], v[80:83], v[24:27]
    v_mfma_f32_16x16x32_bf16 v[28:31], a[184:187], v[80:83], v[28:31]
    v_mfma_f32_16x16x32_bf16 v[32:35], a[16:19], v[136:139], v[32:35]
    v_mfma_f32_16x16x32_bf16 v[36:39], a[72:75], v[136:139], v[36:39]
    s_add_u32 s67, s77, 16384
    buffer_load_dwordx4 v[248:251], v8, s[8:11], s67 offen offset:2048 sc1
    v_mfma_f32_16x16x32_bf16 v[40:43], a[128:131], v[136:139], v[40:43]
    v_mfma_f32_16x16x32_bf16 v[44:47], a[184:187], v[136:139], v[44:47]
    v_mfma_f32_16x16x32_bf16 v[16:19], a[20:23], v[84:87], v[16:19]
    v_mfma_f32_16x16x32_bf16 v[20:23], a[76:79], v[84:87], v[20:23]
    s_add_u32 s67, s77, 4096
    buffer_load_dwordx4 v[196:199], v8, s[8:11], s67 offen offset:1024 sc1
    v_mfma_f32_16x16x32_bf16 v[24:27], a[132:135], v[84:87], v[24:27]
    v_mfma_f32_16x16x32_bf16 v[28:31], a[188:191], v[84:87], v[28:31]
    v_mfma_f32_16x16x32_bf16 v[32:35], a[20:23], v[140:143], v[32:35]
    v_mfma_f32_16x16x32_bf16 v[36:39], a[76:79], v[140:143], v[36:39]
    s_add_u32 s67, s77, 16384
    buffer_load_dwordx4 v[252:255], v8, s[8:11], s67 offen offset:3072 sc1
    v_mfma_f32_16x16x32_bf16 v[40:43], a[132:135], v[140:143], v[40:43]
    v_mfma_f32_16x16x32_bf16 v[44:47], a[188:191], v[140:143], v[44:47]
    v_mfma_f32_16x16x32_bf16 v[16:19], a[24:27], v[88:91], v[16:19]
    v_mfma_f32_16x16x32_bf16 v[20:23], a[80:83], v[88:91], v[20:23]
    s_add_u32 s67, s77, 4096
    buffer_load_dwordx4 v[200:203], v8, s[8:11], s67 offen offset:2048 sc1
    v_mfma_f32_16x16x32_bf16 v[24:27], a[136:139], v[88:91], v[24:27]
    v_mfma_f32_16x16x32_bf16 v[28:31], a[192:195], v[88:91], v[28:31]
    v_mfma_f32_16x16x32_bf16 v[32:35], a[24:27], v[144:147], v[32:35]
    v_mfma_f32_16x16x32_bf16 v[36:39], a[80:83], v[144:147], v[36:39]
    s_add_u32 s67, s77, 20480
    buffer_load_dwordx4 a[224:227], v8, s[8:11], s67 offen offset:0 sc1
    v_mfma_f32_16x16x32_bf16 v[40:43], a[136:139], v[144:147], v[40:43]
    v_mfma_f32_16x16x32_bf16 v[44:47], a[192:195], v[144:147], v[44:47]
    v_mfma_f32_16x16x32_bf16 v[16:19], a[28:31], v[92:95], v[16:19]
    v_mfma_f32_16x16x32_bf16 v[20:23], a[84:87], v[92:95], v[20:23]
    s_add_u32 s67, s77, 4096
    buffer_load_dwordx4 v[204:207], v8, s[8:11], s67 offen offset:3072 sc1
    v_mfma_f32_16x16x32_bf16 v[24:27], a[140:143], v[92:95], v[24:27]
    v_mfma_f32_16x16x32_bf16 v[28:31], a[196:199], v[92:95], v[28:31]
    v_mfma_f32_16x16x32_bf16 v[32:35], a[28:31], v[148:151], v[32:35]
    v_mfma_f32_16x16x32_bf16 v[36:39], a[84:87], v[148:151], v[36:39]
    s_add_u32 s67, s77, 20480
    buffer_load_dwordx4 a[228:231], v8, s[8:11], s67 offen offset:1024 sc1
    v_mfma_f32_16x16x32_bf16 v[40:43], a[140:143], v[148:151], v[40:43]
    v_mfma_f32_16x16x32_bf16 v[44:47], a[196:199], v[148:151], v[44:47]
    v_mfma_f32_16x16x32_bf16 v[16:19], a[32:35], v[96:99], v[16:19]
    v_mfma_f32_16x16x32_bf16 v[20:23], a[88:91], v[96:99], v[20:23]
    s_add_u32 s67, s77, 8192
    buffer_load_dwordx4 v[208:211], v8, s[8:11], s67 offen offset:0 sc1
    v_mfma_f32_16x16x32_bf16 v[24:27], a[144:147], v[96:99], v[24:27]
    v_mfma_f32_16x16x32_bf16 v[28:31], a[200:203], v[96:99], v[28:31]
    v_mfma_f32_16x16x32_bf16 v[32:35], a[32:35], v[152:155], v[32:35]
    v_mfma_f32_16x16x32_bf16 v[36:39], a[88:91], v[152:155], v[36:39]
    s_add_u32 s67, s77, 20480
    buffer_load_dwordx4 a[232:235], v8, s[8:11], s67 offen offset:2048 sc1
    v_mfma_f32_16x16x32_bf16 v[40:43], a[144:147], v[152:155], v[40:43]
    v_mfma_f32_16x16x32_bf16 v[44:47], a[200:203], v[152:155], v[44:47]
    v_mfma_f32_16x16x32_bf16 v[16:19], a[36:39], v[100:103], v[16:19]
    v_mfma_f32_16x16x32_bf16 v[20:23], a[92:95], v[100:103], v[20:23]
    s_add_u32 s67, s77, 8192
    buffer_load_dwordx4 v[212:215], v8, s[8:11], s67 offen offset:1024 sc1
    v_mfma_f32_16x16x32_bf16 v[24:27], a[148:151], v[100:103], v[24:27]
    v_mfma_f32_16x16x32_bf16 v[28:31], a[204:207], v[100:103], v[28:31]
    v_mfma_f32_16x16x32_bf16 v[32:35], a[36:39], v[156:159], v[32:35]
    v_mfma_f32_16x16x32_bf16 v[36:39], a[92:95], v[156:159], v[36:39]
    s_add_u32 s67, s77, 20480
    buffer_load_dwordx4 a[236:239], v8, s[8:11], s67 offen offset:3072 sc1
    v_mfma_f32_16x16x32_bf16 v[40:43], a[148:151], v[156:159], v[40:43]
    v_mfma_f32_16x16x32_bf16 v[44:47], a[204:207], v[156:159], v[44:47]
    v_mfma_f32_16x16x32_bf16 v[16:19], a[40:43], v[104:107], v[16:19]
    v_mfma_f32_16x16x32_bf16 v[20:23], a[96:99], v[104:107], v[20:23]
    s_add_u32 s67, s77, 8192
    buffer_load_dwordx4 v[216:219], v8, s[8:11], s67 offen offset:2048 sc1
    v_mfma_f32_16x16x32_bf16 v[24:27], a[152:155], v[104:107], v[24:27]
    v_mfma_f32_16x16x32_bf16 v[28:31], a[208:211], v[104:107], v[28:31]
    v_mfma_f32_16x16x32_bf16 v[32:35], a[40:43], v[160:163], v[32:35]
    v_mfma_f32_16x16x32_bf16 v[36:39], a[96:99], v[160:163], v[36:39]
    s_add_u32 s67, s77, 24576
    buffer_load_dwordx4 a[240:243], v8, s[8:11], s67 offen offset:0 sc1
    v_mfma_f32_16x16x32_bf16 v[40:43], a[152:155], v[160:163], v[40:43]
    v_mfma_f32_16x16x32_bf16 v[44:47], a[208:211], v[160:163], v[44:47]
    v_mfma_f32_16x16x32_bf16 v[16:19], a[44:47], v[108:111], v[16:19]
    v_mfma_f32_16x16x32_bf16 v[20:23], a[100:103], v[108:111], v[20:23]
    s_add_u32 s67, s77, 8192
    buffer_load_dwordx4 v[220:223], v8, s[8:11], s67 offen offset:3072 sc1
    v_mfma_f32_16x16x32_bf16 v[24:27], a[156:159], v[108:111], v[24:27]
    v_mfma_f32_16x16x32_bf16 v[28:31], a[212:215], v[108:111], v[28:31]
    v_mfma_f32_16x16x32_bf16 v[32:35], a[44:47], v[164:167], v[32:35]
    v_mfma_f32_16x16x32_bf16 v[36:39], a[100:103], v[164:167], v[36:39]
    s_add_u32 s67, s77, 24576
    buffer_load_dwordx4 a[244:247], v8, s[8:11], s67 offen offset:1024 sc1
    v_mfma_f32_16x16x32_bf16 v[40:43], a[156:159], v[164:167], v[40:43]
    v_mfma_f32_16x16x32_bf16 v[44:47], a[212:215], v[164:167], v[44:47]
    v_mfma_f32_16x16x32_bf16 v[16:19], a[48:51], v[112:115], v[16:19]
    v_mfma_f32_16x16x32_bf16 v[20:23], a[104:107], v[112:115], v[20:23]
    s_add_u32 s67, s77, 12288
    buffer_load_dwordx4 v[224:227], v8, s[8:11], s67 offen offset:0 sc1
    v_mfma_f32_16x16x32_bf16 v[24:27], a[160:163], v[112:115], v[24:27]
    v_mfma_f32_16x16x32_bf16 v[28:31], a[216:219], v[112:115], v[28:31]
    v_mfma_f32_16x16x32_bf16 v[32:35], a[48:51], v[168:171], v[32:35]
    v_mfma_f32_16x16x32_bf16 v[36:39], a[104:107], v[168:171], v[36:39]
    s_add_u32 s67, s77, 24576
    buffer_load_dwordx4 a[248:251], v8, s[8:11], s67 offen offset:2048 sc1
    v_mfma_f32_16x16x32_bf16 v[40:43], a[160:163], v[168:171], v[40:43]
    v_mfma_f32_16x16x32_bf16 v[44:47], a[216:219], v[168:171], v[44:47]
    v_mfma_f32_16x16x32_bf16 v[16:19], a[52:55], v[116:119], v[16:19]
    v_mfma_f32_16x16x32_bf16 v[20:23], a[108:111], v[116:119], v[20:23]
    s_add_u32 s67, s77, 12288
    buffer_load_dwordx4 v[228:231], v8, s[8:11], s67 offen offset:1024 sc1
    v_mfma_f32_16x16x32_bf16 v[24:27], a[164:167], v[116:119], v[24:27]
    v_mfma_f32_16x16x32_bf16 v[28:31], a[220:223], v[116:119], v[28:31]
    v_mfma_f32_16x16x32_bf16 v[32:35], a[52:55], v[172:175], v[32:35]
    v_mfma_f32_16x16x32_bf16 v[36:39], a[108:111], v[172:175], v[36:39]
    s_add_u32 s67, s77, 24576
    buffer_load_dwordx4 a[252:255], v8, s[8:11], s67 offen offset:3072 sc1
    v_mfma_f32_16x16x32_bf16 v[40:43], a[164:167], v[172:175], v[40:43]
    v_mfma_f32_16x16x32_bf16 v[44:47], a[220:223], v[172:175], v[44:47]
    s_add_u32 s77, s77, 114688
    v_cvt_pk_bf16_f32 v48, v16, v17
    v_cvt_pk_bf16_f32 v49, v18, v19
    v_cvt_pk_bf16_f32 v50, v20, v21
    v_cvt_pk_bf16_f32 v51, v22, v23
    buffer_store_dwordx4 v[48:51], v4, s[8:11], s79 offen sc1
    v_cvt_pk_bf16_f32 v52, v24, v25
    v_cvt_pk_bf16_f32 v53, v26, v27
    v_cvt_pk_bf16_f32 v54, v28, v29
    v_cvt_pk_bf16_f32 v55, v30, v31
    buffer_store_dwordx4 v[52:55], v5, s[8:11], s79 offen sc1
    v_cvt_pk_bf16_f32 v56, v32, v33
    v_cvt_pk_bf16_f32 v57, v34, v35
    v_cvt_pk_bf16_f32 v58, v36, v37
    v_cvt_pk_bf16_f32 v59, v38, v39
    buffer_store_dwordx4 v[56:59], v6, s[8:11], s79 offen sc1
    v_cvt_pk_bf16_f32 v60, v40, v41
    v_cvt_pk_bf16_f32 v61, v42, v43
    v_cvt_pk_bf16_f32 v62, v44, v45
    v_cvt_pk_bf16_f32 v63, v46, v47
    buffer_store_dwordx4 v[60:63], v7, s[8:11], s79 offen sc1
    s_add_u32 s79, s79, 1835008
    s_add_u32 s81, s81, 1
    s_waitcnt vmcnt(31)
    v_mfma_f32_16x16x32_bf16 v[16:19], a[0:3], v[176:179], 0
    v_mfma_f32_16x16x32_bf16 v[20:23], a[56:59], v[176:179], 0
    s_add_u32 s67, s77, 0
    buffer_load_dwordx4 v[64:67], v8, s[8:11], s67 offen offset:0 sc1
    v_mfma_f32_16x16x32_bf16 v[24:27], a[112:115], v[176:179], 0
    v_mfma_f32_16x16x32_bf16 v[28:31], a[168:171], v[176:179], 0
    v_mfma_f32_16x16x32_bf16 v[32:35], a[0:3], v[232:235], 0
    v_mfma_f32_16x16x32_bf16 v[36:39], a[56:59], v[232:235], 0
    s_add_u32 s67, s77, 12288
    buffer_load_dwordx4 v[120:123], v8, s[8:11], s67 offen offset:2048 sc1
    v_mfma_f32_16x16x32_bf16 v[40:43], a[112:115], v[232:235], 0
    v_mfma_f32_16x16x32_bf16 v[44:47], a[168:171], v[232:235], 0
    s_waitcnt vmcnt(31)
    v_mfma_f32_16x16x32_bf16 v[16:19], a[4:7], v[180:183], v[16:19]
    v_mfma_f32_16x16x32_bf16 v[20:23], a[60:63], v[180:183], v[20:23]
    s_add_u32 s67, s77, 0
    buffer_load_dwordx4 v[68:71], v8, s[8:11], s67 offen offset:1024 sc1
    v_mfma_f32_16x16x32_bf16 v[24:27], a[116:119], v[180:183], v[24:27]
    v_mfma_f32_16x16x32_bf16 v[28:31], a[172:175], v[180:183], v[28:31]
    v_mfma_f32_16x16x32_bf16 v[32:35], a[4:7], v[236:239], v[32:35]
    v_mfma_f32_16x16x32_bf16 v[36:39], a[60:63], v[236:239], v[36:39]
    s_add_u32 s67, s77, 12288
    buffer_load_dwordx4 v[124:127], v8, s[8:11], s67 offen offset:3072 sc1
    v_mfma_f32_16x16x32_bf16 v[40:43], a[116:119], v[236:239], v[40:43]
    v_mfma_f32_16x16x32_bf16 v[44:47], a[172:175], v[236:239], v[44:47]
    s_waitcnt vmcnt(4)
    v_mov_b32 v10, s81
    buffer_store_dword v10, v9, s[8:11], 0 offen sc1
    v_mfma_f32_16x16x32_bf16 v[16:19], a[8:11], v[184:187], v[16:19]
    v_mfma_f32_16x16x32_bf16 v[20:23], a[64:67], v[184:187], v[20:23]
    s_add_u32 s67, s77, 0
    buffer_load_dwordx4 v[72:75], v8, s[8:11], s67 offen offset:2048 sc1
    v_mfma_f32_16x16x32_bf16 v[24:27], a[120:123], v[184:187], v[24:27]
    v_mfma_f32_16x16x32_bf16 v[28:31], a[176:179], v[184:187], v[28:31]
    v_mfma_f32_16x16x32_bf16 v[32:35], a[8:11], v[240:243], v[32:35]
    v_mfma_f32_16x16x32_bf16 v[36:39], a[64:67], v[240:243], v[36:39]
    s_add_u32 s67, s77, 16384
    buffer_load_dwordx4 v[128:131], v8, s[8:11], s67 offen offset:0 sc1
    v_mfma_f32_16x16x32_bf16 v[40:43], a[120:123], v[240:243], v[40:43]
    v_mfma_f32_16x16x32_bf16 v[44:47], a[176:179], v[240:243], v[44:47]
    v_mfma_f32_16x16x32_bf16 v[16:19], a[12:15], v[188:191], v[16:19]
    v_mfma_f32_16x16x32_bf16 v[20:23], a[68:71], v[188:191], v[20:23]
    s_add_u32 s67, s77, 0
    buffer_load_dwordx4 v[76:79], v8, s[8:11], s67 offen offset:3072 sc1
    v_mfma_f32_16x16x32_bf16 v[24:27], a[124:127], v[188:191], v[24:27]
    v_mfma_f32_16x16x32_bf16 v[28:31], a[180:183], v[188:191], v[28:31]
    v_mfma_f32_16x16x32_bf16 v[32:35], a[12:15], v[244:247], v[32:35]
    v_mfma_f32_16x16x32_bf16 v[36:39], a[68:71], v[244:247], v[36:39]
    s_add_u32 s67, s77, 16384
    buffer_load_dwordx4 v[132:135], v8, s[8:11], s67 offen offset:1024 sc1
    v_mfma_f32_16x16x32_bf16 v[40:43], a[124:127], v[244:247], v[40:43]
    v_mfma_f32_16x16x32_bf16 v[44:47], a[180:183], v[244:247], v[44:47]
    v_mfma_f32_16x16x32_bf16 v[16:19], a[16:19], v[192:195], v[16:19]
    v_mfma_f32_16x16x32_bf16 v[20:23], a[72:75], v[192:195], v[20:23]
    s_add_u32 s67, s77, 4096
    buffer_load_dwordx4 v[80:83], v8, s[8:11], s67 offen offset:0 sc1
    v_mfma_f32_16x16x32_bf16 v[24:27], a[128:131], v[192:195], v[24:27]
    v_mfma_f32_16x16x32_bf16 v[28:31], a[184:187], v[192:195], v[28:31]
    v_mfma_f32_16x16x32_bf16 v[32:35], a[16:19], v[248:251], v[32:35]
    v_mfma_f32_16x16x32_bf16 v[36:39], a[72:75], v[248:251], v[36:39]
    s_add_u32 s67, s77, 16384
    buffer_load_dwordx4 v[136:139], v8, s[8:11], s67 offen offset:2048 sc1
    v_mfma_f32_16x16x32_bf16 v[40:43], a[128:131], v[248:251], v[40:43]
    v_mfma_f32_16x16x32_bf16 v[44:47], a[184:187], v[248:251], v[44:47]
    v_mfma_f32_16x16x32_bf16 v[16:19], a[20:23], v[196:199], v[16:19]
    v_mfma_f32_16x16x32_bf16 v[20:23], a[76:79], v[196:199], v[20:23]
    s_add_u32 s67, s77, 4096
    buffer_load_dwordx4 v[84:87], v8, s[8:11], s67 offen offset:1024 sc1
    v_mfma_f32_16x16x32_bf16 v[24:27], a[132:135], v[196:199], v[24:27]
    v_mfma_f32_16x16x32_bf16 v[28:31], a[188:191], v[196:199], v[28:31]
    v_mfma_f32_16x16x32_bf16 v[32:35], a[20:23], v[252:255], v[32:35]
    v_mfma_f32_16x16x32_bf16 v[36:39], a[76:79], v[252:255], v[36:39]
    s_add_u32 s67, s77, 16384
    buffer_load_dwordx4 v[140:143], v8, s[8:11], s67 offen offset:3072 sc1
    v_mfma_f32_16x16x32_bf16 v[40:43], a[132:135], v[252:255], v[40:43]
    v_mfma_f32_16x16x32_bf16 v[44:47], a[188:191], v[252:255], v[44:47]
    v_mfma_f32_16x16x32_bf16 v[16:19], a[24:27], v[200:203], v[16:19]
    v_mfma_f32_16x16x32_bf16 v[20:23], a[80:83], v[200:203], v[20:23]
    s_add_u32 s67, s77, 4096
    buffer_load_dwordx4 v[88:91], v8, s[8:11], s67 offen offset:2048 sc1
    v_mfma_f32_16x16x32_bf16 v[24:27], a[136:139], v[200:203], v[24:27]
    v_mfma_f32_16x16x32_bf16 v[28:31], a[192:195], v[200:203], v[28:31]
    v_mfma_f32_16x16x32_bf16 v[32:35], a[24:27], a[224:227], v[32:35]
    v_mfma_f32_16x16x32_bf16 v[36:39], a[80:83], a[224:227], v[36:39]
    s_add_u32 s67, s77, 20480
    buffer_load_dwordx4 v[144:147], v8, s[8:11], s67 offen offset:0 sc1
    v_mfma_f32_16x16x32_bf16 v[40:43], a[136:139], a[224:227], v[40:43]
    v_mfma_f32_16x16x32_bf16 v[44:47], a[192:195], a[224:227], v[44:47]
    v_mfma_f32_16x16x32_bf16 v[16:19], a[28:31], v[204:207], v[16:19]
    v_mfma_f32_16x16x32_bf16 v[20:23], a[84:87], v[204:207], v[20:23]
    s_add_u32 s67, s77, 4096
    buffer_load_dwordx4 v[92:95], v8, s[8:11], s67 offen offset:3072 sc1
    v_mfma_f32_16x16x32_bf16 v[24:27], a[140:143], v[204:207], v[24:27]
    v_mfma_f32_16x16x32_bf16 v[28:31], a[196:199], v[204:207], v[28:31]
    v_mfma_f32_16x16x32_bf16 v[32:35], a[28:31], a[228:231], v[32:35]
    v_mfma_f32_16x16x32_bf16 v[36:39], a[84:87], a[228:231], v[36:39]
    s_add_u32 s67, s77, 20480
    buffer_load_dwordx4 v[148:151], v8, s[8:11], s67 offen offset:1024 sc1
    v_mfma_f32_16x16x32_bf16 v[40:43], a[140:143], a[228:231], v[40:43]
    v_mfma_f32_16x16x32_bf16 v[44:47], a[196:199], a[228:231], v[44:47]
    v_mfma_f32_16x16x32_bf16 v[16:19], a[32:35], v[208:211], v[16:19]
    v_mfma_f32_16x16x32_bf16 v[20:23], a[88:91], v[208:211], v[20:23]
    s_add_u32 s67, s77, 8192
    buffer_load_dwordx4 v[96:99], v8, s[8:11], s67 offen offset:0 sc1
    v_mfma_f32_16x16x32_bf16 v[24:27], a[144:147], v[208:211], v[24:27]
    v_mfma_f32_16x16x32_bf16 v[28:31], a[200:203], v[208:211], v[28:31]
    v_mfma_f32_16x16x32_bf16 v[32:35], a[32:35], a[232:235], v[32:35]
    v_mfma_f32_16x16x32_bf16 v[36:39], a[88:91], a[232:235], v[36:39]
    s_add_u32 s67, s77, 20480
    buffer_load_dwordx4 v[152:155], v8, s[8:11], s67 offen offset:2048 sc1
    v_mfma_f32_16x16x32_bf16 v[40:43], a[144:147], a[232:235], v[40:43]
    v_mfma_f32_16x16x32_bf16 v[44:47], a[200:203], a[232:235], v[44:47]
    v_mfma_f32_16x16x32_bf16 v[16:19], a[36:39], v[212:215], v[16:19]
    v_mfma_f32_16x16x32_bf16 v[20:23], a[92:95], v[212:215], v[20:23]
    s_add_u32 s67, s77, 8192
    buffer_load_dwordx4 v[100:103], v8, s[8:11], s67 offen offset:1024 sc1
    v_mfma_f32_16x16x32_bf16 v[24:27], a[148:151], v[212:215], v[24:27]
    v_mfma_f32_16x16x32_bf16 v[28:31], a[204:207], v[212:215], v[28:31]
    v_mfma_f32_16x16x32_bf16 v[32:35], a[36:39], a[236:239], v[32:35]
    v_mfma_f32_16x16x32_bf16 v[36:39], a[92:95], a[236:239], v[36:39]
    s_add_u32 s67, s77, 20480
    buffer_load_dwordx4 v[156:159], v8, s[8:11], s67 offen offset:3072 sc1
    v_mfma_f32_16x16x32_bf16 v[40:43], a[148:151], a[236:239], v[40:43]
    v_mfma_f32_16x16x32_bf16 v[44:47], a[204:207], a[236:239], v[44:47]
    v_mfma_f32_16x16x32_bf16 v[16:19], a[40:43], v[216:219], v[16:19]
    v_mfma_f32_16x16x32_bf16 v[20:23], a[96:99], v[216:219], v[20:23]
    s_add_u32 s67, s77, 8192
    buffer_load_dwordx4 v[104:107], v8, s[8:11], s67 offen offset:2048 sc1
    v_mfma_f32_16x16x32_bf16 v[24:27], a[152:155], v[216:219], v[24:27]
    v_mfma_f32_16x16x32_bf16 v[28:31], a[208:211], v[216:219], v[28:31]
    v_mfma_f32_16x16x32_bf16 v[32:35], a[40:43], a[240:243], v[32:35]
    v_mfma_f32_16x16x32_bf16 v[36:39], a[96:99], a[240:243], v[36:39]
    s_add_u32 s67, s77, 24576
    buffer_load_dwordx4 v[160:163], v8, s[8:11], s67 offen offset:0 sc1
    v_mfma_f32_16x16x32_bf16 v[40:43], a[152:155], a[240:243], v[40:43]
    v_mfma_f32_16x16x32_bf16 v[44:47], a[208:211], a[240:243], v[44:47]
    v_mfma_f32_16x16x32_bf16 v[16:19], a[44:47], v[220:223], v[16:19]
    v_mfma_f32_16x16x32_bf16 v[20:23], a[100:103], v[220:223], v[20:23]
    s_add_u32 s67, s77, 8192
    buffer_load_dwordx4 v[108:111], v8, s[8:11], s67 offen offset:3072 sc1
    v_mfma_f32_16x16x32_bf16 v[24:27], a[156:159], v[220:223], v[24:27]
    v_mfma_f32_16x16x32_bf16 v[28:31], a[212:215], v[220:223], v[28:31]
    v_mfma_f32_16x16x32_bf16 v[32:35], a[44:47], a[244:247], v[32:35]
    v_mfma_f32_16x16x32_bf16 v[36:39], a[100:103], a[244:247], v[36:39]
    s_add_u32 s67, s77, 24576
    buffer_load_dwordx4 v[164:167], v8, s[8:11], s67 offen offset:1024 sc1
    v_mfma_f32_16x16x32_bf16 v[40:43], a[156:159], a[244:247], v[40:43]
    v_mfma_f32_16x16x32_bf16 v[44:47], a[212:215], a[244:247], v[44:47]
    v_mfma_f32_16x16x32_bf16 v[16:19], a[48:51], v[224:227], v[16:19]
    v_mfma_f32_16x16x32_bf16 v[20:23], a[104:107], v[224:227], v[20:23]
    s_add_u32 s67, s77, 12288
    buffer_load_dwordx4 v[112:115], v8, s[8:11], s67 offen offset:0 sc1
    v_mfma_f32_16x16x32_bf16 v[24:27], a[160:163], v[224:227], v[24:27]
    v_mfma_f32_16x16x32_bf16 v[28:31], a[216:219], v[224:227], v[28:31]
    v_mfma_f32_16x16x32_bf16 v[32:35], a[48:51], a[248:251], v[32:35]
    v_mfma_f32_16x16x32_bf16 v[36:39], a[104:107], a[248:251], v[36:39]
    s_add_u32 s67, s77, 24576
    buffer_load_dwordx4 v[168:171], v8, s[8:11], s67 offen offset:2048 sc1
    v_mfma_f32_16x16x32_bf16 v[40:43], a[160:163], a[248:251], v[40:43]
    v_mfma_f32_16x16x32_bf16 v[44:47], a[216:219], a[248:251], v[44:47]
    v_mfma_f32_16x16x32_bf16 v[16:19], a[52:55], v[228:231], v[16:19]
    v_mfma_f32_16x16x32_bf16 v[20:23], a[108:111], v[228:231], v[20:23]
    s_add_u32 s67, s77, 12288
    buffer_load_dwordx4 v[116:119], v8, s[8:11], s67 offen offset:1024 sc1
    v_mfma_f32_16x16x32_bf16 v[24:27], a[164:167], v[228:231], v[24:27]
    v_mfma_f32_16x16x32_bf16 v[28:31], a[220:223], v[228:231], v[28:31]
    v_mfma_f32_16x16x32_bf16 v[32:35], a[52:55], a[252:255], v[32:35]
    v_mfma_f32_16x16x32_bf16 v[36:39], a[108:111], a[252:255], v[36:39]
    s_add_u32 s67, s77, 24576
    buffer_load_dwordx4 v[172:175], v8, s[8:11], s67 offen offset:3072 sc1
    v_mfma_f32_16x16x32_bf16 v[40:43], a[164:167], a[252:255], v[40:43]
    v_mfma_f32_16x16x32_bf16 v[44:47], a[220:223], a[252:255], v[44:47]
    s_add_u32 s77, s77, 114688
    v_cvt_pk_bf16_f32 v48, v16, v17
    v_cvt_pk_bf16_f32 v49, v18, v19
    v_cvt_pk_bf16_f32 v50, v20, v21
    v_cvt_pk_bf16_f32 v51, v22, v23
    buffer_store_dwordx4 v[48:51], v4, s[8:11], s79 offen sc1
    v_cvt_pk_bf16_f32 v52, v24, v25
    v_cvt_pk_bf16_f32 v53, v26, v27
    v_cvt_pk_bf16_f32 v54, v28, v29
    v_cvt_pk_bf16_f32 v55, v30, v31
    buffer_store_dwordx4 v[52:55], v5, s[8:11], s79 offen sc1
    v_cvt_pk_bf16_f32 v56, v32, v33
    v_cvt_pk_bf16_f32 v57, v34, v35
    v_cvt_pk_bf16_f32 v58, v36, v37
    v_cvt_pk_bf16_f32 v59, v38, v39
    buffer_store_dwordx4 v[56:59], v6, s[8:11], s79 offen sc1
    v_cvt_pk_bf16_f32 v60, v40, v41
    v_cvt_pk_bf16_f32 v61, v42, v43
    v_cvt_pk_bf16_f32 v62, v44, v45
    v_cvt_pk_bf16_f32 v63, v46, v47
    buffer_store_dwordx4 v[60:63], v7, s[8:11], s79 offen sc1
    s_add_u32 s79, s79, 1835008
    s_add_u32 s81, s81, 1
    s_cmp_lt_u32 s81, 16
    s_cbranch_scc1 L_w2loopA
    s_waitcnt vmcnt(0)
    v_mov_b32 v10, 16
    buffer_store_dword v10, v9, s[8:11], 0 offen sc1
    s_barrier
    s_mov_b32 s101, 0
    s_and_b32 s82, s75, 7
    s_lshr_b32 s80, s75, 3
    s_and_b32 s73, s82, 1
    s_lshr_b32 s82, s82, 1
    s_lshl_b32 s72, s82, 2
    s_add_u32 s72, s72, s60
    s_min_u32 s68, s72, 13
    v_mov_b32 v4, 0
    v_bfe_u32 v1, v0, 0, 6
    v_lshl_add_u32 v4, v1, 4, v4
    s_lshr_b32 s65, s68, 1
    v_mov_b32 v16, s65
    v_bfe_u32 v1, v0, 0, 4
    v_mul_u32_u24 v1, 7, v1
    v_add_u32 v16, v16, v1
    v_lshlrev_b32 v13, 7, v16
    v_add_u32 v13, 88307712, v13
    v_add_u32 v16, 112, v16
    v_and_b32 v1, 7, v0
    v_min_u32 v1, 6, v1
    s_mul_i32 s65, s72, 7
    v_add_u32 v1, s65, v1
    v_cmp_gt_u32 vcc, 16, v0
    s_nop 1
    v_cndmask_b32 v1, v1, v16, vcc
    v_lshlrev_b32 v1, 4, v1
    v_add_u32 v5, 88293376, v1
    v_mov_b32 v6, 0
    v_bfe_u32 v1, v0, 4, 2
    v_lshl_add_u32 v6, v1, 7, v6
    v_bfe_u32 v1, v0, 0, 3
    v_lshl_add_u32 v6, v1, 4, v6
    v_add_u32 v7, 4096, v6
    s_lshl_b32 s65, s73, 2
    v_mov_b32 v8, s65
    v_bfe_u32 v1, v0, 2, 2
    v_lshl_add_u32 v8, v1, 3, v8
    v_bfe_u32 v1, v0, 0, 2
    v_lshl_add_u32 v8, v1, 0, v8
    v_lshrrev_b32 v1, 4, v0
    v_lshlrev_b32 v1, 3, v1
    v_sub_u32 v8, v8, v1
    s_mul_i32 s67, s73, 20480
    s_lshl_b32 s65, s72, 10
    s_add_u32 s65, s65, s67
    v_add_u32 v9, s65, v4
    s_lshl_b32 s65, s82, 10
    s_lshl_b32 s66, s60, 8
    s_add_u32 s65, s65, s66
    s_add_u32 s65, s65, s67
    s_add_u32 s65, s65, 16384
    v_mov_b32 v16, s65
    v_bfe_u32 v1, v0, 0, 4
    v_lshl_add_u32 v16, v1, 4, v16
    v_bfe_u32 v1, v0, 4, 1
    v_lshl_add_u32 v16, v1, 3, v16
    v_mov_b32 v2, 2147483632
    v_cmp_gt_u32 vcc, 32, v0
    s_nop 1
    v_cndmask_b32 v10, v2, v16, vcc
    s_mul_i32 s76, s60, 5120
    s_add_u32 s83, s76, s67
    s_lshl_b32 s65, s75, 5
    s_add_u32 s65, s65, s60
    s_lshl_b32 s65, s65, 2
    s_add_u32 s65, s65, 88322048
    v_mov_b32 v1, s65
    v_mov_b32 v2, 2147483632
    v_cmp_eq_u32 vcc, 0, v0
    s_nop 1
    v_cndmask_b32 v11, v2, v1, vcc
    s_andn2_b32 s65, s75, 6
    s_lshl_b32 s65, s65, 7
    s_add_u32 s65, s65, 88322048
    v_mov_b32 v12, s65
    v_bfe_u32 v1, v0, 2, 2
    v_lshl_add_u32 v12, v1, 8, v12
    v_bfe_u32 v1, v0, 0, 2
    v_lshl_add_u32 v12, v1, 2, v12
    s_lshl_b32 s65, s68, 11
    v_add_u32 v60, s65, v4
    s_mul_i32 s65, s73, 7168
    s_lshl_b32 s66, s68, 6
    s_add_u32 s65, s65, s66
    s_add_u32 s65, s65, 896
    s_cmp_lt_u32 s72, 14
    s_cselect_b32 s65, s65, 0x70000000
    v_mov_b32 v61, s65
    v_bfe_u32 v1, v0, 2, 2
    v_mul_u32_u24 v1, 14336, v1
    v_add_u32 v61, v61, v1
    v_bfe_u32 v1, v0, 0, 2
    v_mul_u32_u24 v1, 1792, v1
    v_add_u32 v61, v61, v1
    v_bfe_u32 v1, v0, 4, 2
    v_lshl_add_u32 v61, v1, 4, v61
    v_mov_b32 v14, 0xceabfb8f
    v_mov_b32 v15, 0xff800000
L_ploop:
    s_lshr_b32 s81, s80, 2
    s_add_u32 s81, s81, 1
    s_and_b32 s66, s80, 3
    s_lshl_b32 s66, s66, 2
    s_mov_b32 s69, s66
L_wf_321:
    buffer_load_dword v3, v5, s[8:11], s66 offen sc1
    s_waitcnt vmcnt(0)
    v_cmp_gt_u32 vcc, s81, v3
    s_cbranch_vccnz L_retry_322
    s_mul_i32 s77, s80, 28672
    s_add_u32 s77, s77, 92274688
    s_lshl_b32 s78, s80, 4
    s_add_u32 s78, s78, s72
    s_lshl_b32 s78, s78, 1
    s_add_u32 s78, s78, s73
    s_mul_i32 s78, s78, 14336
    s_add_u32 s78, s78, 46137344
    s_mul_i32 s65, s60, 7168
    s_add_u32 s77, s77, s65
    s_add_u32 s67, s77, 4096
    s_add_u32 m0, s65, 32768
    s_nop 0
    buffer_load_dwordx4 v4, s[8:11], s77 offen offset:0 sc1 lds
    buffer_load_dwordx4 v4, s[8:11], s77 offen offset:1024 sc1 lds
    buffer_load_dwordx4 v4, s[8:11], s77 offen offset:2048 sc1 lds
    buffer_load_dwordx4 v4, s[8:11], s77 offen offset:3072 sc1 lds
    s_add_u32 m0, s65, 36864
    s_nop 0
    buffer_load_dwordx4 v4, s[8:11], s67 offen offset:0 sc1 lds
    buffer_load_dwordx4 v4, s[8:11], s67 offen offset:1024 sc1 lds
    buffer_load_dwordx4 v4, s[8:11], s67 offen offset:2048 sc1 lds
    s_add_u32 s67, s78, 0
    buffer_load_dwordx4 a[112:115], v4, s[8:11], s67 offen offset:0 sc1
    s_add_u32 s67, s78, 0
    buffer_load_dwordx4 a[116:119], v4, s[8:11], s67 offen offset:1024 sc1
    s_add_u32 s67, s78, 0
    buffer_load_dwordx4 a[120:123], v4, s[8:11], s67 offen offset:2048 sc1
    s_add_u32 s67, s78, 0
    buffer_load_dwordx4 a[124:127], v4, s[8:11], s67 offen offset:3072 sc1
    s_add_u32 s67, s78, 4096
    buffer_load_dwordx4 a[128:131], v4, s[8:11], s67 offen offset:0 sc1
    s_add_u32 s67, s78, 4096
    buffer_load_dwordx4 a[132:135], v4, s[8:11], s67 offen offset:1024 sc1
    s_add_u32 s67, s78, 4096
    buffer_load_dwordx4 a[136:139], v4, s[8:11], s67 offen offset:2048 sc1
    s_add_u32 s67, s78, 4096
    buffer_load_dwordx4 a[140:143], v4, s[8:11], s67 offen offset:3072 sc1
    s_add_u32 s67, s78, 8192
    buffer_load_dwordx4 a[144:147], v4, s[8:11], s67 offen offset:0 sc1
    s_add_u32 s67, s78, 8192
    buffer_load_dwordx4 a[148:151], v4, s[8:11], s67 offen offset:1024 sc1
    s_add_u32 s67, s78, 8192
    buffer_load_dwordx4 a[152:155], v4, s[8:11], s67 offen offset:2048 sc1
    s_add_u32 s67, s78, 8192
    buffer_load_dwordx4 a[156:159], v4, s[8:11], s67 offen offset:3072 sc1
    s_add_u32 s67, s78, 12288
    buffer_load_dwordx4 a[160:163], v4, s[8:11], s67 offen offset:0 sc1
    s_add_u32 s67, s78, 12288
    buffer_load_dwordx4 a[164:167], v4, s[8:11], s67 offen offset:1024 sc1
    s_mul_i32 s77, s80, 458752
    s_add_u32 s77, s77, 16777216
    buffer_load_dwordx4 v[128:131], v60, s[8:11], s77 offen offset:0 sc1
    buffer_load_dwordx4 v[132:135], v60, s[8:11], s77 offen offset:1024 sc1
    s_add_u32 s77, s77, 28672
    buffer_load_dwordx4 v[136:139], v60, s[8:11], s77 offen offset:0 sc1
    buffer_load_dwordx4 v[140:143], v60, s[8:11], s77 offen offset:1024 sc1
    s_add_u32 s77, s77, 28672
    buffer_load_dwordx4 v[144:147], v60, s[8:11], s77 offen offset:0 sc1
    buffer_load_dwordx4 v[148:151], v60, s[8:11], s77 offen offset:1024 sc1
    s_add_u32 s77, s77, 28672
    buffer_load_dwordx4 v[152:155], v60, s[8:11], s77 offen offset:0 sc1
    buffer_load_dwordx4 v[156:159], v60, s[8:11], s77 offen offset:1024 sc1
    s_add_u32 s77, s77, 28672
    buffer_load_dwordx4 v[160:163], v60, s[8:11], s77 offen offset:0 sc1
    buffer_load_dwordx4 v[164:167], v60, s[8:11], s77 offen offset:1024 sc1
    s_add_u32 s77, s77, 28672
    buffer_load_dwordx4 v[168:171], v60, s[8:11], s77 offen offset:0 sc1
    buffer_load_dwordx4 v[172:175], v60, s[8:11], s77 offen offset:1024 sc1
    s_add_u32 s77, s77, 28672
    buffer_load_dwordx4 v[176:179], v60, s[8:11], s77 offen offset:0 sc1
    buffer_load_dwordx4 v[180:183], v60, s[8:11], s77 offen offset:1024 sc1
    s_add_u32 s77, s77, 28672
    buffer_load_dwordx4 v[184:187], v60, s[8:11], s77 offen offset:0 sc1
    buffer_load_dwordx4 v[188:191], v60, s[8:11], s77 offen offset:1024 sc1
    s_add_u32 s77, s77, 28672
    buffer_load_dwordx4 v[192:195], v60, s[8:11], s77 offen offset:0 sc1
    buffer_load_dwordx4 v[196:199], v60, s[8:11], s77 offen offset:1024 sc1
    s_add_u32 s77, s77, 28672
    buffer_load_dwordx4 v[200:203], v60, s[8:11], s77 offen offset:0 sc1
    buffer_load_dwordx4 v[204:207], v60, s[8:11], s77 offen offset:1024 sc1
    s_add_u32 s77, s77, 28672
    buffer_load_dwordx4 v[208:211], v60, s[8:11], s77 offen offset:0 sc1
    buffer_load_dwordx4 v[212:215], v60, s[8:11], s77 offen offset:1024 sc1
    s_add_u32 s77, s77, 28672
    buffer_load_dwordx4 v[216:219], v60, s[8:11], s77 offen offset:0 sc1
    buffer_load_dwordx4 v[220:223], v60, s[8:11], s77 offen offset:1024 sc1
    s_add_u32 s77, s77, 28672
    buffer_load_dwordx4 v[224:227], v60, s[8:11], s77 offen offset:0 sc1
    buffer_load_dwordx4 v[228:231], v60, s[8:11], s77 offen offset:1024 sc1
    s_add_u32 s77, s77, 28672
    buffer_load_dwordx4 v[232:235], v60, s[8:11], s77 offen offset:0 sc1
    buffer_load_dwordx4 v[236:239], v60, s[8:11], s77 offen offset:1024 sc1
    s_add_u32 s77, s77, 28672
    s_waitcnt vmcnt(42)
    s_barrier
    ds_read_b128 a[0:3], v4 offset:32768
    ds_read_b128 a[4:7], v4 offset:33792
    ds_read_b128 a[8:11], v4 offset:34816
    ds_read_b128 a[12:15], v4 offset:35840
    ds_read_b128 a[16:19], v4 offset:36864
    ds_read_b128 a[20:23], v4 offset:37888
    ds_read_b128 a[24:27], v4 offset:38912
    s_waitcnt lgkmcnt(7)
    ds_read_b128 a[28:31], v4 offset:39936
    ds_read_b128 a[32:35], v4 offset:40960
    ds_read_b128 a[36:39], v4 offset:41984
    ds_read_b128 a[40:43], v4 offset:43008
    ds_read_b128 a[44:47], v4 offset:44032
    ds_read_b128 a[48:51], v4 offset:45056
    ds_read_b128 a[52:55], v4 offset:46080
    s_waitcnt lgkmcnt(7)
    ds_read_b128 a[56:59], v4 offset:47104
    ds_read_b128 a[60:63], v4 offset:48128
    ds_read_b128 a[64:67], v4 offset:49152
    ds_read_b128 a[68:71], v4 offset:50176
    ds_read_b128 a[72:75], v4 offset:51200
    ds_read_b128 a[76:79], v4 offset:52224
    ds_read_b128 a[80:83], v4 offset:53248
    s_waitcnt lgkmcnt(7)
    ds_read_b128 a[84:87], v4 offset:54272
    ds_read_b128 a[88:91], v4 offset:55296
    ds_read_b128 a[92:95], v4 offset:56320
    ds_read_b128 a[96:99], v4 offset:57344
    ds_read_b128 a[100:103], v4 offset:58368
    ds_read_b128 a[104:107], v4 offset:59392
    ds_read_b128 a[108:111], v4 offset:60416
    s_waitcnt lgkmcnt(7)
    s_waitcnt vmcnt(28) lgkmcnt(0)
    v_mfma_f32_16x16x32_bf16 v[16:19], a[0:3], a[112:115], 0
    v_mfma_f32_16x16x32_bf16 v[20:23], a[56:59], a[112:115], 0
    v_mfma_f32_16x16x32_bf16 v[16:19], a[4:7], a[116:119], v[16:19]
    v_mfma_f32_16x16x32_bf16 v[20:23], a[60:63], a[116:119], v[20:23]
    v_mfma_f32_16x16x32_bf16 v[16:19], a[8:11], a[120:123], v[16:19]
    v_mfma_f32_16x16x32_bf16 v[20:23], a[64:67], a[120:123], v[20:23]
    v_mfma_f32_16x16x32_bf16 v[16:19], a[12:15], a[124:127], v[16:19]
    v_mfma_f32_16x16x32_bf16 v[20:23], a[68:71], a[124:127], v[20:23]
    v_mfma_f32_16x16x32_bf16 v[16:19], a[16:19], a[128:131], v[16:19]
    v_mfma_f32_16x16x32_bf16 v[20:23], a[72:75], a[128:131], v[20:23]
    v_mfma_f32_16x16x32_bf16 v[16:19], a[20:23], a[132:135], v[16:19]
    v_mfma_f32_16x16x32_bf16 v[20:23], a[76:79], a[132:135], v[20:23]
    v_mfma_f32_16x16x32_bf16 v[16:19], a[24:27], a[136:139], v[16:19]
    v_mfma_f32_16x16x32_bf16 v[20:23], a[80:83], a[136:139], v[20:23]
    v_mfma_f32_16x16x32_bf16 v[16:19], a[28:31], a[140:143], v[16:19]
    v_mfma_f32_16x16x32_bf16 v[20:23], a[84:87], a[140:143], v[20:23]
    v_mfma_f32_16x16x32_bf16 v[16:19], a[32:35], a[144:147], v[16:19]
    v_mfma_f32_16x16x32_bf16 v[20:23], a[88:91], a[144:147], v[20:23]
    v_mfma_f32_16x16x32_bf16 v[16:19], a[36:39], a[148:151], v[16:19]
    v_mfma_f32_16x16x32_bf16 v[20:23], a[92:95], a[148:151], v[20:23]
    v_mfma_f32_16x16x32_bf16 v[16:19], a[40:43], a[152:155], v[16:19]
    v_mfma_f32_16x16x32_bf16 v[20:23], a[96:99], a[152:155], v[20:23]
    v_mfma_f32_16x16x32_bf16 v[16:19], a[44:47], a[156:159], v[16:19]
    v_mfma_f32_16x16x32_bf16 v[20:23], a[100:103], a[156:159], v[20:23]
    v_mfma_f32_16x16x32_bf16 v[16:19], a[48:51], a[160:163], v[16:19]
    v_mfma_f32_16x16x32_bf16 v[20:23], a[104:107], a[160:163], v[20:23]
    v_mfma_f32_16x16x32_bf16 v[16:19], a[52:55], a[164:167], v[16:19]
    v_mfma_f32_16x16x32_bf16 v[20:23], a[108:111], a[164:167], v[20:23]
    buffer_load_dwordx4 v[240:243], v60, s[8:11], s77 offen offset:0 sc1
    buffer_load_dwordx4 v[244:247], v60, s[8:11], s77 offen offset:1024 sc1
    s_add_u32 s77, s77, 28672
    buffer_load_dwordx4 v[248:251], v60, s[8:11], s77 offen offset:0 sc1
    buffer_load_dwordx4 v[252:255], v60, s[8:11], s77 offen offset:1024 sc1
    s_add_u32 s77, s77, 28672
    v_cmp_le_i32 vcc, 0, v8
    s_nop 1
    v_cndmask_b32 v16, v14, v16, vcc
    v_cmp_le_i32 vcc, 1, v8
    s_nop 1
    v_cndmask_b32 v17, v14, v17, vcc
    v_cmp_le_i32 vcc, 2, v8
    s_nop 1
    v_cndmask_b32 v18, v14, v18, vcc
    v_cmp_le_i32 vcc, 3, v8
    s_nop 1
    v_cndmask_b32 v19, v14, v19, vcc
    v_cmp_le_i32 vcc, 4, v8
    s_nop 1
    v_cndmask_b32 v20, v14, v20, vcc
    v_cmp_le_i32 vcc, 5, v8
    s_nop 1
    v_cndmask_b32 v21, v14, v21, vcc
    v_cmp_le_i32 vcc, 6, v8
    s_nop 1
    v_cndmask_b32 v22, v14, v22, vcc
    v_cmp_le_i32 vcc, 7, v8
    s_nop 1
    v_cndmask_b32 v23, v14, v23, vcc
    v_max3_f32 v40, v16, v17, v18
    v_max3_f32 v40, v40, v19, v20
    v_max3_f32 v40, v40, v21, v22
    v_max_f32 v40, v40, v23
    s_mul_i32 s77, s80, 7168
    s_add_u32 s77, s77, 82837504
    s_and_b32 s79, s101, 1
    s_lshr_b32 s65, s75, 3
    s_lshl_b32 s65, s65, 1
    s_add_u32 s79, s79, s65
    s_mul_i32 s79, s79, 40960
    s_add_u32 s79, s79, 83886080
    buffer_load_dword v36, v9, s[8:11], s79 offen sc1
    buffer_load_dword v36, v10, s[8:11], s79 offen sc1
    v_add_u32 v62, s69, v13
    s_cmp_lg_u32 s80, 63
    s_cbranch_scc1 L_pz63
    s_min_u32 s65, s72, 13
    s_lshl_b32 s65, s65, 9
    s_add_u32 s65, s65, 88277024
    v_mov_b32 v62, s65
    v_bfe_u32 v1, v0, 0, 2
    v_lshl_add_u32 v62, v1, 7, v62
L_pz63:
    v_and_b32 v1, 16, v0
    v_cmp_eq_u32 vcc, 0, v1
    s_nop 1
    v_cndmask_b32 v62, v12, v62, vcc
    s_add_u32 s65, s101, 1
    v_mov_b32 v63, s81
    v_mov_b32 v1, s65
    v_cndmask_b32 v63, v1, v63, vcc
    s_sub_u32 s67, s77, 7168
    s_cmp_ge_u32 s80, 62
    s_cselect_b32 s67, s67, s77
L_hm_323:
    buffer_load_dword v3, v7, s[8:11], s67 offen offset:2560 sc1
    s_waitcnt vmcnt(0)
    v_cmp_eq_u32 vcc, -1, v3
    s_cbranch_vccnz L_retry_326
L_hm2_324:
    buffer_load_dwordx4 v[64:67], v6, s[8:11], s77 offen offset:0 sc1
    buffer_load_dwordx4 v[68:71], v6, s[8:11], s77 offen offset:512 sc1
    buffer_load_dwordx4 v[72:75], v6, s[8:11], s77 offen offset:1024 sc1
    buffer_load_dwordx4 v[76:79], v6, s[8:11], s77 offen offset:1536 sc1
    buffer_load_dwordx4 v[80:83], v6, s[8:11], s77 offen offset:2048 sc1
    buffer_load_dwordx4 v[84:87], v6, s[8:11], s77 offen offset:2560 sc1
    buffer_load_dwordx4 v[88:91], v6, s[8:11], s77 offen offset:3072 sc1
    buffer_load_dwordx4 v[92:95], v6, s[8:11], s77 offen offset:3584 sc1
    buffer_load_dwordx4 v[96:99], v7, s[8:11], s77 offen offset:0 sc1
    buffer_load_dwordx4 v[100:103], v7, s[8:11], s77 offen offset:512 sc1
    buffer_load_dwordx4 v[104:107], v7, s[8:11], s77 offen offset:1024 sc1
    buffer_load_dwordx4 v[108:111], v7, s[8:11], s77 offen offset:1536 sc1
    buffer_load_dwordx4 v[112:115], v7, s[8:11], s77 offen offset:2048 sc1
    buffer_load_dwordx4 v[116:119], v7, s[8:11], s77 offen offset:2560 sc1
    s_waitcnt vmcnt(13)
    v_cmp_eq_u32 vcc, -1, v64
    s_cbranch_vccnz L_retry_327
    s_waitcnt vmcnt(13)
    v_mfma_f32_16x16x32_bf16 v[24:27], v[64:67], a[112:115], 0
    v_max_u32 v3, v64, v65
    v_max3_u32 v3, v3, v66, v67
    s_waitcnt vmcnt(12)
    v_mfma_f32_16x16x32_bf16 v[24:27], v[68:71], a[116:119], v[24:27]
    v_max3_u32 v3, v3, v68, v69
    v_max3_u32 v3, v3, v70, v71
    s_waitcnt vmcnt(11)
    v_mfma_f32_16x16x32_bf16 v[24:27], v[72:75], a[120:123], v[24:27]
    v_max3_u32 v3, v3, v72, v73
    v_max3_u32 v3, v3, v74, v75
    s_waitcnt vmcnt(10)
    v_mfma_f32_16x16x32_bf16 v[24:27], v[76:79], a[124:127], v[24:27]
    v_max3_u32 v3, v3, v76, v77
    v_max3_u32 v3, v3, v78, v79
    s_waitcnt vmcnt(9)
    v_mfma_f32_16x16x32_bf16 v[24:27], v[80:83], a[128:131], v[24:27]
    v_max3_u32 v3, v3, v80, v81
    v_max3_u32 v3, v3, v82, v83
    s_waitcnt vmcnt(8)
    v_mfma_f32_16x16x32_bf16 v[24:27], v[84:87], a[132:135], v[24:27]
    v_max3_u32 v3, v3, v84, v85
    v_max3_u32 v3, v3, v86, v87
    s_waitcnt vmcnt(7)
    v_mfma_f32_16x16x32_bf16 v[24:27], v[88:91], a[136:139], v[24:27]
    v_max3_u32 v3, v3, v88, v89
    v_max3_u32 v3, v3, v90, v91
    s_waitcnt vmcnt(6)
    v_mfma_f32_16x16x32_bf16 v[24:27], v[92:95], a[140:143], v[24:27]
    v_max3_u32 v3, v3, v92, v93
    v_max3_u32 v3, v3, v94, v95
    s_waitcnt vmcnt(5)
    v_mfma_f32_16x16x32_bf16 v[24:27], v[96:99], a[144:147], v[24:27]
    v_max3_u32 v3, v3, v96, v97
    v_max3_u32 v3, v3, v98, v99
    s_waitcnt vmcnt(4)
    v_mfma_f32_16x16x32_bf16 v[24:27], v[100:103], a[148:151], v[24:27]
    v_max3_u32 v3, v3, v100, v101
    v_max3_u32 v3, v3, v102, v103
    s_waitcnt vmcnt(3)
    v_mfma_f32_16x16x32_bf16 v[24:27], v[104:107], a[152:155], v[24:27]
    v_max3_u32 v3, v3, v104, v105
    v_max3_u32 v3, v3, v106, v107
    s_waitcnt vmcnt(2)
    v_mfma_f32_16x16x32_bf16 v[24:27], v[108:111], a[156:159], v[24:27]
    v_max3_u32 v3, v3, v108, v109
    v_max3_u32 v3, v3, v110, v111
    s_waitcnt vmcnt(1)
    v_mfma_f32_16x16x32_bf16 v[24:27], v[112:115], a[160:163], v[24:27]
    v_max3_u32 v3, v3, v112, v113
    v_max3_u32 v3, v3, v114, v115
    s_waitcnt vmcnt(0)
    v_mfma_f32_16x16x32_bf16 v[24:27], v[116:119], a[164:167], v[24:27]
    v_max3_u32 v3, v3, v116, v117
    v_max3_u32 v3, v3, v118, v119
    v_cmp_eq_u32 vcc, -1, v3
    s_cbranch_vccnz L_retry_328
    v_cmp_gt_u32 vcc, 32, v0
    s_nop 2
    v_cndmask_b32 v24, v15, v24, vcc
    v_cndmask_b32 v25, v15, v25, vcc
    v_cndmask_b32 v26, v15, v26, vcc
    v_cndmask_b32 v27, v15, v27, vcc
    v_max3_f32 v40, v40, v24, v25
    v_max3_f32 v40, v40, v26, v27
    v_mov_b32 v41, v40
    s_nop 1
    v_permlane16_swap_b32 v40, v41
    v_max_f32 v40, v40, v41
    v_mov_b32 v41, v40
    s_nop 1
    v_permlane32_swap_b32 v40, v41
    v_max_f32 v40, v40, v41
    v_sub_f32 v16, v16, v40
    v_sub_f32 v17, v17, v40
    v_sub_f32 v18, v18, v40
    v_sub_f32 v19, v19, v40
    v_sub_f32 v20, v20, v40
    v_sub_f32 v21, v21, v40
    v_sub_f32 v22, v22, v40
    v_sub_f32 v23, v23, v40
    v_sub_f32 v24, v24, v40
    v_sub_f32 v25, v25, v40
    v_sub_f32 v26, v26, v40
    v_sub_f32 v27, v27, v40
    v_exp_f32 v16, v16
    v_exp_f32 v17, v17
    v_exp_f32 v18, v18
    v_exp_f32 v19, v19
    v_exp_f32 v20, v20
    v_exp_f32 v21, v21
    v_exp_f32 v22, v22
    v_exp_f32 v23, v23
    v_exp_f32 v24, v24
    v_exp_f32 v25, v25
    v_exp_f32 v26, v26
    v_exp_f32 v27, v27
    v_pk_add_f32 v[42:43], v[16:17], v[18:19]
    v_pk_add_f32 v[42:43], v[42:43], v[20:21]
    v_pk_add_f32 v[42:43], v[42:43], v[22:23]
    v_pk_add_f32 v[42:43], v[42:43], v[24:25]
    v_pk_add_f32 v[42:43], v[42:43], v[26:27]
    v_add_f32 v40, v42, v43
    v_mov_b32 v41, v40
    s_nop 1
    v_permlane16_swap_b32 v40, v41
    v_add_f32 v40, v40, v41
    v_mov_b32 v41, v40
    s_nop 1
    v_permlane32_swap_b32 v40, v41
    v_add_f32 v40, v40, v41
    v_rcp_f32 v40, v40
    s_nop 0
    v_pk_mul_f32 v[16:17], v[16:17], v[40:41] op_sel_hi:[1,0]
    v_cvt_pk_bf16_f32 v44, v16, v17
    v_pk_mul_f32 v[18:19], v[18:19], v[40:41] op_sel_hi:[1,0]
    v_cvt_pk_bf16_f32 v45, v18, v19
    v_pk_mul_f32 v[20:21], v[20:21], v[40:41] op_sel_hi:[1,0]
    v_cvt_pk_bf16_f32 v46, v20, v21
    v_pk_mul_f32 v[22:23], v[22:23], v[40:41] op_sel_hi:[1,0]
    v_cvt_pk_bf16_f32 v47, v22, v23
    v_pk_mul_f32 v[24:25], v[24:25], v[40:41] op_sel_hi:[1,0]
    v_cvt_pk_bf16_f32 v48, v24, v25
    v_pk_mul_f32 v[26:27], v[26:27], v[40:41] op_sel_hi:[1,0]
    v_cvt_pk_bf16_f32 v49, v26, v27
    buffer_store_dwordx4 v[44:47], v9, s[8:11], s79 offen
    buffer_store_dwordx2 v[48:49], v10, s[8:11], s79 offen
    s_add_u32 s101, s101, 1
    v_mov_b32 v3, s101
    s_add_u32 s79, s79, s83
    s_add_u32 s78, s79, 4096
    s_mul_i32 s77, s80, 114688
    s_add_u32 s77, s77, 75497472
    s_waitcnt vmcnt(0)
    buffer_store_dword v3, v11, s[8:11], 0 offen
L_pp:
    buffer_load_dword v3, v62, s[8:11], 0 offen sc1
    s_waitcnt vmcnt(0)
    v_cmp_gt_u32 vcc, v63, v3
    s_nop 0
    s_and_b32 s68, vcc_lo, 0xffff
    s_lshr_b32 vcc_lo, vcc_lo, 16
    s_mov_b32 vcc_hi, 0
    s_cmp_lg_u32 vcc_lo, 0
    s_cbranch_scc1 L_pp_r
    s_mov_b32 m0, s76
    s_nop 0
    buffer_load_dwordx4 v4, s[8:11], s79 offen offset:0 sc1 lds
    buffer_load_dwordx4 v4, s[8:11], s79 offen offset:1024 sc1 lds
    buffer_load_dwordx4 v4, s[8:11], s79 offen offset:2048 sc1 lds
    buffer_load_dwordx4 v4, s[8:11], s79 offen offset:3072 sc1 lds
    s_add_u32 m0, s76, 4096
    s_nop 0
    buffer_load_dwordx4 v4, s[8:11], s78 offen sc1 lds
    s_cmp_lg_u32 s68, 0
    s_cbranch_scc1 L_pz0
    buffer_load_dwordx4 a[168:171], v60, s[8:11], s77 offen offset:0 sc1
    buffer_load_dwordx4 a[172:175], v60, s[8:11], s77 offen offset:1024 sc1
    s_add_u32 s77, s77, 28672
    buffer_load_dwordx4 a[176:179], v60, s[8:11], s77 offen offset:0 sc1
    buffer_load_dwordx4 a[180:183], v60, s[8:11], s77 offen offset:1024 sc1
    s_add_u32 s77, s77, 28672
    buffer_load_dwordx4 a[184:187], v60, s[8:11], s77 offen offset:0 sc1
    buffer_load_dwordx4 a[188:191], v60, s[8:11], s77 offen offset:1024 sc1
    s_add_u32 s77, s77, 28672
    buffer_load_dwordx4 a[192:195], v60, s[8:11], s77 offen offset:0 sc1
    buffer_load_dwordx4 a[196:199], v60, s[8:11], s77 offen offset:1024 sc1
    s_waitcnt vmcnt(8)
    s_barrier
    s_branch L_pz2
L_pz0:
    buffer_load_dword v3, v62, s[8:11], 0 offen sc1
    s_waitcnt vmcnt(1)
    s_barrier
    s_waitcnt vmcnt(0)
L_pz:
    v_cmp_gt_u32 vcc, v63, v3
    s_cbranch_vccnz L_retry_330
    buffer_load_dwordx4 a[168:171], v60, s[8:11], s77 offen offset:0 sc1
    buffer_load_dwordx4 a[172:175], v60, s[8:11], s77 offen offset:1024 sc1
    s_add_u32 s77, s77, 28672
    buffer_load_dwordx4 a[176:179], v60, s[8:11], s77 offen offset:0 sc1
    buffer_load_dwordx4 a[180:183], v60, s[8:11], s77 offen offset:1024 sc1
    s_add_u32 s77, s77, 28672
    buffer_load_dwordx4 a[184:187], v60, s[8:11], s77 offen offset:0 sc1
    buffer_load_dwordx4 a[188:191], v60, s[8:11], s77 offen offset:1024 sc1
    s_add_u32 s77, s77, 28672
    buffer_load_dwordx4 a[192:195], v60, s[8:11], s77 offen offset:0 sc1
    buffer_load_dwordx4 a[196:199], v60, s[8:11], s77 offen offset:1024 sc1
L_pz2:
    ds_read_b128 v[64:67], v4 offset:0
    ds_read_b128 v[68:71], v4 offset:1024
    ds_read_b128 v[72:75], v4 offset:2048
    ds_read_b128 v[76:79], v4 offset:3072
    ds_read_b128 v[80:83], v4 offset:4096
    ds_read_b128 v[84:87], v4 offset:5120
    ds_read_b128 v[88:91], v4 offset:6144
    ds_read_b128 v[92:95], v4 offset:7168
    ds_read_b128 v[96:99], v4 offset:8192
    ds_read_b128 v[100:103], v4 offset:9216
    s_waitcnt lgkmcnt(9)
    v_mfma_f32_16x16x32_bf16 v[16:19], v[128:131], v[64:67], 0
    v_mfma_f32_16x16x32_bf16 v[20:23], v[132:135], v[64:67], 0
    ds_read_b128 v[104:107], v4 offset:10240
    s_waitcnt lgkmcnt(9)
    v_mfma_f32_16x16x32_bf16 v[16:19], v[136:139], v[68:71], v[16:19]
    v_mfma_f32_16x16x32_bf16 v[20:23], v[140:143], v[68:71], v[20:23]
    ds_read_b128 v[108:111], v4 offset:11264
    s_waitcnt lgkmcnt(9)
    v_mfma_f32_16x16x32_bf16 v[16:19], v[144:147], v[72:75], v[16:19]
    v_mfma_f32_16x16x32_bf16 v[20:23], v[148:151], v[72:75], v[20:23]
    ds_read_b128 v[64:67], v4 offset:12288
    s_waitcnt lgkmcnt(9)
    v_mfma_f32_16x16x32_bf16 v[16:19], v[152:155], v[76:79], v[16:19]
    v_mfma_f32_16x16x32_bf16 v[20:23], v[156:159], v[76:79], v[20:23]
    ds_read_b128 v[68:71], v4 offset:13312
    s_waitcnt lgkmcnt(9)
    v_mfma_f32_16x16x32_bf16 v[16:19], v[160:163], v[80:83], v[16:19]
    v_mfma_f32_16x16x32_bf16 v[20:23], v[164:167], v[80:83], v[20:23]
    ds_read_b128 v[72:75], v4 offset:14336
    s_waitcnt lgkmcnt(9)
    v_mfma_f32_16x16x32_bf16 v[16:19], v[168:171], v[84:87], v[16:19]
    v_mfma_f32_16x16x32_bf16 v[20:23], v[172:175], v[84:87], v[20:23]
    ds_read_b128 v[76:79], v4 offset:15360
    s_waitcnt lgkmcnt(9)
    v_mfma_f32_16x16x32_bf16 v[16:19], v[176:179], v[88:91], v[16:19]
    v_mfma_f32_16x16x32_bf16 v[20:23], v[180:183], v[88:91], v[20:23]
    ds_read_b128 v[80:83], v4 offset:16384
    s_waitcnt lgkmcnt(9)
    v_mfma_f32_16x16x32_bf16 v[16:19], v[184:187], v[92:95], v[16:19]
    v_mfma_f32_16x16x32_bf16 v[20:23], v[188:191], v[92:95], v[20:23]
    ds_read_b128 v[84:87], v4 offset:17408
    s_waitcnt lgkmcnt(9)
    v_mfma_f32_16x16x32_bf16 v[16:19], v[192:195], v[96:99], v[16:19]
    v_mfma_f32_16x16x32_bf16 v[20:23], v[196:199], v[96:99], v[20:23]
    ds_read_b128 v[88:91], v4 offset:18432
    s_waitcnt lgkmcnt(9)
    v_mfma_f32_16x16x32_bf16 v[16:19], v[200:203], v[100:103], v[16:19]
    v_mfma_f32_16x16x32_bf16 v[20:23], v[204:207], v[100:103], v[20:23]
    ds_read_b128 v[92:95], v4 offset:19456
    s_waitcnt lgkmcnt(9)
    v_mfma_f32_16x16x32_bf16 v[16:19], v[208:211], v[104:107], v[16:19]
    v_mfma_f32_16x16x32_bf16 v[20:23], v[212:215], v[104:107], v[20:23]
    s_waitcnt lgkmcnt(8)
    v_mfma_f32_16x16x32_bf16 v[16:19], v[216:219], v[108:111], v[16:19]
    v_mfma_f32_16x16x32_bf16 v[20:23], v[220:223], v[108:111], v[20:23]
    s_waitcnt lgkmcnt(7)
    v_mfma_f32_16x16x32_bf16 v[16:19], v[224:227], v[64:67], v[16:19]
    v_mfma_f32_16x16x32_bf16 v[20:23], v[228:231], v[64:67], v[20:23]
    s_waitcnt lgkmcnt(6)
    v_mfma_f32_16x16x32_bf16 v[16:19], v[232:235], v[68:71], v[16:19]
    v_mfma_f32_16x16x32_bf16 v[20:23], v[236:239], v[68:71], v[20:23]
    s_waitcnt lgkmcnt(5)
    v_mfma_f32_16x16x32_bf16 v[16:19], v[240:243], v[72:75], v[16:19]
    v_mfma_f32_16x16x32_bf16 v[20:23], v[244:247], v[72:75], v[20:23]
    s_waitcnt lgkmcnt(4)
    v_mfma_f32_16x16x32_bf16 v[16:19], v[248:251], v[76:79], v[16:19]
    v_mfma_f32_16x16x32_bf16 v[20:23], v[252:255], v[76:79], v[20:23]
    s_waitcnt vmcnt(6)
    s_waitcnt lgkmcnt(3)
    v_mfma_f32_16x16x32_bf16 v[16:19], a[168:171], v[80:83], v[16:19]
    v_mfma_f32_16x16x32_bf16 v[20:23], a[172:175], v[80:83], v[20:23]
    s_waitcnt vmcnt(4)
    s_waitcnt lgkmcnt(2)
    v_mfma_f32_16x16x32_bf16 v[16:19], a[176:179], v[84:87], v[16:19]
    v_mfma_f32_16x16x32_bf16 v[20:23], a[180:183], v[84:87], v[20:23]
    s_waitcnt vmcnt(2)
    s_waitcnt lgkmcnt(1)
    v_mfma_f32_16x16x32_bf16 v[16:19], a[184:187], v[88:91], v[16:19]
    v_mfma_f32_16x16x32_bf16 v[20:23], a[188:191], v[88:91], v[20:23]
    s_waitcnt vmcnt(0)
    s_waitcnt lgkmcnt(0)
    v_mfma_f32_16x16x32_bf16 v[16:19], a[192:195], v[92:95], v[16:19]
    v_mfma_f32_16x16x32_bf16 v[20:23], a[196:199], v[92:95], v[20:23]
    s_mul_i32 s77, s80, 57344
    s_nop 6
    v_cvt_pk_bf16_f32 v32, v16, v20
    v_cvt_pk_bf16_f32 v33, v17, v21
    v_cvt_pk_bf16_f32 v34, v18, v22
    v_cvt_pk_bf16_f32 v35, v19, v23
    buffer_store_dwordx4 v[32:35], v61, s[24:27], s77 offen
    s_add_u32 s80, s80, 14
    s_cmp_lt_u32 s80, 64
    s_cbranch_scc1 L_ploop
    s_branch L_exit
L_w2B:
    v_mov_b32 v8, 0
    v_bfe_u32 v1, v0, 0, 6
    v_lshl_add_u32 v8, v1, 4, v8
    s_lshl_b32 s65, s75, 2
    s_add_u32 s65, s65, s60
    s_lshl_b32 s65, s65, 2
    s_add_u32 s65, s65, 88295168
    v_mov_b32 v1, s65
    v_mov_b32 v2, 2147483632
    v_cmp_eq_u32 vcc, 0, v0
    s_nop 1
    v_cndmask_b32 v9, v2, v1, vcc
    s_mul_i32 s77, s60, 28672
    s_add_u32 s77, s77, 92274688
    s_mul_i32 s65, s60, 458752
    s_add_u32 s79, s79, s65
    s_mov_b32 s81, 0
    s_add_u32 s67, s77, 0
    buffer_load_dwordx4 v[64:67], v8, s[8:11], s67 offen offset:0 sc1
    ds_read_b128 a[0:3], v12 offset:0
    ds_read_b128 a[56:59], v13 offset:0
    s_add_u32 s67, s77, 12288
    buffer_load_dwordx4 v[120:123], v8, s[8:11], s67 offen offset:2048 sc1
    ds_read_b128 a[112:115], v14 offset:0
    ds_read_b128 a[168:171], v15 offset:0
    s_add_u32 s67, s77, 0
    buffer_load_dwordx4 v[68:71], v8, s[8:11], s67 offen offset:1024 sc1
    ds_read_b128 a[4:7], v12 offset:64
    ds_read_b128 a[60:63], v13 offset:64
    s_add_u32 s67, s77, 12288
    buffer_load_dwordx4 v[124:127], v8, s[8:11], s67 offen offset:3072 sc1
    ds_read_b128 a[116:119], v14 offset:64
    ds_read_b128 a[172:175], v15 offset:64
    s_waitcnt lgkmcnt(6)
    buffer_store_dword v1, v2, s[8:11], 0 offen
    s_add_u32 s67, s77, 0
    buffer_load_dwordx4 v[72:75], v8, s[8:11], s67 offen offset:2048 sc1
    ds_read_b128 a[8:11], v12 offset:128
    ds_read_b128 a[64:67], v13 offset:128
    s_add_u32 s67, s77, 16384
    buffer_load_dwordx4 v[128:131], v8, s[8:11], s67 offen offset:0 sc1
    ds_read_b128 a[120:123], v14 offset:128
    ds_read_b128 a[176:179], v15 offset:128
    s_add_u32 s67, s77, 0
    buffer_load_dwordx4 v[76:79], v8, s[8:11], s67 offen offset:3072 sc1
    ds_read_b128 a[12:15], v12 offset:192
    ds_read_b128 a[68:71], v13 offset:192
    s_add_u32 s67, s77, 16384
    buffer_load_dwordx4 v[132:135], v8, s[8:11], s67 offen offset:1024 sc1
    ds_read_b128 a[124:127], v14 offset:192
    ds_read_b128 a[180:183], v15 offset:192
    s_waitcnt lgkmcnt(6)
    s_add_u32 s67, s77, 4096
    buffer_load_dwordx4 v[80:83], v8, s[8:11], s67 offen offset:0 sc1
    ds_read_b128 a[16:19], v12 offset:256
    ds_read_b128 a[72:75], v13 offset:256
    s_add_u32 s67, s77, 16384
    buffer_load_dwordx4 v[136:139], v8, s[8:11], s67 offen offset:2048 sc1
    ds_read_b128 a[128:131], v14 offset:256
    ds_read_b128 a[184:187], v15 offset:256
    s_add_u32 s67, s77, 4096
    buffer_load_dwordx4 v[84:87], v8, s[8:11], s67 offen offset:1024 sc1
    ds_read_b128 a[20:23], v12 offset:320
    ds_read_b128 a[76:79], v13 offset:320
    s_add_u32 s67, s77, 16384
    buffer_load_dwordx4 v[140:143], v8, s[8:11], s67 offen offset:3072 sc1
    ds_read_b128 a[132:135], v14 offset:320
    ds_read_b128 a[188:191], v15 offset:320
    s_waitcnt lgkmcnt(6)
    s_add_u32 s67, s77, 4096
    buffer_load_dwordx4 v[88:91], v8, s[8:11], s67 offen offset:2048 sc1
    ds_read_b128 a[24:27], v12 offset:384
    ds_read_b128 a[80:83], v13 offset:384
    s_add_u32 s67, s77, 20480
    buffer_load_dwordx4 v[144:147], v8, s[8:11], s67 offen offset:0 sc1
    ds_read_b128 a[136:139], v14 offset:384
    ds_read_b128 a[192:195], v15 offset:384
    s_add_u32 s67, s77, 4096
    buffer_load_dwordx4 v[92:95], v8, s[8:11], s67 offen offset:3072 sc1
    ds_read_b128 a[28:31], v12 offset:448
    ds_read_b128 a[84:87], v13 offset:448
    s_add_u32 s67, s77, 20480
    buffer_load_dwordx4 v[148:151], v8, s[8:11], s67 offen offset:1024 sc1
    ds_read_b128 a[140:143], v14 offset:448
    ds_read_b128 a[196:199], v15 offset:448
    s_waitcnt lgkmcnt(6)
    s_add_u32 s67, s77, 8192
    buffer_load_dwordx4 v[96:99], v8, s[8:11], s67 offen offset:0 sc1
    ds_read_b128 a[32:35], v12 offset:512
    ds_read_b128 a[88:91], v13 offset:512
    s_add_u32 s67, s77, 20480
    buffer_load_dwordx4 v[152:155], v8, s[8:11], s67 offen offset:2048 sc1
    ds_read_b128 a[144:147], v14 offset:512
    ds_read_b128 a[200:203], v15 offset:512
    s_add_u32 s67, s77, 8192
    buffer_load_dwordx4 v[100:103], v8, s[8:11], s67 offen offset:1024 sc1
    ds_read_b128 a[36:39], v12 offset:576
    ds_read_b128 a[92:95], v13 offset:576
    s_add_u32 s67, s77, 20480
    buffer_load_dwordx4 v[156:159], v8, s[8:11], s67 offen offset:3072 sc1
    ds_read_b128 a[148:151], v14 offset:576
    ds_read_b128 a[204:207], v15 offset:576
    s_waitcnt lgkmcnt(6)
    s_add_u32 s67, s77, 8192
    buffer_load_dwordx4 v[104:107], v8, s[8:11], s67 offen offset:2048 sc1
    ds_read_b128 a[40:43], v12 offset:640
    ds_read_b128 a[96:99], v13 offset:640
    s_add_u32 s67, s77, 24576
    buffer_load_dwordx4 v[160:163], v8, s[8:11], s67 offen offset:0 sc1
    ds_read_b128 a[152:155], v14 offset:640
    ds_read_b128 a[208:211], v15 offset:640
    s_add_u32 s67, s77, 8192
    buffer_load_dwordx4 v[108:111], v8, s[8:11], s67 offen offset:3072 sc1
    ds_read_b128 a[44:47], v12 offset:704
    ds_read_b128 a[100:103], v13 offset:704
    s_add_u32 s67, s77, 24576
    buffer_load_dwordx4 v[164:167], v8, s[8:11], s67 offen offset:1024 sc1
    ds_read_b128 a[156:159], v14 offset:704
    ds_read_b128 a[212:215], v15 offset:704
    s_waitcnt lgkmcnt(6)
    s_add_u32 s67, s77, 12288
    buffer_load_dwordx4 v[112:115], v8, s[8:11], s67 offen offset:0 sc1
    ds_read_b128 a[48:51], v12 offset:768
    ds_read_b128 a[104:107], v13 offset:768
    s_add_u32 s67, s77, 24576
    buffer_load_dwordx4 v[168:171], v8, s[8:11], s67 offen offset:2048 sc1
    ds_read_b128 a[160:163], v14 offset:768
    ds_read_b128 a[216:219], v15 offset:768
    s_add_u32 s67, s77, 12288
    buffer_load_dwordx4 v[116:119], v8, s[8:11], s67 offen offset:1024 sc1
    ds_read_b128 a[52:55], v12 offset:832
    ds_read_b128 a[108:111], v13 offset:832
    s_add_u32 s67, s77, 24576
    buffer_load_dwordx4 v[172:175], v8, s[8:11], s67 offen offset:3072 sc1
    ds_read_b128 a[164:167], v14 offset:832
    ds_read_b128 a[220:223], v15 offset:832
    s_waitcnt lgkmcnt(6)
    s_waitcnt lgkmcnt(0)
    s_add_u32 s77, s77, 114688
    buffer_store_dword v1, v2, s[8:11], 0 offen
    buffer_store_dword v1, v2, s[8:11], 0 offen
    buffer_store_dword v1, v2, s[8:11], 0 offen
    buffer_store_dword v1, v2, s[8:11], 0 offen
L_w2loopB:
    s_waitcnt vmcnt(31)
    v_mfma_f32_16x16x32_bf16 v[16:19], v[64:67], a[0:3], 0
    v_mfma_f32_16x16x32_bf16 v[20:23], v[64:67], a[56:59], 0
    s_add_u32 s67, s77, 0
    buffer_load_dwordx4 v[176:179], v8, s[8:11], s67 offen offset:0 sc1
    v_mfma_f32_16x16x32_bf16 v[24:27], v[64:67], a[112:115], 0
    v_mfma_f32_16x16x32_bf16 v[28:31], v[64:67], a[168:171], 0
    v_mfma_f32_16x16x32_bf16 v[32:35], v[120:123], a[0:3], 0
    v_mfma_f32_16x16x32_bf16 v[36:39], v[120:123], a[56:59], 0
    s_add_u32 s67, s77, 12288
    buffer_load_dwordx4 v[232:235], v8, s[8:11], s67 offen offset:2048 sc1
    v_mfma_f32_16x16x32_bf16 v[40:43], v[120:123], a[112:115], 0
    v_mfma_f32_16x16x32_bf16 v[44:47], v[120:123], a[168:171], 0
    s_waitcnt vmcnt(31)
    v_mfma_f32_16x16x32_bf16 v[16:19], v[68:71], a[4:7], v[16:19]
    v_mfma_f32_16x16x32_bf16 v[20:23], v[68:71], a[60:63], v[20:23]
    s_add_u32 s67, s77, 0
    buffer_load_dwordx4 v[180:183], v8, s[8:11], s67 offen offset:1024 sc1
    v_mfma_f32_16x16x32_bf16 v[24:27], v[68:71], a[116:119], v[24:27]
    v_mfma_f32_16x16x32_bf16 v[28:31], v[68:71], a[172:175], v[28:31]
    v_mfma_f32_16x16x32_bf16 v[32:35], v[124:127], a[4:7], v[32:35]
    v_mfma_f32_16x16x32_bf16 v[36:39], v[124:127], a[60:63], v[36:39]
    s_add_u32 s67, s77, 12288
    buffer_load_dwordx4 v[236:239], v8, s[8:11], s67 offen offset:3072 sc1
    v_mfma_f32_16x16x32_bf16 v[40:43], v[124:127], a[116:119], v[40:43]
    v_mfma_f32_16x16x32_bf16 v[44:47], v[124:127], a[172:175], v[44:47]
    s_waitcnt vmcnt(4)
    v_mov_b32 v10, s81
    buffer_store_dword v10, v9, s[8:11], 0 offen sc1
    v_mfma_f32_16x16x32_bf16 v[16:19], v[72:75], a[8:11], v[16:19]
    v_mfma_f32_16x16x32_bf16 v[20:23], v[72:75], a[64:67], v[20:23]
    s_add_u32 s67, s77, 0
    buffer_load_dwordx4 v[184:187], v8, s[8:11], s67 offen offset:2048 sc1
    v_mfma_f32_16x16x32_bf16 v[24:27], v[72:75], a[120:123], v[24:27]
    v_mfma_f32_16x16x32_bf16 v[28:31], v[72:75], a[176:179], v[28:31]
    v_mfma_f32_16x16x32_bf16 v[32:35], v[128:131], a[8:11], v[32:35]
    v_mfma_f32_16x16x32_bf16 v[36:39], v[128:131], a[64:67], v[36:39]
    s_add_u32 s67, s77, 16384
    buffer_load_dwordx4 v[240:243], v8, s[8:11], s67 offen offset:0 sc1
    v_mfma_f32_16x16x32_bf16 v[40:43], v[128:131], a[120:123], v[40:43]
    v_mfma_f32_16x16x32_bf16 v[44:47], v[128:131], a[176:179], v[44:47]
    v_mfma_f32_16x16x32_bf16 v[16:19], v[76:79], a[12:15], v[16:19]
    v_mfma_f32_16x16x32_bf16 v[20:23], v[76:79], a[68:71], v[20:23]
    s_add_u32 s67, s77, 0
    buffer_load_dwordx4 v[188:191], v8, s[8:11], s67 offen offset:3072 sc1
    v_mfma_f32_16x16x32_bf16 v[24:27], v[76:79], a[124:127], v[24:27]
    v_mfma_f32_16x16x32_bf16 v[28:31], v[76:79], a[180:183], v[28:31]
    v_mfma_f32_16x16x32_bf16 v[32:35], v[132:135], a[12:15], v[32:35]
    v_mfma_f32_16x16x32_bf16 v[36:39], v[132:135], a[68:71], v[36:39]
    s_add_u32 s67, s77, 16384
    buffer_load_dwordx4 v[244:247], v8, s[8:11], s67 offen offset:1024 sc1
    v_mfma_f32_16x16x32_bf16 v[40:43], v[132:135], a[124:127], v[40:43]
    v_mfma_f32_16x16x32_bf16 v[44:47], v[132:135], a[180:183], v[44:47]
    v_mfma_f32_16x16x32_bf16 v[16:19], v[80:83], a[16:19], v[16:19]
    v_mfma_f32_16x16x32_bf16 v[20:23], v[80:83], a[72:75], v[20:23]
    s_add_u32 s67, s77, 4096
    buffer_load_dwordx4 v[192:195], v8, s[8:11], s67 offen offset:0 sc1
    v_mfma_f32_16x16x32_bf16 v[24:27], v[80:83], a[128:131], v[24:27]
    v_mfma_f32_16x16x32_bf16 v[28:31], v[80:83], a[184:187], v[28:31]
    v_mfma_f32_16x16x32_bf16 v[32:35], v[136:139], a[16:19], v[32:35]
    v_mfma_f32_16x16x32_bf16 v[36:39], v[136:139], a[72:75], v[36:39]
    s_add_u32 s67, s77, 16384
    buffer_load_dwordx4 v[248:251], v8, s[8:11], s67 offen offset:2048 sc1
    v_mfma_f32_16x16x32_bf16 v[40:43], v[136:139], a[128:131], v[40:43]
    v_mfma_f32_16x16x32_bf16 v[44:47], v[136:139], a[184:187], v[44:47]
    v_mfma_f32_16x16x32_bf16 v[16:19], v[84:87], a[20:23], v[16:19]
    v_mfma_f32_16x16x32_bf16 v[20:23], v[84:87], a[76:79], v[20:23]
    s_add_u32 s67, s77, 4096
    buffer_load_dwordx4 v[196:199], v8, s[8:11], s67 offen offset:1024 sc1
    v_mfma_f32_16x16x32_bf16 v[24:27], v[84:87], a[132:135], v[24:27]
    v_mfma_f32_16x16x32_bf16 v[28:31], v[84:87], a[188:191], v[28:31]
    v_mfma_f32_16x16x32_bf16 v[32:35], v[140:143], a[20:23], v[32:35]
    v_mfma_f32_16x16x32_bf16 v[36:39], v[140:143], a[76:79], v[36:39]
    s_add_u32 s67, s77, 16384
    buffer_load_dwordx4 v[252:255], v8, s[8:11], s67 offen offset:3072 sc1
    v_mfma_f32_16x16x32_bf16 v[40:43], v[140:143], a[132:135], v[40:43]
    v_mfma_f32_16x16x32_bf16 v[44:47], v[140:143], a[188:191], v[44:47]
    v_mfma_f32_16x16x32_bf16 v[16:19], v[88:91], a[24:27], v[16:19]
    v_mfma_f32_16x16x32_bf16 v[20:23], v[88:91], a[80:83], v[20:23]
    s_add_u32 s67, s77, 4096
    buffer_load_dwordx4 v[200:203], v8, s[8:11], s67 offen offset:2048 sc1
    v_mfma_f32_16x16x32_bf16 v[24:27], v[88:91], a[136:139], v[24:27]
    v_mfma_f32_16x16x32_bf16 v[28:31], v[88:91], a[192:195], v[28:31]
    v_mfma_f32_16x16x32_bf16 v[32:35], v[144:147], a[24:27], v[32:35]
    v_mfma_f32_16x16x32_bf16 v[36:39], v[144:147], a[80:83], v[36:39]
    s_add_u32 s67, s77, 20480
    buffer_load_dwordx4 a[224:227], v8, s[8:11], s67 offen offset:0 sc1
    v_mfma_f32_16x16x32_bf16 v[40:43], v[144:147], a[136:139], v[40:43]
    v_mfma_f32_16x16x32_bf16 v[44:47], v[144:147], a[192:195], v[44:47]
    v_mfma_f32_16x16x32_bf16 v[16:19], v[92:95], a[28:31], v[16:19]
    v_mfma_f32_16x16x32_bf16 v[20:23], v[92:95], a[84:87], v[20:23]
    s_add_u32 s67, s77, 4096
    buffer_load_dwordx4 v[204:207], v8, s[8:11], s67 offen offset:3072 sc1
    v_mfma_f32_16x16x32_bf16 v[24:27], v[92:95], a[140:143], v[24:27]
    v_mfma_f32_16x16x32_bf16 v[28:31], v[92:95], a[196:199], v[28:31]
    v_mfma_f32_16x16x32_bf16 v[32:35], v[148:151], a[28:31], v[32:35]
    v_mfma_f32_16x16x32_bf16 v[36:39], v[148:151], a[84:87], v[36:39]
    s_add_u32 s67, s77, 20480
    buffer_load_dwordx4 a[228:231], v8, s[8:11], s67 offen offset:1024 sc1
    v_mfma_f32_16x16x32_bf16 v[40:43], v[148:151], a[140:143], v[40:43]
    v_mfma_f32_16x16x32_bf16 v[44:47], v[148:151], a[196:199], v[44:47]
    v_mfma_f32_16x16x32_bf16 v[16:19], v[96:99], a[32:35], v[16:19]
    v_mfma_f32_16x16x32_bf16 v[20:23], v[96:99], a[88:91], v[20:23]
    s_add_u32 s67, s77, 8192
    buffer_load_dwordx4 v[208:211], v8, s[8:11], s67 offen offset:0 sc1
    v_mfma_f32_16x16x32_bf16 v[24:27], v[96:99], a[144:147], v[24:27]
    v_mfma_f32_16x16x32_bf16 v[28:31], v[96:99], a[200:203], v[28:31]
    v_mfma_f32_16x16x32_bf16 v[32:35], v[152:155], a[32:35], v[32:35]
    v_mfma_f32_16x16x32_bf16 v[36:39], v[152:155], a[88:91], v[36:39]
    s_add_u32 s67, s77, 20480
    buffer_load_dwordx4 a[232:235], v8, s[8:11], s67 offen offset:2048 sc1
    v_mfma_f32_16x16x32_bf16 v[40:43], v[152:155], a[144:147], v[40:43]
    v_mfma_f32_16x16x32_bf16 v[44:47], v[152:155], a[200:203], v[44:47]
    v_mfma_f32_16x16x32_bf16 v[16:19], v[100:103], a[36:39], v[16:19]
    v_mfma_f32_16x16x32_bf16 v[20:23], v[100:103], a[92:95], v[20:23]
    s_add_u32 s67, s77, 8192
    buffer_load_dwordx4 v[212:215], v8, s[8:11], s67 offen offset:1024 sc1
    v_mfma_f32_16x16x32_bf16 v[24:27], v[100:103], a[148:151], v[24:27]
    v_mfma_f32_16x16x32_bf16 v[28:31], v[100:103], a[204:207], v[28:31]
    v_mfma_f32_16x16x32_bf16 v[32:35], v[156:159], a[36:39], v[32:35]
    v_mfma_f32_16x16x32_bf16 v[36:39], v[156:159], a[92:95], v[36:39]
    s_add_u32 s67, s77, 20480
    buffer_load_dwordx4 a[236:239], v8, s[8:11], s67 offen offset:3072 sc1
    v_mfma_f32_16x16x32_bf16 v[40:43], v[156:159], a[148:151], v[40:43]
    v_mfma_f32_16x16x32_bf16 v[44:47], v[156:159], a[204:207], v[44:47]
    v_mfma_f32_16x16x32_bf16 v[16:19], v[104:107], a[40:43], v[16:19]
    v_mfma_f32_16x16x32_bf16 v[20:23], v[104:107], a[96:99], v[20:23]
    s_add_u32 s67, s77, 8192
    buffer_load_dwordx4 v[216:219], v8, s[8:11], s67 offen offset:2048 sc1
    v_mfma_f32_16x16x32_bf16 v[24:27], v[104:107], a[152:155], v[24:27]
    v_mfma_f32_16x16x32_bf16 v[28:31], v[104:107], a[208:211], v[28:31]
    v_mfma_f32_16x16x32_bf16 v[32:35], v[160:163], a[40:43], v[32:35]
    v_mfma_f32_16x16x32_bf16 v[36:39], v[160:163], a[96:99], v[36:39]
    s_add_u32 s67, s77, 24576
    buffer_load_dwordx4 a[240:243], v8, s[8:11], s67 offen offset:0 sc1
    v_mfma_f32_16x16x32_bf16 v[40:43], v[160:163], a[152:155], v[40:43]
    v_mfma_f32_16x16x32_bf16 v[44:47], v[160:163], a[208:211], v[44:47]
    v_mfma_f32_16x16x32_bf16 v[16:19], v[108:111], a[44:47], v[16:19]
    v_mfma_f32_16x16x32_bf16 v[20:23], v[108:111], a[100:103], v[20:23]
    s_add_u32 s67, s77, 8192
    buffer_load_dwordx4 v[220:223], v8, s[8:11], s67 offen offset:3072 sc1
    v_mfma_f32_16x16x32_bf16 v[24:27], v[108:111], a[156:159], v[24:27]
    v_mfma_f32_16x16x32_bf16 v[28:31], v[108:111], a[212:215], v[28:31]
    v_mfma_f32_16x16x32_bf16 v[32:35], v[164:167], a[44:47], v[32:35]
    v_mfma_f32_16x16x32_bf16 v[36:39], v[164:167], a[100:103], v[36:39]
    s_add_u32 s67, s77, 24576
    buffer_load_dwordx4 a[244:247], v8, s[8:11], s67 offen offset:1024 sc1
    v_mfma_f32_16x16x32_bf16 v[40:43], v[164:167], a[156:159], v[40:43]
    v_mfma_f32_16x16x32_bf16 v[44:47], v[164:167], a[212:215], v[44:47]
    v_mfma_f32_16x16x32_bf16 v[16:19], v[112:115], a[48:51], v[16:19]
    v_mfma_f32_16x16x32_bf16 v[20:23], v[112:115], a[104:107], v[20:23]
    s_add_u32 s67, s77, 12288
    buffer_load_dwordx4 v[224:227], v8, s[8:11], s67 offen offset:0 sc1
    v_mfma_f32_16x16x32_bf16 v[24:27], v[112:115], a[160:163], v[24:27]
    v_mfma_f32_16x16x32_bf16 v[28:31], v[112:115], a[216:219], v[28:31]
    v_mfma_f32_16x16x32_bf16 v[32:35], v[168:171], a[48:51], v[32:35]
    v_mfma_f32_16x16x32_bf16 v[36:39], v[168:171], a[104:107], v[36:39]
    s_add_u32 s67, s77, 24576
    buffer_load_dwordx4 a[248:251], v8, s[8:11], s67 offen offset:2048 sc1
    v_mfma_f32_16x16x32_bf16 v[40:43], v[168:171], a[160:163], v[40:43]
    v_mfma_f32_16x16x32_bf16 v[44:47], v[168:171], a[216:219], v[44:47]
    v_mfma_f32_16x16x32_bf16 v[16:19], v[116:119], a[52:55], v[16:19]
    v_mfma_f32_16x16x32_bf16 v[20:23], v[116:119], a[108:111], v[20:23]
    s_add_u32 s67, s77, 12288
    buffer_load_dwordx4 v[228:231], v8, s[8:11], s67 offen offset:1024 sc1
    v_mfma_f32_16x16x32_bf16 v[24:27], v[116:119], a[164:167], v[24:27]
    v_mfma_f32_16x16x32_bf16 v[28:31], v[116:119], a[220:223], v[28:31]
    v_mfma_f32_16x16x32_bf16 v[32:35], v[172:175], a[52:55], v[32:35]
    v_mfma_f32_16x16x32_bf16 v[36:39], v[172:175], a[108:111], v[36:39]
    s_add_u32 s67, s77, 24576
    buffer_load_dwordx4 a[252:255], v8, s[8:11], s67 offen offset:3072 sc1
    v_mfma_f32_16x16x32_bf16 v[40:43], v[172:175], a[164:167], v[40:43]
    v_mfma_f32_16x16x32_bf16 v[44:47], v[172:175], a[220:223], v[44:47]
    s_add_u32 s77, s77, 114688
    v_cvt_pk_bf16_f32 v48, v16, v17
    v_cvt_pk_bf16_f32 v49, v18, v19
    v_cvt_pk_bf16_f32 v50, v32, v33
    v_cvt_pk_bf16_f32 v51, v34, v35
    buffer_store_dwordx4 v[48:51], v4, s[8:11], s79 offen sc1
    v_cvt_pk_bf16_f32 v52, v20, v21
    v_cvt_pk_bf16_f32 v53, v22, v23
    v_cvt_pk_bf16_f32 v54, v36, v37
    v_cvt_pk_bf16_f32 v55, v38, v39
    buffer_store_dwordx4 v[52:55], v5, s[8:11], s79 offen sc1
    v_cvt_pk_bf16_f32 v56, v24, v25
    v_cvt_pk_bf16_f32 v57, v26, v27
    v_cvt_pk_bf16_f32 v58, v40, v41
    v_cvt_pk_bf16_f32 v59, v42, v43
    buffer_store_dwordx4 v[56:59], v6, s[8:11], s79 offen sc1
    v_cvt_pk_bf16_f32 v60, v28, v29
    v_cvt_pk_bf16_f32 v61, v30, v31
    v_cvt_pk_bf16_f32 v62, v44, v45
    v_cvt_pk_bf16_f32 v63, v46, v47
    buffer_store_dwordx4 v[60:63], v7, s[8:11], s79 offen sc1
    s_add_u32 s79, s79, 1835008
    s_add_u32 s81, s81, 1
    s_waitcnt vmcnt(31)
    v_mfma_f32_16x16x32_bf16 v[16:19], v[176:179], a[0:3], 0
    v_mfma_f32_16x16x32_bf16 v[20:23], v[176:179], a[56:59], 0
    s_add_u32 s67, s77, 0
    buffer_load_dwordx4 v[64:67], v8, s[8:11], s67 offen offset:0 sc1
    v_mfma_f32_16x16x32_bf16 v[24:27], v[176:179], a[112:115], 0
    v_mfma_f32_16x16x32_bf16 v[28:31], v[176:179], a[168:171], 0
    v_mfma_f32_16x16x32_bf16 v[32:35], v[232:235], a[0:3], 0
    v_mfma_f32_16x16x32_bf16 v[36:39], v[232:235], a[56:59], 0
    s_add_u32 s67, s77, 12288
    buffer_load_dwordx4 v[120:123], v8, s[8:11], s67 offen offset:2048 sc1
    v_mfma_f32_16x16x32_bf16 v[40:43], v[232:235], a[112:115], 0
    v_mfma_f32_16x16x32_bf16 v[44:47], v[232:235], a[168:171], 0
    s_waitcnt vmcnt(31)
    v_mfma_f32_16x16x32_bf16 v[16:19], v[180:183], a[4:7], v[16:19]
    v_mfma_f32_16x16x32_bf16 v[20:23], v[180:183], a[60:63], v[20:23]
    s_add_u32 s67, s77, 0
    buffer_load_dwordx4 v[68:71], v8, s[8:11], s67 offen offset:1024 sc1
    v_mfma_f32_16x16x32_bf16 v[24:27], v[180:183], a[116:119], v[24:27]
    v_mfma_f32_16x16x32_bf16 v[28:31], v[180:183], a[172:175], v[28:31]
    v_mfma_f32_16x16x32_bf16 v[32:35], v[236:239], a[4:7], v[32:35]
    v_mfma_f32_16x16x32_bf16 v[36:39], v[236:239], a[60:63], v[36:39]
    s_add_u32 s67, s77, 12288
    buffer_load_dwordx4 v[124:127], v8, s[8:11], s67 offen offset:3072 sc1
    v_mfma_f32_16x16x32_bf16 v[40:43], v[236:239], a[116:119], v[40:43]
    v_mfma_f32_16x16x32_bf16 v[44:47], v[236:239], a[172:175], v[44:47]
    s_waitcnt vmcnt(4)
    v_mov_b32 v10, s81
    buffer_store_dword v10, v9, s[8:11], 0 offen sc1
    v_mfma_f32_16x16x32_bf16 v[16:19], v[184:187], a[8:11], v[16:19]
    v_mfma_f32_16x16x32_bf16 v[20:23], v[184:187], a[64:67], v[20:23]
    s_add_u32 s67, s77, 0
    buffer_load_dwordx4 v[72:75], v8, s[8:11], s67 offen offset:2048 sc1
    v_mfma_f32_16x16x32_bf16 v[24:27], v[184:187], a[120:123], v[24:27]
    v_mfma_f32_16x16x32_bf16 v[28:31], v[184:187], a[176:179], v[28:31]
    v_mfma_f32_16x16x32_bf16 v[32:35], v[240:243], a[8:11], v[32:35]
    v_mfma_f32_16x16x32_bf16 v[36:39], v[240:243], a[64:67], v[36:39]
    s_add_u32 s67, s77, 16384
    buffer_load_dwordx4 v[128:131], v8, s[8:11], s67 offen offset:0 sc1
    v_mfma_f32_16x16x32_bf16 v[40:43], v[240:243], a[120:123], v[40:43]
    v_mfma_f32_16x16x32_bf16 v[44:47], v[240:243], a[176:179], v[44:47]
    v_mfma_f32_16x16x32_bf16 v[16:19], v[188:191], a[12:15], v[16:19]
    v_mfma_f32_16x16x32_bf16 v[20:23], v[188:191], a[68:71], v[20:23]
    s_add_u32 s67, s77, 0
    buffer_load_dwordx4 v[76:79], v8, s[8:11], s67 offen offset:3072 sc1
    v_mfma_f32_16x16x32_bf16 v[24:27], v[188:191], a[124:127], v[24:27]
    v_mfma_f32_16x16x32_bf16 v[28:31], v[188:191], a[180:183], v[28:31]
    v_mfma_f32_16x16x32_bf16 v[32:35], v[244:247], a[12:15], v[32:35]
    v_mfma_f32_16x16x32_bf16 v[36:39], v[244:247], a[68:71], v[36:39]
    s_add_u32 s67, s77, 16384
    buffer_load_dwordx4 v[132:135], v8, s[8:11], s67 offen offset:1024 sc1
    v_mfma_f32_16x16x32_bf16 v[40:43], v[244:247], a[124:127], v[40:43]
    v_mfma_f32_16x16x32_bf16 v[44:47], v[244:247], a[180:183], v[44:47]
    v_mfma_f32_16x16x32_bf16 v[16:19], v[192:195], a[16:19], v[16:19]
    v_mfma_f32_16x16x32_bf16 v[20:23], v[192:195], a[72:75], v[20:23]
    s_add_u32 s67, s77, 4096
    buffer_load_dwordx4 v[80:83], v8, s[8:11], s67 offen offset:0 sc1
    v_mfma_f32_16x16x32_bf16 v[24:27], v[192:195], a[128:131], v[24:27]
    v_mfma_f32_16x16x32_bf16 v[28:31], v[192:195], a[184:187], v[28:31]
    v_mfma_f32_16x16x32_bf16 v[32:35], v[248:251], a[16:19], v[32:35]
    v_mfma_f32_16x16x32_bf16 v[36:39], v[248:251], a[72:75], v[36:39]
    s_add_u32 s67, s77, 16384
    buffer_load_dwordx4 v[136:139], v8, s[8:11], s67 offen offset:2048 sc1
    v_mfma_f32_16x16x32_bf16 v[40:43], v[248:251], a[128:131], v[40:43]
    v_mfma_f32_16x16x32_bf16 v[44:47], v[248:251], a[184:187], v[44:47]
    v_mfma_f32_16x16x32_bf16 v[16:19], v[196:199], a[20:23], v[16:19]
    v_mfma_f32_16x16x32_bf16 v[20:23], v[196:199], a[76:79], v[20:23]
    s_add_u32 s67, s77, 4096
    buffer_load_dwordx4 v[84:87], v8, s[8:11], s67 offen offset:1024 sc1
    v_mfma_f32_16x16x32_bf16 v[24:27], v[196:199], a[132:135], v[24:27]
    v_mfma_f32_16x16x32_bf16 v[28:31], v[196:199], a[188:191], v[28:31]
    v_mfma_f32_16x16x32_bf16 v[32:35], v[252:255], a[20:23], v[32:35]
    v_mfma_f32_16x16x32_bf16 v[36:39], v[252:255], a[76:79], v[36:39]
    s_add_u32 s67, s77, 16384
    buffer_load_dwordx4 v[140:143], v8, s[8:11], s67 offen offset:3072 sc1
    v_mfma_f32_16x16x32_bf16 v[40:43], v[252:255], a[132:135], v[40:43]
    v_mfma_f32_16x16x32_bf16 v[44:47], v[252:255], a[188:191], v[44:47]
    v_mfma_f32_16x16x32_bf16 v[16:19], v[200:203], a[24:27], v[16:19]
    v_mfma_f32_16x16x32_bf16 v[20:23], v[200:203], a[80:83], v[20:23]
    s_add_u32 s67, s77, 4096
    buffer_load_dwordx4 v[88:91], v8, s[8:11], s67 offen offset:2048 sc1
    v_mfma_f32_16x16x32_bf16 v[24:27], v[200:203], a[136:139], v[24:27]
    v_mfma_f32_16x16x32_bf16 v[28:31], v[200:203], a[192:195], v[28:31]
    v_mfma_f32_16x16x32_bf16 v[32:35], a[224:227], a[24:27], v[32:35]
    v_mfma_f32_16x16x32_bf16 v[36:39], a[224:227], a[80:83], v[36:39]
    s_add_u32 s67, s77, 20480
    buffer_load_dwordx4 v[144:147], v8, s[8:11], s67 offen offset:0 sc1
    v_mfma_f32_16x16x32_bf16 v[40:43], a[224:227], a[136:139], v[40:43]
    v_mfma_f32_16x16x32_bf16 v[44:47], a[224:227], a[192:195], v[44:47]
    v_mfma_f32_16x16x32_bf16 v[16:19], v[204:207], a[28:31], v[16:19]
    v_mfma_f32_16x16x32_bf16 v[20:23], v[204:207], a[84:87], v[20:23]
    s_add_u32 s67, s77, 4096
    buffer_load_dwordx4 v[92:95], v8, s[8:11], s67 offen offset:3072 sc1
    v_mfma_f32_16x16x32_bf16 v[24:27], v[204:207], a[140:143], v[24:27]
    v_mfma_f32_16x16x32_bf16 v[28:31], v[204:207], a[196:199], v[28:31]
    v_mfma_f32_16x16x32_bf16 v[32:35], a[228:231], a[28:31], v[32:35]
    v_mfma_f32_16x16x32_bf16 v[36:39], a[228:231], a[84:87], v[36:39]
    s_add_u32 s67, s77, 20480
    buffer_load_dwordx4 v[148:151], v8, s[8:11], s67 offen offset:1024 sc1
    v_mfma_f32_16x16x32_bf16 v[40:43], a[228:231], a[140:143], v[40:43]
    v_mfma_f32_16x16x32_bf16 v[44:47], a[228:231], a[196:199], v[44:47]
    v_mfma_f32_16x16x32_bf16 v[16:19], v[208:211], a[32:35], v[16:19]
    v_mfma_f32_16x16x32_bf16 v[20:23], v[208:211], a[88:91], v[20:23]
    s_add_u32 s67, s77, 8192
    buffer_load_dwordx4 v[96:99], v8, s[8:11], s67 offen offset:0 sc1
    v_mfma_f32_16x16x32_bf16 v[24:27], v[208:211], a[144:147], v[24:27]
    v_mfma_f32_16x16x32_bf16 v[28:31], v[208:211], a[200:203], v[28:31]
    v_mfma_f32_16x16x32_bf16 v[32:35], a[232:235], a[32:35], v[32:35]
    v_mfma_f32_16x16x32_bf16 v[36:39], a[232:235], a[88:91], v[36:39]
    s_add_u32 s67, s77, 20480
    buffer_load_dwordx4 v[152:155], v8, s[8:11], s67 offen offset:2048 sc1
    v_mfma_f32_16x16x32_bf16 v[40:43], a[232:235], a[144:147], v[40:43]
    v_mfma_f32_16x16x32_bf16 v[44:47], a[232:235], a[200:203], v[44:47]
    v_mfma_f32_16x16x32_bf16 v[16:19], v[212:215], a[36:39], v[16:19]
    v_mfma_f32_16x16x32_bf16 v[20:23], v[212:215], a[92:95], v[20:23]
    s_add_u32 s67, s77, 8192
    buffer_load_dwordx4 v[100:103], v8, s[8:11], s67 offen offset:1024 sc1
    v_mfma_f32_16x16x32_bf16 v[24:27], v[212:215], a[148:151], v[24:27]
    v_mfma_f32_16x16x32_bf16 v[28:31], v[212:215], a[204:207], v[28:31]
    v_mfma_f32_16x16x32_bf16 v[32:35], a[236:239], a[36:39], v[32:35]
    v_mfma_f32_16x16x32_bf16 v[36:39], a[236:239], a[92:95], v[36:39]
    s_add_u32 s67, s77, 20480
    buffer_load_dwordx4 v[156:159], v8, s[8:11], s67 offen offset:3072 sc1
    v_mfma_f32_16x16x32_bf16 v[40:43], a[236:239], a[148:151], v[40:43]
    v_mfma_f32_16x16x32_bf16 v[44:47], a[236:239], a[204:207], v[44:47]
    v_mfma_f32_16x16x32_bf16 v[16:19], v[216:219], a[40:43], v[16:19]
    v_mfma_f32_16x16x32_bf16 v[20:23], v[216:219], a[96:99], v[20:23]
    s_add_u32 s67, s77, 8192
    buffer_load_dwordx4 v[104:107], v8, s[8:11], s67 offen offset:2048 sc1
    v_mfma_f32_16x16x32_bf16 v[24:27], v[216:219], a[152:155], v[24:27]
    v_mfma_f32_16x16x32_bf16 v[28:31], v[216:219], a[208:211], v[28:31]
    v_mfma_f32_16x16x32_bf16 v[32:35], a[240:243], a[40:43], v[32:35]
    v_mfma_f32_16x16x32_bf16 v[36:39], a[240:243], a[96:99], v[36:39]
    s_add_u32 s67, s77, 24576
    buffer_load_dwordx4 v[160:163], v8, s[8:11], s67 offen offset:0 sc1
    v_mfma_f32_16x16x32_bf16 v[40:43], a[240:243], a[152:155], v[40:43]
    v_mfma_f32_16x16x32_bf16 v[44:47], a[240:243], a[208:211], v[44:47]
    v_mfma_f32_16x16x32_bf16 v[16:19], v[220:223], a[44:47], v[16:19]
    v_mfma_f32_16x16x32_bf16 v[20:23], v[220:223], a[100:103], v[20:23]
    s_add_u32 s67, s77, 8192
    buffer_load_dwordx4 v[108:111], v8, s[8:11], s67 offen offset:3072 sc1
    v_mfma_f32_16x16x32_bf16 v[24:27], v[220:223], a[156:159], v[24:27]
    v_mfma_f32_16x16x32_bf16 v[28:31], v[220:223], a[212:215], v[28:31]
    v_mfma_f32_16x16x32_bf16 v[32:35], a[244:247], a[44:47], v[32:35]
    v_mfma_f32_16x16x32_bf16 v[36:39], a[244:247], a[100:103], v[36:39]
    s_add_u32 s67, s77, 24576
    buffer_load_dwordx4 v[164:167], v8, s[8:11], s67 offen offset:1024 sc1
    v_mfma_f32_16x16x32_bf16 v[40:43], a[244:247], a[156:159], v[40:43]
    v_mfma_f32_16x16x32_bf16 v[44:47], a[244:247], a[212:215], v[44:47]
    v_mfma_f32_16x16x32_bf16 v[16:19], v[224:227], a[48:51], v[16:19]
    v_mfma_f32_16x16x32_bf16 v[20:23], v[224:227], a[104:107], v[20:23]
    s_add_u32 s67, s77, 12288
    buffer_load_dwordx4 v[112:115], v8, s[8:11], s67 offen offset:0 sc1
    v_mfma_f32_16x16x32_bf16 v[24:27], v[224:227], a[160:163], v[24:27]
    v_mfma_f32_16x16x32_bf16 v[28:31], v[224:227], a[216:219], v[28:31]
    v_mfma_f32_16x16x32_bf16 v[32:35], a[248:251], a[48:51], v[32:35]
    v_mfma_f32_16x16x32_bf16 v[36:39], a[248:251], a[104:107], v[36:39]
    s_add_u32 s67, s77, 24576
    buffer_load_dwordx4 v[168:171], v8, s[8:11], s67 offen offset:2048 sc1
    v_mfma_f32_16x16x32_bf16 v[40:43], a[248:251], a[160:163], v[40:43]
    v_mfma_f32_16x16x32_bf16 v[44:47], a[248:251], a[216:219], v[44:47]
    v_mfma_f32_16x16x32_bf16 v[16:19], v[228:231], a[52:55], v[16:19]
    v_mfma_f32_16x16x32_bf16 v[20:23], v[228:231], a[108:111], v[20:23]
    s_add_u32 s67, s77, 12288
    buffer_load_dwordx4 v[116:119], v8, s[8:11], s67 offen offset:1024 sc1
    v_mfma_f32_16x16x32_bf16 v[24:27], v[228:231], a[164:167], v[24:27]
    v_mfma_f32_16x16x32_bf16 v[28:31], v[228:231], a[220:223], v[28:31]
    v_mfma_f32_16x16x32_bf16 v[32:35], a[252:255], a[52:55], v[32:35]
    v_mfma_f32_16x16x32_bf16 v[36:39], a[252:255], a[108:111], v[36:39]
    s_add_u32 s67, s77, 24576
    buffer_load_dwordx4 v[172:175], v8, s[8:11], s67 offen offset:3072 sc1
    v_mfma_f32_16x16x32_bf16 v[40:43], a[252:255], a[164:167], v[40:43]
    v_mfma_f32_16x16x32_bf16 v[44:47], a[252:255], a[220:223], v[44:47]
    s_add_u32 s77, s77, 114688
    v_cvt_pk_bf16_f32 v48, v16, v17
    v_cvt_pk_bf16_f32 v49, v18, v19
    v_cvt_pk_bf16_f32 v50, v32, v33
    v_cvt_pk_bf16_f32 v51, v34, v35
    buffer_store_dwordx4 v[48:51], v4, s[8:11], s79 offen sc1
    v_cvt_pk_bf16_f32 v52, v20, v21
    v_cvt_pk_bf16_f32 v53, v22, v23
    v_cvt_pk_bf16_f32 v54, v36, v37
    v_cvt_pk_bf16_f32 v55, v38, v39
    buffer_store_dwordx4 v[52:55], v5, s[8:11], s79 offen sc1
    v_cvt_pk_bf16_f32 v56, v24, v25
    v_cvt_pk_bf16_f32 v57, v26, v27
    v_cvt_pk_bf16_f32 v58, v40, v41
    v_cvt_pk_bf16_f32 v59, v42, v43
    buffer_store_dwordx4 v[56:59], v6, s[8:11], s79 offen sc1
    v_cvt_pk_bf16_f32 v60, v28, v29
    v_cvt_pk_bf16_f32 v61, v30, v31
    v_cvt_pk_bf16_f32 v62, v44, v45
    v_cvt_pk_bf16_f32 v63, v46, v47
    buffer_store_dwordx4 v[60:63], v7, s[8:11], s79 offen sc1
    s_add_u32 s79, s79, 1835008
    s_add_u32 s81, s81, 1
    s_cmp_lt_u32 s81, 16
    s_cbranch_scc1 L_w2loopB
    s_waitcnt vmcnt(0)
    v_mov_b32 v10, 16
    buffer_store_dword v10, v9, s[8:11], 0 offen sc1
    v_mov_b32 v9, 0
    v_bfe_u32 v1, v0, 4, 2
    v_lshl_add_u32 v9, v1, 7, v9
    v_bfe_u32 v1, v0, 0, 3
    v_lshl_add_u32 v9, v1, 4, v9
    v_add_u32 v11, 4096, v9
    s_lshl_b32 s65, s75, 5
    s_add_u32 s65, s65, s60
    s_lshl_b32 s65, s65, 2
    s_add_u32 s65, s65, 88307712
    v_mov_b32 v1, s65
    v_mov_b32 v2, 2147483632
    v_cmp_eq_u32 vcc, 0, v0
    s_nop 1
    v_cndmask_b32 v10, v2, v1, vcc
    s_lshr_b32 s65, s72, 2
    s_mul_i32 s65, s65, 28672
    s_and_b32 s66, s72, 3
    s_lshl_b32 s66, s66, 8
    s_add_u32 s65, s65, s66
    s_lshl_b32 s66, s73, 12
    s_add_u32 s65, s65, s66
    v_mov_b32 v12, s65
    v_bfe_u32 v1, v0, 0, 4
    v_lshl_add_u32 v12, v1, 4, v12
    v_bfe_u32 v1, v0, 4, 1
    v_lshl_add_u32 v12, v1, 3, v12
    v_cmp_gt_u32 vcc, 32, v0
    s_nop 1
    v_cndmask_b32 v4, v2, v12, vcc
    s_mul_i32 s65, s72, 28672
    s_lshl_b32 s66, s73, 12
    s_add_u32 s65, s65, s66
    s_add_u32 s65, s65, 16777216
    v_mov_b32 v13, s65
    v_bfe_u32 v1, v0, 0, 5
    v_lshl_add_u32 v13, v1, 7, v13
    s_mov_b32 s80, s60
    s_mov_b32 s81, 0
L_zloop:
    s_mul_i32 s77, s80, 7168
    s_add_u32 s77, s77, 82837504
    s_mul_i32 s78, s80, 114688
    s_add_u32 s78, s78, 75497472
    s_sub_u32 s67, s77, 7168
    s_cmp_ge_u32 s80, 62
    s_cselect_b32 s67, s67, s77
L_hm_331:
    buffer_load_dword v3, v11, s[8:11], s67 offen offset:2560 sc1
    s_waitcnt vmcnt(0)
    v_cmp_eq_u32 vcc, -1, v3
    s_cbranch_vccnz L_retry_334
L_hm2_332:
    buffer_load_dwordx4 v[64:67], v9, s[8:11], s77 offen offset:0 sc1
    buffer_load_dwordx4 v[68:71], v9, s[8:11], s77 offen offset:512 sc1
    buffer_load_dwordx4 v[72:75], v9, s[8:11], s77 offen offset:1024 sc1
    buffer_load_dwordx4 v[76:79], v9, s[8:11], s77 offen offset:1536 sc1
    buffer_load_dwordx4 v[80:83], v9, s[8:11], s77 offen offset:2048 sc1
    buffer_load_dwordx4 v[84:87], v9, s[8:11], s77 offen offset:2560 sc1
    buffer_load_dwordx4 v[88:91], v9, s[8:11], s77 offen offset:3072 sc1
    buffer_load_dwordx4 v[92:95], v9, s[8:11], s77 offen offset:3584 sc1
    buffer_load_dwordx4 v[96:99], v11, s[8:11], s77 offen offset:0 sc1
    buffer_load_dwordx4 v[100:103], v11, s[8:11], s77 offen offset:512 sc1
    buffer_load_dwordx4 v[104:107], v11, s[8:11], s77 offen offset:1024 sc1
    buffer_load_dwordx4 v[108:111], v11, s[8:11], s77 offen offset:1536 sc1
    buffer_load_dwordx4 v[112:115], v11, s[8:11], s77 offen offset:2048 sc1
    buffer_load_dwordx4 v[116:119], v11, s[8:11], s77 offen offset:2560 sc1
    s_waitcnt vmcnt(13)
    v_cmp_eq_u32 vcc, -1, v64
    s_cbranch_vccnz L_retry_335
    s_waitcnt vmcnt(13)
    v_mfma_f32_16x16x32_bf16 v[16:19], v[64:67], a[0:3], 0
    v_mfma_f32_16x16x32_bf16 v[20:23], v[64:67], a[56:59], 0
    v_mfma_f32_16x16x32_bf16 v[24:27], v[64:67], a[112:115], 0
    v_mfma_f32_16x16x32_bf16 v[28:31], v[64:67], a[168:171], 0
    v_max_u32 v3, v64, v65
    v_max3_u32 v3, v3, v66, v67
    s_waitcnt vmcnt(12)
    v_mfma_f32_16x16x32_bf16 v[16:19], v[68:71], a[4:7], v[16:19]
    v_mfma_f32_16x16x32_bf16 v[20:23], v[68:71], a[60:63], v[20:23]
    v_mfma_f32_16x16x32_bf16 v[24:27], v[68:71], a[116:119], v[24:27]
    v_mfma_f32_16x16x32_bf16 v[28:31], v[68:71], a[172:175], v[28:31]
    v_max3_u32 v3, v3, v68, v69
    v_max3_u32 v3, v3, v70, v71
    s_waitcnt vmcnt(11)
    v_mfma_f32_16x16x32_bf16 v[16:19], v[72:75], a[8:11], v[16:19]
    v_mfma_f32_16x16x32_bf16 v[20:23], v[72:75], a[64:67], v[20:23]
    v_mfma_f32_16x16x32_bf16 v[24:27], v[72:75], a[120:123], v[24:27]
    v_mfma_f32_16x16x32_bf16 v[28:31], v[72:75], a[176:179], v[28:31]
    v_max3_u32 v3, v3, v72, v73
    v_max3_u32 v3, v3, v74, v75
    s_waitcnt vmcnt(10)
    v_mfma_f32_16x16x32_bf16 v[16:19], v[76:79], a[12:15], v[16:19]
    v_mfma_f32_16x16x32_bf16 v[20:23], v[76:79], a[68:71], v[20:23]
    v_mfma_f32_16x16x32_bf16 v[24:27], v[76:79], a[124:127], v[24:27]
    v_mfma_f32_16x16x32_bf16 v[28:31], v[76:79], a[180:183], v[28:31]
    v_max3_u32 v3, v3, v76, v77
    v_max3_u32 v3, v3, v78, v79
    s_waitcnt vmcnt(9)
    v_mfma_f32_16x16x32_bf16 v[16:19], v[80:83], a[16:19], v[16:19]
    v_mfma_f32_16x16x32_bf16 v[20:23], v[80:83], a[72:75], v[20:23]
    v_mfma_f32_16x16x32_bf16 v[24:27], v[80:83], a[128:131], v[24:27]
    v_mfma_f32_16x16x32_bf16 v[28:31], v[80:83], a[184:187], v[28:31]
    v_max3_u32 v3, v3, v80, v81
    v_max3_u32 v3, v3, v82, v83
    s_waitcnt vmcnt(8)
    v_mfma_f32_16x16x32_bf16 v[16:19], v[84:87], a[20:23], v[16:19]
    v_mfma_f32_16x16x32_bf16 v[20:23], v[84:87], a[76:79], v[20:23]
    v_mfma_f32_16x16x32_bf16 v[24:27], v[84:87], a[132:135], v[24:27]
    v_mfma_f32_16x16x32_bf16 v[28:31], v[84:87], a[188:191], v[28:31]
    v_max3_u32 v3, v3, v84, v85
    v_max3_u32 v3, v3, v86, v87
    s_waitcnt vmcnt(7)
    v_mfma_f32_16x16x32_bf16 v[16:19], v[88:91], a[24:27], v[16:19]
    v_mfma_f32_16x16x32_bf16 v[20:23], v[88:91], a[80:83], v[20:23]
    v_mfma_f32_16x16x32_bf16 v[24:27], v[88:91], a[136:139], v[24:27]
    v_mfma_f32_16x16x32_bf16 v[28:31], v[88:91], a[192:195], v[28:31]
    v_max3_u32 v3, v3, v88, v89
    v_max3_u32 v3, v3, v90, v91
    s_waitcnt vmcnt(6)
    v_mfma_f32_16x16x32_bf16 v[16:19], v[92:95], a[28:31], v[16:19]
    v_mfma_f32_16x16x32_bf16 v[20:23], v[92:95], a[84:87], v[20:23]
    v_mfma_f32_16x16x32_bf16 v[24:27], v[92:95], a[140:143], v[24:27]
    v_mfma_f32_16x16x32_bf16 v[28:31], v[92:95], a[196:199], v[28:31]
    v_max3_u32 v3, v3, v92, v93
    v_max3_u32 v3, v3, v94, v95
    s_waitcnt vmcnt(5)
    v_mfma_f32_16x16x32_bf16 v[16:19], v[96:99], a[32:35], v[16:19]
    v_mfma_f32_16x16x32_bf16 v[20:23], v[96:99], a[88:91], v[20:23]
    v_mfma_f32_16x16x32_bf16 v[24:27], v[96:99], a[144:147], v[24:27]
    v_mfma_f32_16x16x32_bf16 v[28:31], v[96:99], a[200:203], v[28:31]
    v_max3_u32 v3, v3, v96, v97
    v_max3_u32 v3, v3, v98, v99
    s_waitcnt vmcnt(4)
    v_mfma_f32_16x16x32_bf16 v[16:19], v[100:103], a[36:39], v[16:19]
    v_mfma_f32_16x16x32_bf16 v[20:23], v[100:103], a[92:95], v[20:23]
    v_mfma_f32_16x16x32_bf16 v[24:27], v[100:103], a[148:151], v[24:27]
    v_mfma_f32_16x16x32_bf16 v[28:31], v[100:103], a[204:207], v[28:31]
    v_max3_u32 v3, v3, v100, v101
    v_max3_u32 v3, v3, v102, v103
    s_waitcnt vmcnt(3)
    v_mfma_f32_16x16x32_bf16 v[16:19], v[104:107], a[40:43], v[16:19]
    v_mfma_f32_16x16x32_bf16 v[20:23], v[104:107], a[96:99], v[20:23]
    v_mfma_f32_16x16x32_bf16 v[24:27], v[104:107], a[152:155], v[24:27]
    v_mfma_f32_16x16x32_bf16 v[28:31], v[104:107], a[208:211], v[28:31]
    v_max3_u32 v3, v3, v104, v105
    v_max3_u32 v3, v3, v106, v107
    s_waitcnt vmcnt(2)
    v_mfma_f32_16x16x32_bf16 v[16:19], v[108:111], a[44:47], v[16:19]
    v_mfma_f32_16x16x32_bf16 v[20:23], v[108:111], a[100:103], v[20:23]
    v_mfma_f32_16x16x32_bf16 v[24:27], v[108:111], a[156:159], v[24:27]
    v_mfma_f32_16x16x32_bf16 v[28:31], v[108:111], a[212:215], v[28:31]
    v_max3_u32 v3, v3, v108, v109
    v_max3_u32 v3, v3, v110, v111
    s_waitcnt vmcnt(1)
    v_mfma_f32_16x16x32_bf16 v[16:19], v[112:115], a[48:51], v[16:19]
    v_mfma_f32_16x16x32_bf16 v[20:23], v[112:115], a[104:107], v[20:23]
    v_mfma_f32_16x16x32_bf16 v[24:27], v[112:115], a[160:163], v[24:27]
    v_mfma_f32_16x16x32_bf16 v[28:31], v[112:115], a[216:219], v[28:31]
    v_max3_u32 v3, v3, v112, v113
    v_max3_u32 v3, v3, v114, v115
    s_waitcnt vmcnt(0)
    v_mfma_f32_16x16x32_bf16 v[16:19], v[116:119], a[52:55], v[16:19]
    v_mfma_f32_16x16x32_bf16 v[20:23], v[116:119], a[108:111], v[20:23]
    v_mfma_f32_16x16x32_bf16 v[24:27], v[116:119], a[164:167], v[24:27]
    v_mfma_f32_16x16x32_bf16 v[28:31], v[116:119], a[220:223], v[28:31]
    v_max3_u32 v3, v3, v116, v117
    v_max3_u32 v3, v3, v118, v119
    v_cmp_eq_u32 vcc, -1, v3
    s_cbranch_vccnz L_retry_336
    v_cvt_pk_bf16_f32 v16, v16, v17
    v_cvt_pk_bf16_f32 v17, v18, v19
    buffer_store_dwordx2 v[16:17], v4, s[8:11], s78 offen offset:0 sc1
    v_cvt_pk_bf16_f32 v20, v20, v21
    v_cvt_pk_bf16_f32 v21, v22, v23
    buffer_store_dwordx2 v[20:21], v4, s[8:11], s78 offen offset:2048 sc1
    v_cvt_pk_bf16_f32 v24, v24, v25
    v_cvt_pk_bf16_f32 v25, v26, v27
    buffer_store_dwordx2 v[24:25], v4, s[8:11], s78 offen offset:1024 sc1
    v_cvt_pk_bf16_f32 v28, v28, v29
    v_cvt_pk_bf16_f32 v29, v30, v31
    buffer_store_dwordx2 v[28:29], v4, s[8:11], s78 offen offset:3072 sc1
    s_add_u32 s81, s81, 1
    v_mov_b32 v3, s81
    s_waitcnt vmcnt(0)
    buffer_store_dword v3, v10, s[8:11], 0 offen sc1
    s_add_u32 s80, s80, 4
    s_cmp_lt_u32 s80, 63
    s_cbranch_scc1 L_zloop
    s_branch L_exit
L_retry_313:
    s_sleep 16
    s_sub_u32 s64, s64, 1
    s_cbranch_scc0 L_wd_311
    s_branch L_exit
L_retry_315:
    s_sleep 8
    s_sub_u32 s64, s64, 1
    s_cbranch_scc0 L_wf_314
    s_branch L_exit
L_retry_317:
    s_sleep 8
    s_sub_u32 s64, s64, 1
    s_cbranch_scc0 L_wf_316
    s_branch L_exit
L_retry_320:
    s_sleep 4
    s_sub_u32 s64, s64, 1
    s_cbranch_scc0 L_wd_318
    s_branch L_exit
L_retry_322:
    s_sleep 16
    s_sub_u32 s64, s64, 1
    s_cbranch_scc0 L_wf_321
    s_branch L_exit
L_retry_326:
    s_sleep 8
    s_sub_u32 s64, s64, 1
    s_cbranch_scc0 L_hm_323
    s_branch L_exit
L_retry_327:
    s_waitcnt vmcnt(0)
    s_sub_u32 s64, s64, 1
    s_cbranch_scc0 L_hm2_324
    s_branch L_exit
L_retry_328:
    s_sub_u32 s64, s64, 1
    s_cbranch_scc0 L_hm2_324
    s_branch L_exit
L_pp_r:
    s_sleep 1
    s_sub_u32 s64, s64, 1
    s_cbranch_scc0 L_pp
    s_branch L_exit
L_retry_330:
    s_cmp_ge_u32 s80, 62
    s_cbranch_scc1 L_pzf_329
    s_sleep 8
L_pzf_329:
    buffer_load_dword v3, v62, s[8:11], 0 offen sc1
    s_waitcnt vmcnt(0)
    s_sub_u32 s64, s64, 1
    s_cbranch_scc0 L_pz
    s_branch L_exit
L_retry_334:
    s_sleep 8
    s_sub_u32 s64, s64, 1
    s_cbranch_scc0 L_hm_331
    s_branch L_exit
L_retry_335:
    s_waitcnt vmcnt(0)
    s_sub_u32 s64, s64, 1
    s_cbranch_scc0 L_hm2_332
    s_branch L_exit
L_retry_336:
    s_sub_u32 s64, s64, 1
    s_cbranch_scc0 L_hm2_332
    s_branch L_exit
L_exit:
    s_endpgm
.section .rodata,"a"
.p2align 6
.amdhsa_kernel concat_heads__linear_attn_block__memory_aug_recurrent_mem_tr__prompt_kernel
  .amdhsa_next_free_vgpr 512
  .amdhsa_next_free_sgpr 102
  .amdhsa_accum_offset 256
  .amdhsa_group_segment_fixed_size 0
  .amdhsa_kernarg_size 104
  .amdhsa_user_sgpr_count 2
  .amdhsa_user_sgpr_kernarg_segment_ptr 1
  .amdhsa_system_sgpr_workgroup_id_x 1
  .amdhsa_float_denorm_mode_32 3
.end_amdhsa_kernel
```
